```python
import torch

def _softmax(x, axis=-1):
    return torch.softmax(x, dim=axis)
def _gelu(x):
    return torch.nn.functional.gelu(x, approximate="tanh")
def _silu(x):
    return torch.nn.functional.silu(x)
def _sigmoid(x):
    return torch.sigmoid(x)
def _layernorm(x, axis=-1, eps=1e-5):
    m = x.mean(dim=axis, keepdim=True)
    v = x.var(dim=axis, keepdim=True, unbiased=False)
    return (x - m) / torch.sqrt(v + eps)
def _scatter_add(tgt, idx, src, axis=0):
    return tgt.clone().index_add_(axis, idx, src)
def _segment_sum(src, seg, n):
    out = torch.zeros((n,) + src.shape[1:], dtype=src.dtype)
    return out.index_add_(0, seg, src)
def _pad(x, pw):
    flat = tuple(v for pair in reversed(pw) for v in pair)
    return torch.nn.functional.pad(x, flat)

kernel_name = 'sequential_preLN__mha_block__mixer_channel_mlp__prompt'

def setup_inputs():

    _w = (lambda a: (lambda t: t.to(torch.bfloat16) if t.is_floating_point() else t)(torch.as_tensor(a)))
    def _A_setup():
        B, S, D, H = 1, 2048, 640, 32
        return {
            "x": _w((lambda *s: torch.randn(*s, dtype=torch.bfloat16) * 0.05)(B, S, D)),
            "wqkv": _w((lambda *s: torch.randn(*s, dtype=torch.bfloat16) * 0.05)(D, 3 * D)),
            "wo": _w((lambda *s: torch.randn(*s, dtype=torch.bfloat16) * 0.05)(D, D)),
        }
    _A_in = _A_setup()

    def _B_setup():
        B, S, D, F = 1, 2048, 640, 1728
        return {
            "x": _w((lambda *s: torch.randn(*s, dtype=torch.bfloat16) * 0.05)(B, S, D)),
            "w1": _w((lambda *s: torch.randn(*s, dtype=torch.bfloat16) * 3.2)(D, F) * (D ** -0.5)),
            "b1": _w((lambda *s: torch.randn(*s, dtype=torch.bfloat16) * 1.6)(F)),
            "w2": _w((lambda *s: torch.randn(*s, dtype=torch.bfloat16) * 0.2)(F, D) * (F ** -0.5)),
            "b2": _w((lambda *s: torch.randn(*s, dtype=torch.bfloat16) * 0.4)(D)),
        }
    _B_in = _B_setup()

    return {
        "A_x": _A_in["x"],
        "A_wqkv": _A_in["wqkv"],
        "A_wo": _A_in["wo"],
        "B_x": _B_in["x"],
        "B_w1": _B_in["w1"],
        "B_b1": _B_in["b1"],
        "B_w2": _B_in["w2"],
        "B_b2": _B_in["b2"],
    }

def reference(A_x, A_wqkv, A_wo, B_x, B_w1, B_b1, B_w2, B_b2):
    def _A_ref(x, wqkv, wo):
        B, S, D = x.shape
        H = 32
        Dh = D // H
        qkv = (lambda x, *d: x.permute(*d))((x @ wqkv).reshape(B, S, 3, H, Dh), 2, 0, 3, 1, 4)
        q, k, v = qkv[0], qkv[1], qkv[2]
        scores = torch.einsum("bhqd,bhkd->bhqk", q, k) * (Dh ** -0.5)
        p = _softmax(scores, axis=-1)
        o = torch.einsum("bhqk,bhkd->bhqd", p, v)
        return (lambda x, *d: x.permute(*d))(o, 0, 2, 1, 3).reshape(B, S, D) @ wo

    def _B_ref(x, w1, b1, w2, b2):
        y = _layernorm(x, axis=-1)
        h = _gelu(torch.einsum("bsd,df->bsf", y, w1) + b1)
        return torch.einsum("bsf,fd->bsd", h, w2) + b2

    x = A_x
    h = x + _A_ref(_layernorm(x, axis=-1), A_wqkv, A_wo)
    h2 = h + _B_ref(_layernorm(h, axis=-1), B_w1, B_b1, B_w2, B_b2)
    return h2
```

```asm
; @launch grid=(256,1,1) block=(512,1,1) lds=159744
.amdgcn_target "amdgcn-amd-amdhsa--gfx950"
.text
.globl sequential_preLN__mha_block__mixer_channel_mlp__prompt_kernel
.p2align 8
.type sequential_preLN__mha_block__mixer_channel_mlp__prompt_kernel,@function
sequential_preLN__mha_block__mixer_channel_mlp__prompt_kernel:
    s_cmp_ge_u32 s2, 256
    s_cbranch_scc1 L_exit
    s_load_dwordx4 s[36:39], s[0:1], 0
    s_load_dwordx4 s[40:43], s[0:1], 72
    s_and_b32 s30, s2, 7
    s_lshr_b32 s31, s2, 3
    s_lshr_b32 s20, s30, 1
    s_lshl_b32 s20, s20, 2
    s_and_b32 s21, s31, 3
    s_add_u32 s20, s20, s21
    s_and_b32 s21, s30, 1
    s_lshl_b32 s21, s21, 3
    s_lshr_b32 s31, s31, 2
    s_add_u32 s21, s21, s31
    v_lshrrev_b32 v18, 6, v0
    v_and_b32 v1, 63, v0
    v_readfirstlane_b32 s89, v18
    v_and_b32 v2, 31, v0
    v_bfe_u32 v3, v0, 5, 1
    s_and_b32 s22, s89, 3
    s_cmp_lt_u32 s89, 4
    s_cbranch_scc1 L_p1_compute
    s_cmp_ge_u32 s21, 15
    s_cbranch_scc1 L_p1_auxl
    v_lshrrev_b32 v18, 3, v1
    v_and_b32 v19, 7, v1
    v_lshrrev_b32 v20, 1, v18
    v_xor_b32 v20, v20, v19
    v_xor_b32 v21, 4, v20
    s_lshl_b32 s30, s20, 7
    s_lshl_b32 s31, s22, 5
    s_add_u32 s30, s30, s31
    v_add_u32 v18, s30, v18
    v_mul_u32_u24 v18, 1280, v18
    v_lshl_add_u32 v4, v20, 4, v18
    v_lshl_add_u32 v5, v21, 4, v18
    v_add_u32 v5, 9216, v5
    v_lshl_add_u32 v6, v20, 4, v18
    v_add_u32 v6, 18432, v6
    v_lshl_add_u32 v7, v21, 4, v18
    v_add_u32 v7, 27648, v7
    v_lshrrev_b32 v18, 4, v1
    v_and_b32 v19, 15, v1
    v_lshlrev_b32 v20, 2, v18
    v_xor_b32 v19, v19, v20
    s_lshl_b32 s30, s22, 4
    v_add_u32 v18, s30, v18
    v_mul_u32_u24 v18, 3840, v18
    v_lshl_add_u32 v18, v19, 4, v18
    s_lshl_b32 s30, s21, 8
    v_add_u32 v8, s30, v18
    v_add_u32 v9, 14336, v8
    v_add_u32 v10, 28672, v8
    v_add_u32 v11, 43008, v8
    s_add_u32 s32, s20, s21
    s_and_b32 s32, s32, 1
    s_mul_i32 s32, s32, 1
    s_mul_i32 s25, s32, 128
    s_mul_i32 s26, s32, 245760
    s_lshl_b32 s27, s22, 12
    s_mov_b32 s28, 0
    s_waitcnt lgkmcnt(0)
    s_mov_b32 s4, s36
    s_and_b32 s5, s37, 0xffff
    s_mov_b32 s6, 0x280000
    s_mov_b32 s7, 0x00020000
    s_mov_b32 s8, s38
    s_and_b32 s9, s39, 0xffff
    s_mov_b32 s10, 0x258000
    s_mov_b32 s11, 0x00020000
    s_add_u32 m0, s27, 0
    s_nop 0
    buffer_load_dwordx4 v4, s[4:7], s25 offen offset:0 lds
    buffer_load_dwordx4 v5, s[4:7], s25 offen offset:1024 lds
    buffer_load_dwordx4 v6, s[4:7], s25 offen offset:2048 lds
    buffer_load_dwordx4 v7, s[4:7], s25 offen offset:3072 lds
    s_add_u32 s25, s25, 128
    s_cmp_lg_u32 s25, 1280
    s_cselect_b32 s25, s25, 0
    s_add_u32 m0, s27, 16384
    s_nop 0
    buffer_load_dwordx4 v8, s[8:11], s26 offen offset:0 lds
    buffer_load_dwordx4 v9, s[8:11], s26 offen offset:1024 lds
    buffer_load_dwordx4 v10, s[8:11], s26 offen offset:2048 lds
    buffer_load_dwordx4 v11, s[8:11], s26 offen offset:3072 lds
    s_add_u32 s26, s26, 245760
    s_cmp_lg_u32 s26, 2457600
    s_cselect_b32 s26, s26, 0
    s_add_u32 m0, s27, 32768
    s_nop 0
    buffer_load_dwordx4 v4, s[4:7], s25 offen offset:0 lds
    buffer_load_dwordx4 v5, s[4:7], s25 offen offset:1024 lds
    buffer_load_dwordx4 v6, s[4:7], s25 offen offset:2048 lds
    buffer_load_dwordx4 v7, s[4:7], s25 offen offset:3072 lds
    s_add_u32 s25, s25, 128
    s_cmp_lg_u32 s25, 1280
    s_cselect_b32 s25, s25, 0
    s_add_u32 m0, s27, 49152
    s_nop 0
    buffer_load_dwordx4 v8, s[8:11], s26 offen offset:0 lds
    buffer_load_dwordx4 v9, s[8:11], s26 offen offset:1024 lds
    buffer_load_dwordx4 v10, s[8:11], s26 offen offset:2048 lds
    buffer_load_dwordx4 v11, s[8:11], s26 offen offset:3072 lds
    s_add_u32 s26, s26, 245760
    s_cmp_lg_u32 s26, 2457600
    s_cselect_b32 s26, s26, 0
    s_cmp_ge_u32 s22, 2
    s_cbranch_scc1 L_p1_slc
    v_lshrrev_b32 v22, 4, v1
    v_and_b32 v23, 15, v1
    v_mul_u32_u24 v22, 1280, v22
    v_lshl_add_u32 v22, v23, 4, v22
    s_lshl_b32 s30, s20, 5
    s_lshl_b32 s31, s21, 1
    s_add_u32 s30, s30, s31
    s_add_u32 s29, s30, s22
    s_mul_i32 s30, s29, 5120
    buffer_load_dwordx4 v[32:35], v22, s[4:7], s30 offen offset:0
    buffer_load_dwordx4 v[36:39], v22, s[4:7], s30 offen offset:256
    buffer_load_dwordx4 v[40:43], v22, s[4:7], s30 offen offset:512
    buffer_load_dwordx4 v[44:47], v22, s[4:7], s30 offen offset:768
    buffer_load_dwordx4 v[48:51], v22, s[4:7], s30 offen offset:1024
    s_branch L_p1_sll
L_p1_slc:
    v_lshrrev_b32 v22, 4, v1
    v_and_b32 v23, 15, v1
    v_mul_u32_u24 v22, 3840, v22
    v_lshl_add_u32 v22, v23, 4, v22
    s_lshl_b32 s29, s20, 1
    s_add_u32 s29, s29, s22
    s_sub_u32 s29, s29, 2
    s_mul_i32 s30, s29, 76800
    s_lshl_b32 s31, s21, 8
    s_add_u32 s30, s30, s31
    buffer_load_dwordx4 v[32:35], v22, s[8:11], s30 offen
    s_add_u32 s30, s30, 15360
    buffer_load_dwordx4 v[36:39], v22, s[8:11], s30 offen
    s_add_u32 s30, s30, 15360
    buffer_load_dwordx4 v[40:43], v22, s[8:11], s30 offen
    s_add_u32 s30, s30, 15360
    buffer_load_dwordx4 v[44:47], v22, s[8:11], s30 offen
    s_add_u32 s30, s30, 15360
    buffer_load_dwordx4 v[48:51], v22, s[8:11], s30 offen
    s_add_u32 s30, s30, 15360
L_p1_sll:
    s_mov_b32 s12, s42
    s_and_b32 s13, s43, 0xffff
    s_mov_b32 s14, 0x1428800
    s_mov_b32 s15, 0x00020000
    s_mov_b32 s16, s40
    s_and_b32 s17, s41, 0xffff
    s_mov_b32 s18, 0x100
    s_mov_b32 s19, 0x00020000
    s_waitcnt vmcnt(13)
    s_barrier
    v_mov_b32 v15, 0
    buffer_load_dword v16, v15, s[16:19], 0 offen sc1
    s_add_u32 m0, s27, 65536
    s_nop 0
    buffer_load_dwordx4 v4, s[4:7], s25 offen offset:0 lds
    buffer_load_dwordx4 v5, s[4:7], s25 offen offset:1024 lds
    buffer_load_dwordx4 v6, s[4:7], s25 offen offset:2048 lds
    buffer_load_dwordx4 v7, s[4:7], s25 offen offset:3072 lds
    s_add_u32 s25, s25, 128
    s_cmp_lg_u32 s25, 1280
    s_cselect_b32 s25, s25, 0
    s_add_u32 m0, s27, 81920
    s_nop 0
    buffer_load_dwordx4 v8, s[8:11], s26 offen offset:0 lds
    buffer_load_dwordx4 v9, s[8:11], s26 offen offset:1024 lds
    buffer_load_dwordx4 v10, s[8:11], s26 offen offset:2048 lds
    buffer_load_dwordx4 v11, s[8:11], s26 offen offset:3072 lds
    s_add_u32 s26, s26, 245760
    s_cmp_lg_u32 s26, 2457600
    s_cselect_b32 s26, s26, 0
    s_waitcnt vmcnt(14)
    s_barrier
    s_add_u32 m0, s27, 98304
    s_nop 0
    buffer_load_dwordx4 v4, s[4:7], s25 offen offset:0 lds
    buffer_load_dwordx4 v5, s[4:7], s25 offen offset:1024 lds
    buffer_load_dwordx4 v6, s[4:7], s25 offen offset:2048 lds
    buffer_load_dwordx4 v7, s[4:7], s25 offen offset:3072 lds
    s_add_u32 s25, s25, 128
    s_cmp_lg_u32 s25, 1280
    s_cselect_b32 s25, s25, 0
    s_add_u32 m0, s27, 114688
    s_nop 0
    buffer_load_dwordx4 v8, s[8:11], s26 offen offset:0 lds
    buffer_load_dwordx4 v9, s[8:11], s26 offen offset:1024 lds
    buffer_load_dwordx4 v10, s[8:11], s26 offen offset:2048 lds
    buffer_load_dwordx4 v11, s[8:11], s26 offen offset:3072 lds
    s_add_u32 s26, s26, 245760
    s_cmp_lg_u32 s26, 2457600
    s_cselect_b32 s26, s26, 0
    s_waitcnt vmcnt(8)
    s_barrier
    s_add_u32 m0, s27, 0
    s_nop 0
    buffer_load_dwordx4 v4, s[4:7], s25 offen offset:0 lds
    buffer_load_dwordx4 v5, s[4:7], s25 offen offset:1024 lds
    buffer_load_dwordx4 v6, s[4:7], s25 offen offset:2048 lds
    buffer_load_dwordx4 v7, s[4:7], s25 offen offset:3072 lds
    s_add_u32 s25, s25, 128
    s_cmp_lg_u32 s25, 1280
    s_cselect_b32 s25, s25, 0
    s_add_u32 m0, s27, 16384
    s_nop 0
    buffer_load_dwordx4 v8, s[8:11], s26 offen offset:0 lds
    buffer_load_dwordx4 v9, s[8:11], s26 offen offset:1024 lds
    buffer_load_dwordx4 v10, s[8:11], s26 offen offset:2048 lds
    buffer_load_dwordx4 v11, s[8:11], s26 offen offset:3072 lds
    s_add_u32 s26, s26, 245760
    s_cmp_lg_u32 s26, 2457600
    s_cselect_b32 s26, s26, 0
    s_cmp_ge_u32 s22, 2
    s_cbranch_scc1 L_p1_slc0
    v_mov_b32 v56, 0
    v_mov_b32 v57, 0
    v_mov_b32 v58, 0
    v_mov_b32 v59, 0
    v_lshlrev_b32 v52, 16, v32
    v_and_b32 v53, 0xffff0000, v32
    v_add_f32 v56, v56, v52
    v_fmac_f32 v57, v52, v52
    v_add_f32 v58, v58, v53
    v_fmac_f32 v59, v53, v53
    v_lshlrev_b32 v52, 16, v33
    v_and_b32 v53, 0xffff0000, v33
    v_add_f32 v56, v56, v52
    v_fmac_f32 v57, v52, v52
    v_add_f32 v58, v58, v53
    v_fmac_f32 v59, v53, v53
    v_lshlrev_b32 v52, 16, v34
    v_and_b32 v53, 0xffff0000, v34
    v_add_f32 v56, v56, v52
    v_fmac_f32 v57, v52, v52
    v_add_f32 v58, v58, v53
    v_fmac_f32 v59, v53, v53
    v_lshlrev_b32 v52, 16, v35
    v_and_b32 v53, 0xffff0000, v35
    v_add_f32 v56, v56, v52
    v_fmac_f32 v57, v52, v52
    v_add_f32 v58, v58, v53
    v_fmac_f32 v59, v53, v53
    v_lshlrev_b32 v52, 16, v36
    v_and_b32 v53, 0xffff0000, v36
    v_add_f32 v56, v56, v52
    v_fmac_f32 v57, v52, v52
    v_add_f32 v58, v58, v53
    v_fmac_f32 v59, v53, v53
    v_lshlrev_b32 v52, 16, v37
    v_and_b32 v53, 0xffff0000, v37
    v_add_f32 v56, v56, v52
    v_fmac_f32 v57, v52, v52
    v_add_f32 v58, v58, v53
    v_fmac_f32 v59, v53, v53
    v_lshlrev_b32 v52, 16, v38
    v_and_b32 v53, 0xffff0000, v38
    v_add_f32 v56, v56, v52
    v_fmac_f32 v57, v52, v52
    v_add_f32 v58, v58, v53
    v_fmac_f32 v59, v53, v53
    v_lshlrev_b32 v52, 16, v39
    v_and_b32 v53, 0xffff0000, v39
    v_add_f32 v56, v56, v52
    v_fmac_f32 v57, v52, v52
    v_add_f32 v58, v58, v53
    v_fmac_f32 v59, v53, v53
    v_lshlrev_b32 v52, 16, v40
    v_and_b32 v53, 0xffff0000, v40
    v_add_f32 v56, v56, v52
    v_fmac_f32 v57, v52, v52
    v_add_f32 v58, v58, v53
    v_fmac_f32 v59, v53, v53
    v_lshlrev_b32 v52, 16, v41
    v_and_b32 v53, 0xffff0000, v41
    v_add_f32 v56, v56, v52
    v_fmac_f32 v57, v52, v52
    v_add_f32 v58, v58, v53
    v_fmac_f32 v59, v53, v53
    v_lshlrev_b32 v52, 16, v42
    v_and_b32 v53, 0xffff0000, v42
    v_add_f32 v56, v56, v52
    v_fmac_f32 v57, v52, v52
    v_add_f32 v58, v58, v53
    v_fmac_f32 v59, v53, v53
    v_lshlrev_b32 v52, 16, v43
    v_and_b32 v53, 0xffff0000, v43
    v_add_f32 v56, v56, v52
    v_fmac_f32 v57, v52, v52
    v_add_f32 v58, v58, v53
    v_fmac_f32 v59, v53, v53
    v_lshlrev_b32 v52, 16, v44
    v_and_b32 v53, 0xffff0000, v44
    v_add_f32 v56, v56, v52
    v_fmac_f32 v57, v52, v52
    v_add_f32 v58, v58, v53
    v_fmac_f32 v59, v53, v53
    s_branch L_p1_sld0
L_p1_slc0:
    v_lshlrev_b32 v56, 16, v32
    v_and_b32 v57, 0xffff0000, v32
    v_lshlrev_b32 v58, 16, v33
    v_and_b32 v59, 0xffff0000, v33
    v_lshlrev_b32 v60, 16, v34
    v_and_b32 v61, 0xffff0000, v34
    v_lshlrev_b32 v62, 16, v35
    v_and_b32 v63, 0xffff0000, v35
    v_lshlrev_b32 v52, 16, v36
    v_and_b32 v53, 0xffff0000, v36
    v_add_f32 v56, v56, v52
    v_add_f32 v57, v57, v53
    v_lshlrev_b32 v52, 16, v37
    v_and_b32 v53, 0xffff0000, v37
    v_add_f32 v58, v58, v52
    v_add_f32 v59, v59, v53
    v_lshlrev_b32 v52, 16, v38
    v_and_b32 v53, 0xffff0000, v38
    v_add_f32 v60, v60, v52
    v_add_f32 v61, v61, v53
    v_lshlrev_b32 v52, 16, v39
    v_and_b32 v53, 0xffff0000, v39
    v_add_f32 v62, v62, v52
    v_add_f32 v63, v63, v53
    v_lshlrev_b32 v52, 16, v40
    v_and_b32 v53, 0xffff0000, v40
    v_add_f32 v56, v56, v52
    v_add_f32 v57, v57, v53
    v_lshlrev_b32 v52, 16, v41
    v_and_b32 v53, 0xffff0000, v41
    v_add_f32 v58, v58, v52
    v_add_f32 v59, v59, v53
    v_lshlrev_b32 v52, 16, v42
    v_and_b32 v53, 0xffff0000, v42
    v_add_f32 v60, v60, v52
    v_add_f32 v61, v61, v53
    v_lshlrev_b32 v52, 16, v43
    v_and_b32 v53, 0xffff0000, v43
    v_add_f32 v62, v62, v52
    v_add_f32 v63, v63, v53
    v_lshlrev_b32 v52, 16, v44
    v_and_b32 v53, 0xffff0000, v44
    v_add_f32 v56, v56, v52
    v_add_f32 v57, v57, v53
    v_lshlrev_b32 v52, 16, v45
    v_and_b32 v53, 0xffff0000, v45
    v_add_f32 v58, v58, v52
    v_add_f32 v59, v59, v53
    v_lshlrev_b32 v52, 16, v46
    v_and_b32 v53, 0xffff0000, v46
    v_add_f32 v60, v60, v52
    v_add_f32 v61, v61, v53
    v_lshlrev_b32 v52, 16, v47
    v_and_b32 v53, 0xffff0000, v47
    v_add_f32 v62, v62, v52
    v_add_f32 v63, v63, v53
    v_lshlrev_b32 v52, 16, v48
    v_and_b32 v53, 0xffff0000, v48
    v_add_f32 v56, v56, v52
    v_add_f32 v57, v57, v53
    v_lshlrev_b32 v52, 16, v49
    v_and_b32 v53, 0xffff0000, v49
    v_add_f32 v58, v58, v52
    v_add_f32 v59, v59, v53
    v_lshlrev_b32 v52, 16, v50
    v_and_b32 v53, 0xffff0000, v50
    v_add_f32 v60, v60, v52
    v_add_f32 v61, v61, v53
    v_lshlrev_b32 v52, 16, v51
    v_and_b32 v53, 0xffff0000, v51
    v_add_f32 v62, v62, v52
    v_add_f32 v63, v63, v53
L_p1_sld0:
    s_waitcnt vmcnt(8)
    s_barrier
    s_add_u32 m0, s27, 32768
    s_nop 0
    buffer_load_dwordx4 v4, s[4:7], s25 offen offset:0 lds
    buffer_load_dwordx4 v5, s[4:7], s25 offen offset:1024 lds
    buffer_load_dwordx4 v6, s[4:7], s25 offen offset:2048 lds
    buffer_load_dwordx4 v7, s[4:7], s25 offen offset:3072 lds
    s_add_u32 s25, s25, 128
    s_cmp_lg_u32 s25, 1280
    s_cselect_b32 s25, s25, 0
    s_add_u32 m0, s27, 49152
    s_nop 0
    buffer_load_dwordx4 v8, s[8:11], s26 offen offset:0 lds
    buffer_load_dwordx4 v9, s[8:11], s26 offen offset:1024 lds
    buffer_load_dwordx4 v10, s[8:11], s26 offen offset:2048 lds
    buffer_load_dwordx4 v11, s[8:11], s26 offen offset:3072 lds
    s_add_u32 s26, s26, 245760
    s_cmp_lg_u32 s26, 2457600
    s_cselect_b32 s26, s26, 0
    s_mov_b32 s28, 0
L_p1_twa:
    v_cmp_eq_u32 vcc, 0, v16
    s_nop 1
    s_cbranch_vccz L_p1_tra
    s_sleep 2
    buffer_load_dword v16, v15, s[16:19], 0 offen sc1
    s_add_u32 s28, s28, 1
    s_waitcnt vmcnt(0)
    s_cmp_lt_u32 s28, 0x4000
    s_cbranch_scc1 L_p1_twa
L_p1_tra:
    s_cmp_ge_u32 s22, 2
    s_cbranch_scc1 L_p1_slc1
    v_lshlrev_b32 v52, 16, v45
    v_and_b32 v53, 0xffff0000, v45
    v_add_f32 v56, v56, v52
    v_fmac_f32 v57, v52, v52
    v_add_f32 v58, v58, v53
    v_fmac_f32 v59, v53, v53
    v_lshlrev_b32 v52, 16, v46
    v_and_b32 v53, 0xffff0000, v46
    v_add_f32 v56, v56, v52
    v_fmac_f32 v57, v52, v52
    v_add_f32 v58, v58, v53
    v_fmac_f32 v59, v53, v53
    v_lshlrev_b32 v52, 16, v47
    v_and_b32 v53, 0xffff0000, v47
    v_add_f32 v56, v56, v52
    v_fmac_f32 v57, v52, v52
    v_add_f32 v58, v58, v53
    v_fmac_f32 v59, v53, v53
    v_lshlrev_b32 v52, 16, v48
    v_and_b32 v53, 0xffff0000, v48
    v_add_f32 v56, v56, v52
    v_fmac_f32 v57, v52, v52
    v_add_f32 v58, v58, v53
    v_fmac_f32 v59, v53, v53
    v_lshlrev_b32 v52, 16, v49
    v_and_b32 v53, 0xffff0000, v49
    v_add_f32 v56, v56, v52
    v_fmac_f32 v57, v52, v52
    v_add_f32 v58, v58, v53
    v_fmac_f32 v59, v53, v53
    v_lshlrev_b32 v52, 16, v50
    v_and_b32 v53, 0xffff0000, v50
    v_add_f32 v56, v56, v52
    v_fmac_f32 v57, v52, v52
    v_add_f32 v58, v58, v53
    v_fmac_f32 v59, v53, v53
    v_lshlrev_b32 v52, 16, v51
    v_and_b32 v53, 0xffff0000, v51
    v_add_f32 v56, v56, v52
    v_fmac_f32 v57, v52, v52
    v_add_f32 v58, v58, v53
    v_fmac_f32 v59, v53, v53
    v_add_f32 v56, v56, v58
    v_add_f32 v57, v57, v59
    s_nop 0
    v_add_f32_dpp v56, v56, v56 row_ror:8 row_mask:0xf bank_mask:0xf
    v_add_f32_dpp v57, v57, v57 row_ror:8 row_mask:0xf bank_mask:0xf
    s_nop 0
    v_add_f32_dpp v56, v56, v56 row_ror:4 row_mask:0xf bank_mask:0xf
    v_add_f32_dpp v57, v57, v57 row_ror:4 row_mask:0xf bank_mask:0xf
    s_nop 0
    v_add_f32_dpp v56, v56, v56 row_ror:2 row_mask:0xf bank_mask:0xf
    v_add_f32_dpp v57, v57, v57 row_ror:2 row_mask:0xf bank_mask:0xf
    s_nop 0
    v_add_f32_dpp v56, v56, v56 row_ror:1 row_mask:0xf bank_mask:0xf
    v_add_f32_dpp v57, v57, v57 row_ror:1 row_mask:0xf bank_mask:0xf
    v_mul_f32 v60, 0xbacccccd, v56
    v_mul_f32 v57, 0x3acccccd, v57
    v_fma_f32 v57, -v60, v60, v57
    v_max_f32 v57, 0, v57
    v_add_f32 v52, 0x3727c5ac, v57
    v_rsq_f32 v62, v52
    v_mov_b32 v61, v16
    v_mov_b32 v63, v16
    s_lshl_b32 s30, s29, 6
    s_add_u32 s30, s30, 20414464
    s_mov_b32 exec_lo, 0x00010001
    s_mov_b32 exec_hi, 0x00010001
    buffer_store_dwordx4 v[60:63], v1, s[12:15], s30 offen sc1
    s_mov_b64 exec, -1
    s_branch L_p1_sld1
L_p1_slc1:
    v_permlane32_swap_b32 v56, v60
    v_permlane32_swap_b32 v57, v61
    v_permlane32_swap_b32 v58, v62
    v_permlane32_swap_b32 v59, v63
    v_add_f32 v56, v56, v60
    v_add_f32 v57, v57, v61
    v_add_f32 v58, v58, v62
    v_add_f32 v59, v59, v63
    s_nop 0
    v_permlane16_swap_b32 v56, v58
    v_permlane16_swap_b32 v57, v59
    v_add_f32 v56, v56, v58
    v_add_f32 v58, v57, v59
    v_mov_b32 v57, v16
    v_mov_b32 v59, v16
    v_and_b32 v22, 48, v1
    v_lshl_add_u32 v22, v23, 6, v22
    s_mul_i32 s30, s29, 15360
    s_lshl_b32 s31, s21, 10
    s_add_u32 s30, s30, s31
    s_add_u32 s30, s30, 20447232
    buffer_store_dwordx4 v[56:59], v22, s[12:15], s30 offen sc1
L_p1_sld1:
    s_waitcnt vmcnt(9)
    s_barrier
    s_add_u32 m0, s27, 65536
    s_nop 0
    buffer_load_dwordx4 v4, s[4:7], s25 offen offset:0 lds
    buffer_load_dwordx4 v5, s[4:7], s25 offen offset:1024 lds
    buffer_load_dwordx4 v6, s[4:7], s25 offen offset:2048 lds
    buffer_load_dwordx4 v7, s[4:7], s25 offen offset:3072 lds
    s_add_u32 s25, s25, 128
    s_cmp_lg_u32 s25, 1280
    s_cselect_b32 s25, s25, 0
    s_add_u32 m0, s27, 81920
    s_nop 0
    buffer_load_dwordx4 v8, s[8:11], s26 offen offset:0 lds
    buffer_load_dwordx4 v9, s[8:11], s26 offen offset:1024 lds
    buffer_load_dwordx4 v10, s[8:11], s26 offen offset:2048 lds
    buffer_load_dwordx4 v11, s[8:11], s26 offen offset:3072 lds
    s_add_u32 s26, s26, 245760
    s_cmp_lg_u32 s26, 2457600
    s_cselect_b32 s26, s26, 0
    s_waitcnt vmcnt(9)
    s_barrier
    s_add_u32 m0, s27, 98304
    s_nop 0
    buffer_load_dwordx4 v4, s[4:7], s25 offen offset:0 lds
    buffer_load_dwordx4 v5, s[4:7], s25 offen offset:1024 lds
    buffer_load_dwordx4 v6, s[4:7], s25 offen offset:2048 lds
    buffer_load_dwordx4 v7, s[4:7], s25 offen offset:3072 lds
    s_add_u32 s25, s25, 128
    s_cmp_lg_u32 s25, 1280
    s_cselect_b32 s25, s25, 0
    s_add_u32 m0, s27, 114688
    s_nop 0
    buffer_load_dwordx4 v8, s[8:11], s26 offen offset:0 lds
    buffer_load_dwordx4 v9, s[8:11], s26 offen offset:1024 lds
    buffer_load_dwordx4 v10, s[8:11], s26 offen offset:2048 lds
    buffer_load_dwordx4 v11, s[8:11], s26 offen offset:3072 lds
    s_add_u32 s26, s26, 245760
    s_cmp_lg_u32 s26, 2457600
    s_cselect_b32 s26, s26, 0
    s_waitcnt vmcnt(8)
    s_barrier
    s_add_u32 m0, s27, 0
    s_nop 0
    buffer_load_dwordx4 v4, s[4:7], s25 offen offset:0 lds
    buffer_load_dwordx4 v5, s[4:7], s25 offen offset:1024 lds
    buffer_load_dwordx4 v6, s[4:7], s25 offen offset:2048 lds
    buffer_load_dwordx4 v7, s[4:7], s25 offen offset:3072 lds
    s_add_u32 s25, s25, 128
    s_cmp_lg_u32 s25, 1280
    s_cselect_b32 s25, s25, 0
    s_add_u32 m0, s27, 16384
    s_nop 0
    buffer_load_dwordx4 v8, s[8:11], s26 offen offset:0 lds
    buffer_load_dwordx4 v9, s[8:11], s26 offen offset:1024 lds
    buffer_load_dwordx4 v10, s[8:11], s26 offen offset:2048 lds
    buffer_load_dwordx4 v11, s[8:11], s26 offen offset:3072 lds
    s_add_u32 s26, s26, 245760
    s_cmp_lg_u32 s26, 2457600
    s_cselect_b32 s26, s26, 0
    s_waitcnt vmcnt(8)
    s_barrier
    s_add_u32 m0, s27, 32768
    s_nop 0
    buffer_load_dwordx4 v4, s[4:7], s25 offen offset:0 lds
    buffer_load_dwordx4 v5, s[4:7], s25 offen offset:1024 lds
    buffer_load_dwordx4 v6, s[4:7], s25 offen offset:2048 lds
    buffer_load_dwordx4 v7, s[4:7], s25 offen offset:3072 lds
    s_add_u32 s25, s25, 128
    s_cmp_lg_u32 s25, 1280
    s_cselect_b32 s25, s25, 0
    s_add_u32 m0, s27, 49152
    s_nop 0
    buffer_load_dwordx4 v8, s[8:11], s26 offen offset:0 lds
    buffer_load_dwordx4 v9, s[8:11], s26 offen offset:1024 lds
    buffer_load_dwordx4 v10, s[8:11], s26 offen offset:2048 lds
    buffer_load_dwordx4 v11, s[8:11], s26 offen offset:3072 lds
    s_add_u32 s26, s26, 245760
    s_cmp_lg_u32 s26, 2457600
    s_cselect_b32 s26, s26, 0
    s_lshl_b32 s30, s20, 11
    s_lshl_b32 s31, s22, 9
    s_add_u32 s30, s30, s31
    s_add_u32 s25, s30, 20414464
    v_lshlrev_b32 v18, 4, v2
    v_lshrrev_b32 v19, 4, v1
    v_mul_u32_u24 v19, 122880, v19
    v_lshl_add_u32 v19, v23, 4, v19
    s_lshl_b32 s30, s21, 10
    s_lshl_b32 s31, s22, 8
    s_add_u32 s30, s30, s31
    s_add_u32 s26, s30, 20447232
    buffer_load_dwordx4 v[64:67], v18, s[12:15], s25 offen sc1
    s_mov_b32 s30, s26
    buffer_load_dwordx4 v[32:35], v19, s[12:15], s30 offen sc1
    s_add_u32 s30, s30, 15360
    buffer_load_dwordx4 v[36:39], v19, s[12:15], s30 offen sc1
    s_add_u32 s30, s30, 15360
    buffer_load_dwordx4 v[40:43], v19, s[12:15], s30 offen sc1
    s_add_u32 s30, s30, 15360
    buffer_load_dwordx4 v[44:47], v19, s[12:15], s30 offen sc1
    s_add_u32 s30, s30, 15360
    buffer_load_dwordx4 v[48:51], v19, s[12:15], s30 offen sc1
    s_add_u32 s30, s30, 15360
    buffer_load_dwordx4 v[52:55], v19, s[12:15], s30 offen sc1
    s_add_u32 s30, s30, 15360
    buffer_load_dwordx4 v[56:59], v19, s[12:15], s30 offen sc1
    s_add_u32 s30, s30, 15360
    buffer_load_dwordx4 v[60:63], v19, s[12:15], s30 offen sc1
    s_add_u32 s30, s30, 15360
    s_waitcnt vmcnt(17)
    s_barrier
    s_waitcnt vmcnt(9)
    s_barrier
    s_mov_b32 s28, 0
L_p1_poll:
    s_waitcnt vmcnt(0)
    v_and_b32 v68, v65, v67
    v_or_b32 v69, v65, v67
    v_and_b32 v68, v68, v33
    v_or_b32 v69, v69, v33
    v_and_b32 v68, v68, v35
    v_or_b32 v69, v69, v35
    v_and_b32 v68, v68, v37
    v_or_b32 v69, v69, v37
    v_and_b32 v68, v68, v39
    v_or_b32 v69, v69, v39
    v_and_b32 v68, v68, v41
    v_or_b32 v69, v69, v41
    v_and_b32 v68, v68, v43
    v_or_b32 v69, v69, v43
    v_and_b32 v68, v68, v45
    v_or_b32 v69, v69, v45
    v_and_b32 v68, v68, v47
    v_or_b32 v69, v69, v47
    v_and_b32 v68, v68, v49
    v_or_b32 v69, v69, v49
    v_and_b32 v68, v68, v51
    v_or_b32 v69, v69, v51
    v_and_b32 v68, v68, v53
    v_or_b32 v69, v69, v53
    v_and_b32 v68, v68, v55
    v_or_b32 v69, v69, v55
    v_and_b32 v68, v68, v57
    v_or_b32 v69, v69, v57
    v_and_b32 v68, v68, v59
    v_or_b32 v69, v69, v59
    v_and_b32 v68, v68, v61
    v_or_b32 v69, v69, v61
    v_and_b32 v68, v68, v63
    v_or_b32 v69, v69, v63
    v_xor_b32 v68, v68, v16
    v_xor_b32 v69, v69, v16
    v_or_b32 v68, v68, v69
    v_cmp_ne_u32 vcc, 0, v68
    s_nop 1
    s_cbranch_vccz L_p1_ready
    s_sleep 2
    buffer_load_dwordx4 v[64:67], v18, s[12:15], s25 offen sc1
    s_mov_b32 s30, s26
    buffer_load_dwordx4 v[32:35], v19, s[12:15], s30 offen sc1
    s_add_u32 s30, s30, 15360
    buffer_load_dwordx4 v[36:39], v19, s[12:15], s30 offen sc1
    s_add_u32 s30, s30, 15360
    buffer_load_dwordx4 v[40:43], v19, s[12:15], s30 offen sc1
    s_add_u32 s30, s30, 15360
    buffer_load_dwordx4 v[44:47], v19, s[12:15], s30 offen sc1
    s_add_u32 s30, s30, 15360
    buffer_load_dwordx4 v[48:51], v19, s[12:15], s30 offen sc1
    s_add_u32 s30, s30, 15360
    buffer_load_dwordx4 v[52:55], v19, s[12:15], s30 offen sc1
    s_add_u32 s30, s30, 15360
    buffer_load_dwordx4 v[56:59], v19, s[12:15], s30 offen sc1
    s_add_u32 s30, s30, 15360
    buffer_load_dwordx4 v[60:63], v19, s[12:15], s30 offen sc1
    s_add_u32 s30, s30, 15360
    s_add_u32 s28, s28, 1
    s_cmp_lt_u32 s28, 0x2000
    s_cbranch_scc1 L_p1_poll
    s_waitcnt vmcnt(0)
L_p1_ready:
    v_add_f32 v33, v34, v38
    v_add_f32 v32, v32, v36
    v_add_f32 v32, v32, v40
    v_add_f32 v33, v33, v42
    v_add_f32 v32, v32, v44
    v_add_f32 v33, v33, v46
    v_add_f32 v32, v32, v48
    v_add_f32 v33, v33, v50
    v_add_f32 v32, v32, v52
    v_add_f32 v33, v33, v54
    v_add_f32 v32, v32, v56
    v_add_f32 v33, v33, v58
    v_add_f32 v32, v32, v60
    v_add_f32 v33, v33, v62
    s_cmp_lt_u32 s21, 5
    s_cselect_b32 s30, 0x3ea52b5c, 1.0
    v_mul_f32 v65, s30, v66
    s_lshl_b32 s31, s22, 7
    s_add_u32 s31, s31, 131072
    v_lshl_add_u32 v18, v2, 2, s31
    ds_write2_b32 v18, v64, v65 offset0:0 offset1:128
    v_mov_b32 v34, v32
    v_mov_b32 v35, v33
    s_nop 0
    v_permlane32_swap_b32 v32, v34
    v_permlane32_swap_b32 v33, v35
    v_add_f32 v32, v32, v34
    v_add_f32 v33, v33, v35
    v_mov_b32 v34, v32
    v_mov_b32 v35, v33
    s_nop 0
    v_permlane16_swap_b32 v32, v34
    v_permlane16_swap_b32 v33, v35
    v_add_f32 v32, v32, v34
    v_add_f32 v33, v33, v35
    v_lshl_add_u32 v19, v23, 3, s31
    ds_write_b64 v19, v[32:33] offset:1024
    s_waitcnt lgkmcnt(0)
    s_barrier
    s_branch L_p1_end
L_p1_compute:
    s_or_b32 s30, s2, s22
    s_cbranch_scc1 L_p1_notag
    s_memrealtime s[44:45]
    s_waitcnt lgkmcnt(0)
    s_mov_b32 s16, s40
    s_and_b32 s17, s41, 0xffff
    s_mov_b32 s18, 0x100
    s_mov_b32 s19, 0x00020000
    s_mul_i32 s44, s44, 0x9e3779b1
    s_or_b32 s44, s44, 1
    v_mov_b32 v18, 0
    v_mov_b32 v19, s44
    s_mov_b64 exec, 1
    buffer_store_dword v19, v18, s[16:19], 0 offen sc1
    s_mov_b32 s12, s42
    s_and_b32 s13, s43, 0xffff
    s_mov_b32 s14, 0x1428800
    s_mov_b32 s15, 0x00020000
    s_mov_b32 s30, 21135360
    buffer_store_dword v19, v18, s[12:15], s30 offen sc1
    s_mov_b64 exec, -1
L_p1_notag:
    s_cmp_lg_u32 s22, 1
    s_cbranch_scc1 L_p1_nocpf
    s_getpc_b64 s[8:9]
L_p1_pc0:
    s_add_u32 s8, s8, sequential_preLN__mha_block__mixer_channel_mlp__prompt_kernel-L_p1_pc0
    s_addc_u32 s9, s9, -1
    s_and_b32 s9, s9, 0xffff
    s_mov_b32 s10, L_code_end-sequential_preLN__mha_block__mixer_channel_mlp__prompt_kernel
    s_mov_b32 s11, 0x00020000
    s_lshr_b32 s30, s2, 3
    s_mul_i32 s30, s30, 1536
    v_lshlrev_b32 v18, 7, v1
    s_mov_b64 exec, 0xfff
    buffer_load_dword v14, v18, s[8:11], s30 offen
    s_mov_b64 exec, -1
L_p1_nocpf:
    s_cmp_ge_u32 s21, 15
    s_cbranch_scc1 L_p1_aux
    s_lshr_b32 s23, s22, 1
    s_and_b32 s24, s22, 1
    s_mov_b32 s34, 32768
    v_bfe_u32 v18, v2, 1, 3
    v_xor_b32 v18, v18, v3
    s_lshl_b32 s30, s23, 13
    v_lshl_add_u32 v19, v2, 7, s30
    v_xor_b32 v20, 0, v18
    v_lshl_add_u32 v24, v20, 4, v19
    v_xor_b32 v20, 2, v18
    v_lshl_add_u32 v25, v20, 4, v19
    v_xor_b32 v20, 4, v18
    v_lshl_add_u32 v26, v20, 4, v19
    v_xor_b32 v20, 6, v18
    v_lshl_add_u32 v27, v20, 4, v19
    v_bfe_u32 v18, v1, 2, 2
    v_lshl_add_u32 v19, v3, 3, v18
    v_lshlrev_b32 v19, 8, v19
    v_bfe_u32 v20, v1, 4, 1
    v_lshl_add_u32 v19, v20, 5, v19
    v_and_b32 v20, 3, v1
    v_lshl_add_u32 v19, v20, 3, v19
    v_add_u32 v19, 16384, v19
    s_lshl_b32 s30, s24, 1
    v_xor_b32 v20, s30, v18
    v_lshl_add_u32 v12, v20, 6, v19
    v_xor_b32 v13, 64, v12
    v_mov_b32 v96, 0
    v_mov_b32 v97, 0
    v_mov_b32 v98, 0
    v_mov_b32 v99, 0
    v_mov_b32 v100, 0
    v_mov_b32 v101, 0
    v_mov_b32 v102, 0
    v_mov_b32 v103, 0
    v_mov_b32 v104, 0
    v_mov_b32 v105, 0
    v_mov_b32 v106, 0
    v_mov_b32 v107, 0
    v_mov_b32 v108, 0
    v_mov_b32 v109, 0
    v_mov_b32 v110, 0
    v_mov_b32 v111, 0
    v_mov_b32 v112, 0
    v_mov_b32 v113, 0
    v_mov_b32 v114, 0
    v_mov_b32 v115, 0
    v_mov_b32 v116, 0
    v_mov_b32 v117, 0
    v_mov_b32 v118, 0
    v_mov_b32 v119, 0
    v_mov_b32 v120, 0
    v_mov_b32 v121, 0
    v_mov_b32 v122, 0
    v_mov_b32 v123, 0
    v_mov_b32 v124, 0
    v_mov_b32 v125, 0
    v_mov_b32 v126, 0
    v_mov_b32 v127, 0
    v_mov_b32 v128, 0
    v_mov_b32 v129, 0
    v_mov_b32 v130, 0
    v_mov_b32 v131, 0
    v_mov_b32 v132, 0
    v_mov_b32 v133, 0
    v_mov_b32 v134, 0
    v_mov_b32 v135, 0
    v_mov_b32 v136, 0
    v_mov_b32 v137, 0
    v_mov_b32 v138, 0
    v_mov_b32 v139, 0
    v_mov_b32 v140, 0
    v_mov_b32 v141, 0
    v_mov_b32 v142, 0
    v_mov_b32 v143, 0
    v_mov_b32 v144, 0
    v_mov_b32 v145, 0
    v_mov_b32 v146, 0
    v_mov_b32 v147, 0
    v_mov_b32 v148, 0
    v_mov_b32 v149, 0
    v_mov_b32 v150, 0
    v_mov_b32 v151, 0
    v_mov_b32 v152, 0
    v_mov_b32 v153, 0
    v_mov_b32 v154, 0
    v_mov_b32 v155, 0
    v_mov_b32 v156, 0
    v_mov_b32 v157, 0
    v_mov_b32 v158, 0
    v_mov_b32 v159, 0
    s_mov_b32 s28, 0
    s_mov_b32 s32, 0
    s_waitcnt lgkmcnt(0)
    s_mov_b32 s12, s42
    s_and_b32 s13, s43, 0xffff
    s_mov_b32 s14, 0x1428800
    s_mov_b32 s15, 0x00020000
    s_waitcnt lgkmcnt(0)
    s_barrier
    ds_read_b128 v[32:35], v24 offset:0
    ds_read_b64_tr_b16 v[40:41], v12 offset:0
    ds_read_b64_tr_b16 v[42:43], v12 offset:1024
    ds_read_b64_tr_b16 v[44:45], v13 offset:0
    ds_read_b64_tr_b16 v[46:47], v13 offset:1024
    ds_read_b128 v[36:39], v24 offset:4096
    ds_read_b128 v[48:51], v25 offset:0
    ds_read_b64_tr_b16 v[56:57], v12 offset:4096
    ds_read_b64_tr_b16 v[58:59], v12 offset:5120
    ds_read_b64_tr_b16 v[60:61], v13 offset:4096
    ds_read_b64_tr_b16 v[62:63], v13 offset:5120
    ds_read_b128 v[52:55], v25 offset:4096
    s_cmp_ge_u32 s21, 10
    s_cbranch_scc1 L_p1_loopv
L_p1_loopq:
    s_waitcnt lgkmcnt(6)
    v_mfma_f32_32x32x16_bf16 v[96:111], v[40:43], v[32:35], v[96:111]
    ds_read_b128 v[64:67], v26 offset:0
    ds_read_b64_tr_b16 v[72:73], v12 offset:8192
    v_mfma_f32_32x32x16_bf16 v[112:127], v[44:47], v[32:35], v[112:127]
    ds_read_b64_tr_b16 v[74:75], v12 offset:9216
    ds_read_b64_tr_b16 v[76:77], v13 offset:8192
    v_mfma_f32_32x32x16_bf16 v[128:143], v[40:43], v[36:39], v[128:143]
    ds_read_b64_tr_b16 v[78:79], v13 offset:9216
    ds_read_b128 v[68:71], v26 offset:4096
    v_mfma_f32_32x32x16_bf16 v[144:159], v[44:47], v[36:39], v[144:159]
    s_waitcnt lgkmcnt(6)
    v_mfma_f32_32x32x16_bf16 v[96:111], v[56:59], v[48:51], v[96:111]
    ds_read_b128 v[80:83], v27 offset:0
    ds_read_b64_tr_b16 v[88:89], v12 offset:12288
    v_mfma_f32_32x32x16_bf16 v[112:127], v[60:63], v[48:51], v[112:127]
    ds_read_b64_tr_b16 v[90:91], v12 offset:13312
    ds_read_b64_tr_b16 v[92:93], v13 offset:12288
    v_mfma_f32_32x32x16_bf16 v[128:143], v[56:59], v[52:55], v[128:143]
    ds_read_b64_tr_b16 v[94:95], v13 offset:13312
    ds_read_b128 v[84:87], v27 offset:4096
    v_mfma_f32_32x32x16_bf16 v[144:159], v[60:63], v[52:55], v[144:159]
    s_barrier
    s_waitcnt lgkmcnt(6)
    v_mfma_f32_32x32x16_bf16 v[96:111], v[72:75], v[64:67], v[96:111]
    s_add_u32 s32, s32, 1
    s_and_b32 s32, s32, 3
    s_cselect_b32 s29, s34, 0xfffe8000
    v_add_u32 v12, s29, v12
    v_add_u32 v13, s29, v13
    v_add_u32 v24, s29, v24
    ds_read_b128 v[32:35], v24 offset:0
    ds_read_b64_tr_b16 v[40:41], v12 offset:0
    v_mfma_f32_32x32x16_bf16 v[112:127], v[76:79], v[64:67], v[112:127]
    ds_read_b64_tr_b16 v[42:43], v12 offset:1024
    ds_read_b64_tr_b16 v[44:45], v13 offset:0
    v_mfma_f32_32x32x16_bf16 v[128:143], v[72:75], v[68:71], v[128:143]
    ds_read_b64_tr_b16 v[46:47], v13 offset:1024
    ds_read_b128 v[36:39], v24 offset:4096
    v_mfma_f32_32x32x16_bf16 v[144:159], v[76:79], v[68:71], v[144:159]
    s_waitcnt lgkmcnt(6)
    v_mfma_f32_32x32x16_bf16 v[96:111], v[88:91], v[80:83], v[96:111]
    v_add_u32 v25, s29, v25
    ds_read_b128 v[48:51], v25 offset:0
    ds_read_b64_tr_b16 v[56:57], v12 offset:4096
    v_mfma_f32_32x32x16_bf16 v[112:127], v[92:95], v[80:83], v[112:127]
    ds_read_b64_tr_b16 v[58:59], v12 offset:5120
    ds_read_b64_tr_b16 v[60:61], v13 offset:4096
    v_mfma_f32_32x32x16_bf16 v[128:143], v[88:91], v[84:87], v[128:143]
    ds_read_b64_tr_b16 v[62:63], v13 offset:5120
    ds_read_b128 v[52:55], v25 offset:4096
    v_add_u32 v26, s29, v26
    v_add_u32 v27, s29, v27
    s_add_u32 s28, s28, 1
    s_cmp_lt_u32 s28, 10
    v_mfma_f32_32x32x16_bf16 v[144:159], v[92:95], v[84:87], v[144:159]
    s_cbranch_scc1 L_p1_loopq
    s_lshl_b32 s30, s23, 8
    s_add_u32 s30, s30, 131072
    v_lshl_add_u32 v22, v2, 2, s30
    ds_read2_b32 v[28:29], v22 offset0:0 offset1:128
    ds_read2_b32 v[30:31], v22 offset0:32 offset1:160
    s_lshl_b32 s30, s24, 8
    s_add_u32 s30, s30, 131072
    v_lshl_add_u32 v18, v3, 4, s30
    ds_read_b128 v[160:163], v18 offset:1024
    ds_read_b128 v[164:167], v18 offset:1056
    ds_read_b128 v[168:171], v18 offset:1088
    ds_read_b128 v[172:175], v18 offset:1120
    ds_read_b128 v[176:179], v18 offset:1152
    ds_read_b128 v[180:183], v18 offset:1184
    ds_read_b128 v[184:187], v18 offset:1216
    ds_read_b128 v[188:191], v18 offset:1248
    s_lshl_b32 s30, s21, 4
    s_lshl_b32 s31, s24, 3
    s_add_u32 s30, s30, s31
    v_add_lshl_u32 v20, v3, s30, 15
    s_lshl_b32 s30, s20, 7
    s_lshl_b32 s31, s23, 6
    s_add_u32 s30, s30, s31
    v_add_u32 v21, s30, v2
    v_lshl_add_u32 v20, v21, 4, v20
    s_mov_b32 s46, 0
    s_mov_b32 s47, 65536
    s_mov_b32 s48, 131072
    s_mov_b32 s49, 196608
    s_waitcnt lgkmcnt(0)
    v_pk_fma_f32 v[96:97], v[160:161], v[28:29], v[96:97] op_sel_hi:[1,0,1]
    v_pk_fma_f32 v[98:99], v[162:163], v[28:29], v[98:99] op_sel_hi:[1,0,1]
    v_pk_fma_f32 v[100:101], v[164:165], v[28:29], v[100:101] op_sel_hi:[1,0,1]
    v_pk_fma_f32 v[102:103], v[166:167], v[28:29], v[102:103] op_sel_hi:[1,0,1]
    v_pk_fma_f32 v[104:105], v[168:169], v[28:29], v[104:105] op_sel_hi:[1,0,1]
    v_pk_fma_f32 v[106:107], v[170:171], v[28:29], v[106:107] op_sel_hi:[1,0,1]
    v_pk_fma_f32 v[108:109], v[172:173], v[28:29], v[108:109] op_sel_hi:[1,0,1]
    v_pk_fma_f32 v[110:111], v[174:175], v[28:29], v[110:111] op_sel_hi:[1,0,1]
    v_pk_mul_f32 v[96:97], v[96:97], v[28:29] op_sel:[0,1] op_sel_hi:[1,1]
    v_pk_mul_f32 v[98:99], v[98:99], v[28:29] op_sel:[0,1] op_sel_hi:[1,1]
    v_pk_mul_f32 v[100:101], v[100:101], v[28:29] op_sel:[0,1] op_sel_hi:[1,1]
    v_pk_mul_f32 v[102:103], v[102:103], v[28:29] op_sel:[0,1] op_sel_hi:[1,1]
    v_pk_mul_f32 v[104:105], v[104:105], v[28:29] op_sel:[0,1] op_sel_hi:[1,1]
    v_pk_mul_f32 v[106:107], v[106:107], v[28:29] op_sel:[0,1] op_sel_hi:[1,1]
    v_pk_mul_f32 v[108:109], v[108:109], v[28:29] op_sel:[0,1] op_sel_hi:[1,1]
    v_pk_mul_f32 v[110:111], v[110:111], v[28:29] op_sel:[0,1] op_sel_hi:[1,1]
    v_cvt_pk_bf16_f32 v240, v96, v97
    v_cvt_pk_bf16_f32 v241, v98, v99
    v_cvt_pk_bf16_f32 v242, v100, v101
    v_cvt_pk_bf16_f32 v243, v102, v103
    v_cvt_pk_bf16_f32 v244, v104, v105
    v_cvt_pk_bf16_f32 v245, v106, v107
    v_cvt_pk_bf16_f32 v246, v108, v109
    v_cvt_pk_bf16_f32 v247, v110, v111
    v_permlane32_swap_b32 v240, v242
    v_permlane32_swap_b32 v241, v243
    v_permlane32_swap_b32 v244, v246
    v_permlane32_swap_b32 v245, v247
    buffer_store_dwordx4 v[240:243], v20, s[12:15], s46 offen offset:0 sc1
    buffer_store_dwordx4 v[244:247], v20, s[12:15], s47 offen offset:0 sc1
    v_pk_fma_f32 v[128:129], v[160:161], v[30:31], v[128:129] op_sel_hi:[1,0,1]
    v_pk_fma_f32 v[130:131], v[162:163], v[30:31], v[130:131] op_sel_hi:[1,0,1]
    v_pk_fma_f32 v[132:133], v[164:165], v[30:31], v[132:133] op_sel_hi:[1,0,1]
    v_pk_fma_f32 v[134:135], v[166:167], v[30:31], v[134:135] op_sel_hi:[1,0,1]
    v_pk_fma_f32 v[136:137], v[168:169], v[30:31], v[136:137] op_sel_hi:[1,0,1]
    v_pk_fma_f32 v[138:139], v[170:171], v[30:31], v[138:139] op_sel_hi:[1,0,1]
    v_pk_fma_f32 v[140:141], v[172:173], v[30:31], v[140:141] op_sel_hi:[1,0,1]
    v_pk_fma_f32 v[142:143], v[174:175], v[30:31], v[142:143] op_sel_hi:[1,0,1]
    v_pk_mul_f32 v[128:129], v[128:129], v[30:31] op_sel:[0,1] op_sel_hi:[1,1]
    v_pk_mul_f32 v[130:131], v[130:131], v[30:31] op_sel:[0,1] op_sel_hi:[1,1]
    v_pk_mul_f32 v[132:133], v[132:133], v[30:31] op_sel:[0,1] op_sel_hi:[1,1]
    v_pk_mul_f32 v[134:135], v[134:135], v[30:31] op_sel:[0,1] op_sel_hi:[1,1]
    v_pk_mul_f32 v[136:137], v[136:137], v[30:31] op_sel:[0,1] op_sel_hi:[1,1]
    v_pk_mul_f32 v[138:139], v[138:139], v[30:31] op_sel:[0,1] op_sel_hi:[1,1]
    v_pk_mul_f32 v[140:141], v[140:141], v[30:31] op_sel:[0,1] op_sel_hi:[1,1]
    v_pk_mul_f32 v[142:143], v[142:143], v[30:31] op_sel:[0,1] op_sel_hi:[1,1]
    v_cvt_pk_bf16_f32 v248, v128, v129
    v_cvt_pk_bf16_f32 v249, v130, v131
    v_cvt_pk_bf16_f32 v250, v132, v133
    v_cvt_pk_bf16_f32 v251, v134, v135
    v_cvt_pk_bf16_f32 v252, v136, v137
    v_cvt_pk_bf16_f32 v253, v138, v139
    v_cvt_pk_bf16_f32 v254, v140, v141
    v_cvt_pk_bf16_f32 v255, v142, v143
    v_permlane32_swap_b32 v248, v250
    v_permlane32_swap_b32 v249, v251
    v_permlane32_swap_b32 v252, v254
    v_permlane32_swap_b32 v253, v255
    buffer_store_dwordx4 v[248:251], v20, s[12:15], s46 offen offset:512 sc1
    buffer_store_dwordx4 v[252:255], v20, s[12:15], s47 offen offset:512 sc1
    v_pk_fma_f32 v[112:113], v[176:177], v[28:29], v[112:113] op_sel_hi:[1,0,1]
    v_pk_fma_f32 v[114:115], v[178:179], v[28:29], v[114:115] op_sel_hi:[1,0,1]
    v_pk_fma_f32 v[116:117], v[180:181], v[28:29], v[116:117] op_sel_hi:[1,0,1]
    v_pk_fma_f32 v[118:119], v[182:183], v[28:29], v[118:119] op_sel_hi:[1,0,1]
    v_pk_fma_f32 v[120:121], v[184:185], v[28:29], v[120:121] op_sel_hi:[1,0,1]
    v_pk_fma_f32 v[122:123], v[186:187], v[28:29], v[122:123] op_sel_hi:[1,0,1]
    v_pk_fma_f32 v[124:125], v[188:189], v[28:29], v[124:125] op_sel_hi:[1,0,1]
    v_pk_fma_f32 v[126:127], v[190:191], v[28:29], v[126:127] op_sel_hi:[1,0,1]
    v_pk_mul_f32 v[112:113], v[112:113], v[28:29] op_sel:[0,1] op_sel_hi:[1,1]
    v_pk_mul_f32 v[114:115], v[114:115], v[28:29] op_sel:[0,1] op_sel_hi:[1,1]
    v_pk_mul_f32 v[116:117], v[116:117], v[28:29] op_sel:[0,1] op_sel_hi:[1,1]
    v_pk_mul_f32 v[118:119], v[118:119], v[28:29] op_sel:[0,1] op_sel_hi:[1,1]
    v_pk_mul_f32 v[120:121], v[120:121], v[28:29] op_sel:[0,1] op_sel_hi:[1,1]
    v_pk_mul_f32 v[122:123], v[122:123], v[28:29] op_sel:[0,1] op_sel_hi:[1,1]
    v_pk_mul_f32 v[124:125], v[124:125], v[28:29] op_sel:[0,1] op_sel_hi:[1,1]
    v_pk_mul_f32 v[126:127], v[126:127], v[28:29] op_sel:[0,1] op_sel_hi:[1,1]
    v_cvt_pk_bf16_f32 v240, v112, v113
    v_cvt_pk_bf16_f32 v241, v114, v115
    v_cvt_pk_bf16_f32 v242, v116, v117
    v_cvt_pk_bf16_f32 v243, v118, v119
    v_cvt_pk_bf16_f32 v244, v120, v121
    v_cvt_pk_bf16_f32 v245, v122, v123
    v_cvt_pk_bf16_f32 v246, v124, v125
    v_cvt_pk_bf16_f32 v247, v126, v127
    v_permlane32_swap_b32 v240, v242
    v_permlane32_swap_b32 v241, v243
    v_permlane32_swap_b32 v244, v246
    v_permlane32_swap_b32 v245, v247
    buffer_store_dwordx4 v[240:243], v20, s[12:15], s48 offen offset:0 sc1
    buffer_store_dwordx4 v[244:247], v20, s[12:15], s49 offen offset:0 sc1
    v_pk_fma_f32 v[144:145], v[176:177], v[30:31], v[144:145] op_sel_hi:[1,0,1]
    v_pk_fma_f32 v[146:147], v[178:179], v[30:31], v[146:147] op_sel_hi:[1,0,1]
    v_pk_fma_f32 v[148:149], v[180:181], v[30:31], v[148:149] op_sel_hi:[1,0,1]
    v_pk_fma_f32 v[150:151], v[182:183], v[30:31], v[150:151] op_sel_hi:[1,0,1]
    v_pk_fma_f32 v[152:153], v[184:185], v[30:31], v[152:153] op_sel_hi:[1,0,1]
    v_pk_fma_f32 v[154:155], v[186:187], v[30:31], v[154:155] op_sel_hi:[1,0,1]
    v_pk_fma_f32 v[156:157], v[188:189], v[30:31], v[156:157] op_sel_hi:[1,0,1]
    v_pk_fma_f32 v[158:159], v[190:191], v[30:31], v[158:159] op_sel_hi:[1,0,1]
    v_pk_mul_f32 v[144:145], v[144:145], v[30:31] op_sel:[0,1] op_sel_hi:[1,1]
    v_pk_mul_f32 v[146:147], v[146:147], v[30:31] op_sel:[0,1] op_sel_hi:[1,1]
    v_pk_mul_f32 v[148:149], v[148:149], v[30:31] op_sel:[0,1] op_sel_hi:[1,1]
    v_pk_mul_f32 v[150:151], v[150:151], v[30:31] op_sel:[0,1] op_sel_hi:[1,1]
    v_pk_mul_f32 v[152:153], v[152:153], v[30:31] op_sel:[0,1] op_sel_hi:[1,1]
    v_pk_mul_f32 v[154:155], v[154:155], v[30:31] op_sel:[0,1] op_sel_hi:[1,1]
    v_pk_mul_f32 v[156:157], v[156:157], v[30:31] op_sel:[0,1] op_sel_hi:[1,1]
    v_pk_mul_f32 v[158:159], v[158:159], v[30:31] op_sel:[0,1] op_sel_hi:[1,1]
    v_cvt_pk_bf16_f32 v248, v144, v145
    v_cvt_pk_bf16_f32 v249, v146, v147
    v_cvt_pk_bf16_f32 v250, v148, v149
    v_cvt_pk_bf16_f32 v251, v150, v151
    v_cvt_pk_bf16_f32 v252, v152, v153
    v_cvt_pk_bf16_f32 v253, v154, v155
    v_cvt_pk_bf16_f32 v254, v156, v157
    v_cvt_pk_bf16_f32 v255, v158, v159
    v_permlane32_swap_b32 v248, v250
    v_permlane32_swap_b32 v249, v251
    v_permlane32_swap_b32 v252, v254
    v_permlane32_swap_b32 v253, v255
    buffer_store_dwordx4 v[248:251], v20, s[12:15], s48 offen offset:512 sc1
    buffer_store_dwordx4 v[252:255], v20, s[12:15], s49 offen offset:512 sc1
    s_branch L_p1_end
L_p1_loopv:
    s_waitcnt lgkmcnt(6)
    v_mfma_f32_32x32x16_bf16 v[96:111], v[32:35], v[40:43], v[96:111]
    ds_read_b128 v[64:67], v26 offset:0
    ds_read_b64_tr_b16 v[72:73], v12 offset:8192
    v_mfma_f32_32x32x16_bf16 v[112:127], v[32:35], v[44:47], v[112:127]
    ds_read_b64_tr_b16 v[74:75], v12 offset:9216
    ds_read_b64_tr_b16 v[76:77], v13 offset:8192
    v_mfma_f32_32x32x16_bf16 v[128:143], v[36:39], v[40:43], v[128:143]
    ds_read_b64_tr_b16 v[78:79], v13 offset:9216
    ds_read_b128 v[68:71], v26 offset:4096
    v_mfma_f32_32x32x16_bf16 v[144:159], v[36:39], v[44:47], v[144:159]
    s_waitcnt lgkmcnt(6)
    v_mfma_f32_32x32x16_bf16 v[96:111], v[48:51], v[56:59], v[96:111]
    ds_read_b128 v[80:83], v27 offset:0
    ds_read_b64_tr_b16 v[88:89], v12 offset:12288
    v_mfma_f32_32x32x16_bf16 v[112:127], v[48:51], v[60:63], v[112:127]
    ds_read_b64_tr_b16 v[90:91], v12 offset:13312
    ds_read_b64_tr_b16 v[92:93], v13 offset:12288
    v_mfma_f32_32x32x16_bf16 v[128:143], v[52:55], v[56:59], v[128:143]
    ds_read_b64_tr_b16 v[94:95], v13 offset:13312
    ds_read_b128 v[84:87], v27 offset:4096
    v_mfma_f32_32x32x16_bf16 v[144:159], v[52:55], v[60:63], v[144:159]
    s_barrier
    s_waitcnt lgkmcnt(6)
    v_mfma_f32_32x32x16_bf16 v[96:111], v[64:67], v[72:75], v[96:111]
    s_add_u32 s32, s32, 1
    s_and_b32 s32, s32, 3
    s_cselect_b32 s29, s34, 0xfffe8000
    v_add_u32 v12, s29, v12
    v_add_u32 v13, s29, v13
    v_add_u32 v24, s29, v24
    ds_read_b128 v[32:35], v24 offset:0
    ds_read_b64_tr_b16 v[40:41], v12 offset:0
    v_mfma_f32_32x32x16_bf16 v[112:127], v[64:67], v[76:79], v[112:127]
    ds_read_b64_tr_b16 v[42:43], v12 offset:1024
    ds_read_b64_tr_b16 v[44:45], v13 offset:0
    v_mfma_f32_32x32x16_bf16 v[128:143], v[68:71], v[72:75], v[128:143]
    ds_read_b64_tr_b16 v[46:47], v13 offset:1024
    ds_read_b128 v[36:39], v24 offset:4096
    v_mfma_f32_32x32x16_bf16 v[144:159], v[68:71], v[76:79], v[144:159]
    s_waitcnt lgkmcnt(6)
    v_mfma_f32_32x32x16_bf16 v[96:111], v[80:83], v[88:91], v[96:111]
    v_add_u32 v25, s29, v25
    ds_read_b128 v[48:51], v25 offset:0
    ds_read_b64_tr_b16 v[56:57], v12 offset:4096
    v_mfma_f32_32x32x16_bf16 v[112:127], v[80:83], v[92:95], v[112:127]
    ds_read_b64_tr_b16 v[58:59], v12 offset:5120
    ds_read_b64_tr_b16 v[60:61], v13 offset:4096
    v_mfma_f32_32x32x16_bf16 v[128:143], v[84:87], v[88:91], v[128:143]
    ds_read_b64_tr_b16 v[62:63], v13 offset:5120
    ds_read_b128 v[52:55], v25 offset:4096
    v_add_u32 v26, s29, v26
    v_add_u32 v27, s29, v27
    s_add_u32 s28, s28, 1
    s_cmp_lt_u32 s28, 10
    v_mfma_f32_32x32x16_bf16 v[144:159], v[84:87], v[92:95], v[144:159]
    s_cbranch_scc1 L_p1_loopv
    s_lshl_b32 s30, s23, 8
    s_add_u32 s30, s30, 131072
    v_lshl_add_u32 v18, v3, 4, s30
    s_lshl_b32 s30, s24, 8
    s_add_u32 s30, s30, 131072
    v_lshl_add_u32 v19, v2, 2, s30
    ds_read_b32 v28, v19 offset:1024
    ds_read_b32 v30, v19 offset:1152
    ds_read_b128 v[160:163], v18 offset:0
    ds_read_b128 v[192:195], v18 offset:512
    ds_read_b128 v[164:167], v18 offset:32
    ds_read_b128 v[196:199], v18 offset:544
    ds_read_b128 v[168:171], v18 offset:64
    ds_read_b128 v[200:203], v18 offset:576
    ds_read_b128 v[172:175], v18 offset:96
    ds_read_b128 v[204:207], v18 offset:608
    ds_read_b128 v[176:179], v18 offset:128
    ds_read_b128 v[208:211], v18 offset:640
    ds_read_b128 v[180:183], v18 offset:160
    ds_read_b128 v[212:215], v18 offset:672
    ds_read_b128 v[184:187], v18 offset:192
    ds_read_b128 v[216:219], v18 offset:704
    ds_read_b128 v[188:191], v18 offset:224
    ds_read_b128 v[220:223], v18 offset:736
    s_lshl_b32 s30, s20, 1
    s_add_u32 s30, s30, s23
    s_mul_i32 s30, s30, 5120
    s_lshl_b32 s31, s21, 7
    s_add_u32 s30, s30, s31
    s_sub_u32 s30, s30, 1280
    s_lshl_b32 s31, s24, 6
    s_add_u32 s30, s30, s31
    v_mul_u32_u24 v21, 640, v3
    v_add3_u32 v20, v2, s30, v21
    v_lshlrev_b32 v20, 4, v20
    s_mov_b32 s46, 5242880
    s_mov_b32 s47, 5263360
    s_mov_b32 s48, 5283840
    s_mov_b32 s49, 5304320
    s_waitcnt lgkmcnt(0)
    v_pk_fma_f32 v[96:97], v[160:161], v[28:29], v[96:97] op_sel_hi:[1,0,1]
    v_pk_fma_f32 v[98:99], v[162:163], v[28:29], v[98:99] op_sel_hi:[1,0,1]
    v_pk_fma_f32 v[100:101], v[164:165], v[28:29], v[100:101] op_sel_hi:[1,0,1]
    v_pk_fma_f32 v[102:103], v[166:167], v[28:29], v[102:103] op_sel_hi:[1,0,1]
    v_pk_fma_f32 v[104:105], v[168:169], v[28:29], v[104:105] op_sel_hi:[1,0,1]
    v_pk_fma_f32 v[106:107], v[170:171], v[28:29], v[106:107] op_sel_hi:[1,0,1]
    v_pk_fma_f32 v[108:109], v[172:173], v[28:29], v[108:109] op_sel_hi:[1,0,1]
    v_pk_fma_f32 v[110:111], v[174:175], v[28:29], v[110:111] op_sel_hi:[1,0,1]
    v_pk_mul_f32 v[96:97], v[96:97], v[192:193]
    v_pk_mul_f32 v[98:99], v[98:99], v[194:195]
    v_pk_mul_f32 v[100:101], v[100:101], v[196:197]
    v_pk_mul_f32 v[102:103], v[102:103], v[198:199]
    v_pk_mul_f32 v[104:105], v[104:105], v[200:201]
    v_pk_mul_f32 v[106:107], v[106:107], v[202:203]
    v_pk_mul_f32 v[108:109], v[108:109], v[204:205]
    v_pk_mul_f32 v[110:111], v[110:111], v[206:207]
    v_cvt_pk_bf16_f32 v224, v96, v97
    v_cvt_pk_bf16_f32 v225, v98, v99
    v_cvt_pk_bf16_f32 v226, v100, v101
    v_cvt_pk_bf16_f32 v227, v102, v103
    v_cvt_pk_bf16_f32 v228, v104, v105
    v_cvt_pk_bf16_f32 v229, v106, v107
    v_cvt_pk_bf16_f32 v230, v108, v109
    v_cvt_pk_bf16_f32 v231, v110, v111
    buffer_store_dwordx4 v[224:227], v20, s[12:15], s46 offen offset:0 sc1
    buffer_store_dwordx4 v[228:231], v20, s[12:15], s47 offen offset:0 sc1
    v_pk_fma_f32 v[112:113], v[160:161], v[30:31], v[112:113] op_sel_hi:[1,0,1]
    v_pk_fma_f32 v[114:115], v[162:163], v[30:31], v[114:115] op_sel_hi:[1,0,1]
    v_pk_fma_f32 v[116:117], v[164:165], v[30:31], v[116:117] op_sel_hi:[1,0,1]
    v_pk_fma_f32 v[118:119], v[166:167], v[30:31], v[118:119] op_sel_hi:[1,0,1]
    v_pk_fma_f32 v[120:121], v[168:169], v[30:31], v[120:121] op_sel_hi:[1,0,1]
    v_pk_fma_f32 v[122:123], v[170:171], v[30:31], v[122:123] op_sel_hi:[1,0,1]
    v_pk_fma_f32 v[124:125], v[172:173], v[30:31], v[124:125] op_sel_hi:[1,0,1]
    v_pk_fma_f32 v[126:127], v[174:175], v[30:31], v[126:127] op_sel_hi:[1,0,1]
    v_pk_mul_f32 v[112:113], v[112:113], v[192:193]
    v_pk_mul_f32 v[114:115], v[114:115], v[194:195]
    v_pk_mul_f32 v[116:117], v[116:117], v[196:197]
    v_pk_mul_f32 v[118:119], v[118:119], v[198:199]
    v_pk_mul_f32 v[120:121], v[120:121], v[200:201]
    v_pk_mul_f32 v[122:123], v[122:123], v[202:203]
    v_pk_mul_f32 v[124:125], v[124:125], v[204:205]
    v_pk_mul_f32 v[126:127], v[126:127], v[206:207]
    v_cvt_pk_bf16_f32 v232, v112, v113
    v_cvt_pk_bf16_f32 v233, v114, v115
    v_cvt_pk_bf16_f32 v234, v116, v117
    v_cvt_pk_bf16_f32 v235, v118, v119
    v_cvt_pk_bf16_f32 v236, v120, v121
    v_cvt_pk_bf16_f32 v237, v122, v123
    v_cvt_pk_bf16_f32 v238, v124, v125
    v_cvt_pk_bf16_f32 v239, v126, v127
    buffer_store_dwordx4 v[232:235], v20, s[12:15], s46 offen offset:512 sc1
    buffer_store_dwordx4 v[236:239], v20, s[12:15], s47 offen offset:512 sc1
    v_pk_fma_f32 v[128:129], v[176:177], v[28:29], v[128:129] op_sel_hi:[1,0,1]
    v_pk_fma_f32 v[130:131], v[178:179], v[28:29], v[130:131] op_sel_hi:[1,0,1]
    v_pk_fma_f32 v[132:133], v[180:181], v[28:29], v[132:133] op_sel_hi:[1,0,1]
    v_pk_fma_f32 v[134:135], v[182:183], v[28:29], v[134:135] op_sel_hi:[1,0,1]
    v_pk_fma_f32 v[136:137], v[184:185], v[28:29], v[136:137] op_sel_hi:[1,0,1]
    v_pk_fma_f32 v[138:139], v[186:187], v[28:29], v[138:139] op_sel_hi:[1,0,1]
    v_pk_fma_f32 v[140:141], v[188:189], v[28:29], v[140:141] op_sel_hi:[1,0,1]
    v_pk_fma_f32 v[142:143], v[190:191], v[28:29], v[142:143] op_sel_hi:[1,0,1]
    v_pk_mul_f32 v[128:129], v[128:129], v[208:209]
    v_pk_mul_f32 v[130:131], v[130:131], v[210:211]
    v_pk_mul_f32 v[132:133], v[132:133], v[212:213]
    v_pk_mul_f32 v[134:135], v[134:135], v[214:215]
    v_pk_mul_f32 v[136:137], v[136:137], v[216:217]
    v_pk_mul_f32 v[138:139], v[138:139], v[218:219]
    v_pk_mul_f32 v[140:141], v[140:141], v[220:221]
    v_pk_mul_f32 v[142:143], v[142:143], v[222:223]
    v_cvt_pk_bf16_f32 v224, v128, v129
    v_cvt_pk_bf16_f32 v225, v130, v131
    v_cvt_pk_bf16_f32 v226, v132, v133
    v_cvt_pk_bf16_f32 v227, v134, v135
    v_cvt_pk_bf16_f32 v228, v136, v137
    v_cvt_pk_bf16_f32 v229, v138, v139
    v_cvt_pk_bf16_f32 v230, v140, v141
    v_cvt_pk_bf16_f32 v231, v142, v143
    buffer_store_dwordx4 v[224:227], v20, s[12:15], s48 offen offset:0 sc1
    buffer_store_dwordx4 v[228:231], v20, s[12:15], s49 offen offset:0 sc1
    v_pk_fma_f32 v[144:145], v[176:177], v[30:31], v[144:145] op_sel_hi:[1,0,1]
    v_pk_fma_f32 v[146:147], v[178:179], v[30:31], v[146:147] op_sel_hi:[1,0,1]
    v_pk_fma_f32 v[148:149], v[180:181], v[30:31], v[148:149] op_sel_hi:[1,0,1]
    v_pk_fma_f32 v[150:151], v[182:183], v[30:31], v[150:151] op_sel_hi:[1,0,1]
    v_pk_fma_f32 v[152:153], v[184:185], v[30:31], v[152:153] op_sel_hi:[1,0,1]
    v_pk_fma_f32 v[154:155], v[186:187], v[30:31], v[154:155] op_sel_hi:[1,0,1]
    v_pk_fma_f32 v[156:157], v[188:189], v[30:31], v[156:157] op_sel_hi:[1,0,1]
    v_pk_fma_f32 v[158:159], v[190:191], v[30:31], v[158:159] op_sel_hi:[1,0,1]
    v_pk_mul_f32 v[144:145], v[144:145], v[208:209]
    v_pk_mul_f32 v[146:147], v[146:147], v[210:211]
    v_pk_mul_f32 v[148:149], v[148:149], v[212:213]
    v_pk_mul_f32 v[150:151], v[150:151], v[214:215]
    v_pk_mul_f32 v[152:153], v[152:153], v[216:217]
    v_pk_mul_f32 v[154:155], v[154:155], v[218:219]
    v_pk_mul_f32 v[156:157], v[156:157], v[220:221]
    v_pk_mul_f32 v[158:159], v[158:159], v[222:223]
    v_cvt_pk_bf16_f32 v232, v144, v145
    v_cvt_pk_bf16_f32 v233, v146, v147
    v_cvt_pk_bf16_f32 v234, v148, v149
    v_cvt_pk_bf16_f32 v235, v150, v151
    v_cvt_pk_bf16_f32 v236, v152, v153
    v_cvt_pk_bf16_f32 v237, v154, v155
    v_cvt_pk_bf16_f32 v238, v156, v157
    v_cvt_pk_bf16_f32 v239, v158, v159
    buffer_store_dwordx4 v[232:235], v20, s[12:15], s48 offen offset:512 sc1
    buffer_store_dwordx4 v[236:239], v20, s[12:15], s49 offen offset:512 sc1
    s_branch L_p1_end
L_p1_auxl:
    s_cmp_ge_u32 s22, 2
    s_cbranch_scc1 L_p1_aux
    v_lshrrev_b32 v22, 4, v1
    v_and_b32 v23, 15, v1
    v_mul_u32_u24 v22, 1280, v22
    v_lshl_add_u32 v22, v23, 4, v22
    s_lshl_b32 s30, s20, 5
    s_lshl_b32 s31, s21, 1
    s_add_u32 s30, s30, s31
    s_add_u32 s29, s30, s22
    s_mul_i32 s30, s29, 5120
    s_waitcnt lgkmcnt(0)
    s_mov_b32 s4, s36
    s_and_b32 s5, s37, 0xffff
    s_mov_b32 s6, 0x280000
    s_mov_b32 s7, 0x00020000
    s_mov_b32 s12, s42
    s_and_b32 s13, s43, 0xffff
    s_mov_b32 s14, 0x1428800
    s_mov_b32 s15, 0x00020000
    s_mov_b32 s16, s40
    s_and_b32 s17, s41, 0xffff
    s_mov_b32 s18, 0x100
    s_mov_b32 s19, 0x00020000
    buffer_load_dwordx4 v[32:35], v22, s[4:7], s30 offen offset:0
    buffer_load_dwordx4 v[36:39], v22, s[4:7], s30 offen offset:256
    buffer_load_dwordx4 v[40:43], v22, s[4:7], s30 offen offset:512
    buffer_load_dwordx4 v[44:47], v22, s[4:7], s30 offen offset:768
    buffer_load_dwordx4 v[48:51], v22, s[4:7], s30 offen offset:1024
    s_waitcnt vmcnt(0)
    v_mov_b32 v15, 0
    buffer_load_dword v16, v15, s[16:19], 0 offen sc1
    v_mov_b32 v56, 0
    v_mov_b32 v57, 0
    v_mov_b32 v58, 0
    v_mov_b32 v59, 0
    v_lshlrev_b32 v52, 16, v32
    v_and_b32 v53, 0xffff0000, v32
    v_add_f32 v56, v56, v52
    v_fmac_f32 v57, v52, v52
    v_add_f32 v58, v58, v53
    v_fmac_f32 v59, v53, v53
    v_lshlrev_b32 v52, 16, v33
    v_and_b32 v53, 0xffff0000, v33
    v_add_f32 v56, v56, v52
    v_fmac_f32 v57, v52, v52
    v_add_f32 v58, v58, v53
    v_fmac_f32 v59, v53, v53
    v_lshlrev_b32 v52, 16, v34
    v_and_b32 v53, 0xffff0000, v34
    v_add_f32 v56, v56, v52
    v_fmac_f32 v57, v52, v52
    v_add_f32 v58, v58, v53
    v_fmac_f32 v59, v53, v53
    v_lshlrev_b32 v52, 16, v35
    v_and_b32 v53, 0xffff0000, v35
    v_add_f32 v56, v56, v52
    v_fmac_f32 v57, v52, v52
    v_add_f32 v58, v58, v53
    v_fmac_f32 v59, v53, v53
    v_lshlrev_b32 v52, 16, v36
    v_and_b32 v53, 0xffff0000, v36
    v_add_f32 v56, v56, v52
    v_fmac_f32 v57, v52, v52
    v_add_f32 v58, v58, v53
    v_fmac_f32 v59, v53, v53
    v_lshlrev_b32 v52, 16, v37
    v_and_b32 v53, 0xffff0000, v37
    v_add_f32 v56, v56, v52
    v_fmac_f32 v57, v52, v52
    v_add_f32 v58, v58, v53
    v_fmac_f32 v59, v53, v53
    v_lshlrev_b32 v52, 16, v38
    v_and_b32 v53, 0xffff0000, v38
    v_add_f32 v56, v56, v52
    v_fmac_f32 v57, v52, v52
    v_add_f32 v58, v58, v53
    v_fmac_f32 v59, v53, v53
    v_lshlrev_b32 v52, 16, v39
    v_and_b32 v53, 0xffff0000, v39
    v_add_f32 v56, v56, v52
    v_fmac_f32 v57, v52, v52
    v_add_f32 v58, v58, v53
    v_fmac_f32 v59, v53, v53
    v_lshlrev_b32 v52, 16, v40
    v_and_b32 v53, 0xffff0000, v40
    v_add_f32 v56, v56, v52
    v_fmac_f32 v57, v52, v52
    v_add_f32 v58, v58, v53
    v_fmac_f32 v59, v53, v53
    v_lshlrev_b32 v52, 16, v41
    v_and_b32 v53, 0xffff0000, v41
    v_add_f32 v56, v56, v52
    v_fmac_f32 v57, v52, v52
    v_add_f32 v58, v58, v53
    v_fmac_f32 v59, v53, v53
    v_lshlrev_b32 v52, 16, v42
    v_and_b32 v53, 0xffff0000, v42
    v_add_f32 v56, v56, v52
    v_fmac_f32 v57, v52, v52
    v_add_f32 v58, v58, v53
    v_fmac_f32 v59, v53, v53
    v_lshlrev_b32 v52, 16, v43
    v_and_b32 v53, 0xffff0000, v43
    v_add_f32 v56, v56, v52
    v_fmac_f32 v57, v52, v52
    v_add_f32 v58, v58, v53
    v_fmac_f32 v59, v53, v53
    v_lshlrev_b32 v52, 16, v44
    v_and_b32 v53, 0xffff0000, v44
    v_add_f32 v56, v56, v52
    v_fmac_f32 v57, v52, v52
    v_add_f32 v58, v58, v53
    v_fmac_f32 v59, v53, v53
    s_waitcnt vmcnt(0)
    s_mov_b32 s28, 0
L_p1_twx:
    v_cmp_eq_u32 vcc, 0, v16
    s_nop 1
    s_cbranch_vccz L_p1_trx
    s_sleep 2
    buffer_load_dword v16, v15, s[16:19], 0 offen sc1
    s_add_u32 s28, s28, 1
    s_waitcnt vmcnt(0)
    s_cmp_lt_u32 s28, 0x4000
    s_cbranch_scc1 L_p1_twx
L_p1_trx:
    v_lshlrev_b32 v52, 16, v45
    v_and_b32 v53, 0xffff0000, v45
    v_add_f32 v56, v56, v52
    v_fmac_f32 v57, v52, v52
    v_add_f32 v58, v58, v53
    v_fmac_f32 v59, v53, v53
    v_lshlrev_b32 v52, 16, v46
    v_and_b32 v53, 0xffff0000, v46
    v_add_f32 v56, v56, v52
    v_fmac_f32 v57, v52, v52
    v_add_f32 v58, v58, v53
    v_fmac_f32 v59, v53, v53
    v_lshlrev_b32 v52, 16, v47
    v_and_b32 v53, 0xffff0000, v47
    v_add_f32 v56, v56, v52
    v_fmac_f32 v57, v52, v52
    v_add_f32 v58, v58, v53
    v_fmac_f32 v59, v53, v53
    v_lshlrev_b32 v52, 16, v48
    v_and_b32 v53, 0xffff0000, v48
    v_add_f32 v56, v56, v52
    v_fmac_f32 v57, v52, v52
    v_add_f32 v58, v58, v53
    v_fmac_f32 v59, v53, v53
    v_lshlrev_b32 v52, 16, v49
    v_and_b32 v53, 0xffff0000, v49
    v_add_f32 v56, v56, v52
    v_fmac_f32 v57, v52, v52
    v_add_f32 v58, v58, v53
    v_fmac_f32 v59, v53, v53
    v_lshlrev_b32 v52, 16, v50
    v_and_b32 v53, 0xffff0000, v50
    v_add_f32 v56, v56, v52
    v_fmac_f32 v57, v52, v52
    v_add_f32 v58, v58, v53
    v_fmac_f32 v59, v53, v53
    v_lshlrev_b32 v52, 16, v51
    v_and_b32 v53, 0xffff0000, v51
    v_add_f32 v56, v56, v52
    v_fmac_f32 v57, v52, v52
    v_add_f32 v58, v58, v53
    v_fmac_f32 v59, v53, v53
    v_add_f32 v56, v56, v58
    v_add_f32 v57, v57, v59
    s_nop 0
    v_add_f32_dpp v56, v56, v56 row_ror:8 row_mask:0xf bank_mask:0xf
    v_add_f32_dpp v57, v57, v57 row_ror:8 row_mask:0xf bank_mask:0xf
    s_nop 0
    v_add_f32_dpp v56, v56, v56 row_ror:4 row_mask:0xf bank_mask:0xf
    v_add_f32_dpp v57, v57, v57 row_ror:4 row_mask:0xf bank_mask:0xf
    s_nop 0
    v_add_f32_dpp v56, v56, v56 row_ror:2 row_mask:0xf bank_mask:0xf
    v_add_f32_dpp v57, v57, v57 row_ror:2 row_mask:0xf bank_mask:0xf
    s_nop 0
    v_add_f32_dpp v56, v56, v56 row_ror:1 row_mask:0xf bank_mask:0xf
    v_add_f32_dpp v57, v57, v57 row_ror:1 row_mask:0xf bank_mask:0xf
    v_mul_f32 v60, 0xbacccccd, v56
    v_mul_f32 v57, 0x3acccccd, v57
    v_fma_f32 v57, -v60, v60, v57
    v_max_f32 v57, 0, v57
    v_add_f32 v52, 0x3727c5ac, v57
    v_rsq_f32 v62, v52
    v_mov_b32 v61, v16
    v_mov_b32 v63, v16
    s_lshl_b32 s30, s29, 6
    s_add_u32 s30, s30, 20414464
    s_mov_b32 exec_lo, 0x00010001
    s_mov_b32 exec_hi, 0x00010001
    buffer_store_dwordx4 v[60:63], v1, s[12:15], s30 offen sc1
    s_mov_b64 exec, -1
L_p1_aux:
    s_load_dwordx4 s[44:47], s[0:1], 32
    v_lshrrev_b32 v18, 4, v1
    v_and_b32 v19, 15, v1
    v_mul_u32_u24 v20, 3456, v18
    v_lshl_add_u32 v20, v19, 4, v20
    v_lshlrev_b32 v21, 1, v0
    s_waitcnt lgkmcnt(0)
    s_mov_b32 s12, s42
    s_and_b32 s13, s43, 0xffff
    s_mov_b32 s14, 0x1428800
    s_mov_b32 s15, 0x00020000
    s_cmp_ge_u32 s20, 14
    s_cbranch_scc1 L_p1_end
    s_mov_b32 s8, s44
    s_and_b32 s9, s45, 0xffff
    s_mov_b32 s10, 0x21c000
    s_mov_b32 s11, 0x00020000
    s_mov_b32 s4, s46
    s_and_b32 s5, s47, 0xffff
    s_mov_b32 s6, 0xd80
    s_mov_b32 s7, 0x00020000
    s_mul_i32 s30, s89, 276480
    s_lshl_b32 s31, s20, 8
    s_add_u32 s30, s30, s31
    buffer_load_ushort v17, v21, s[4:7], s31 offen
    buffer_load_dwordx4 v[40:43], v20, s[8:11], s30 offen
    s_add_u32 s30, s30, 13824
    buffer_load_dwordx4 v[44:47], v20, s[8:11], s30 offen
    s_add_u32 s30, s30, 13824
    buffer_load_dwordx4 v[48:51], v20, s[8:11], s30 offen
    s_add_u32 s30, s30, 13824
    buffer_load_dwordx4 v[52:55], v20, s[8:11], s30 offen
    s_add_u32 s30, s30, 13824
    buffer_load_dwordx4 v[56:59], v20, s[8:11], s30 offen
    s_add_u32 s30, s30, 13824
    buffer_load_dwordx4 v[60:63], v20, s[8:11], s30 offen
    s_add_u32 s30, s30, 13824
    buffer_load_dwordx4 v[64:67], v20, s[8:11], s30 offen
    s_add_u32 s30, s30, 13824
    buffer_load_dwordx4 v[68:71], v20, s[8:11], s30 offen
    s_add_u32 s30, s30, 13824
    buffer_load_dwordx4 v[72:75], v20, s[8:11], s30 offen
    s_add_u32 s30, s30, 13824
    buffer_load_dwordx4 v[76:79], v20, s[8:11], s30 offen
    s_add_u32 s30, s30, 13824
    buffer_load_dwordx4 v[80:83], v20, s[8:11], s30 offen
    s_add_u32 s30, s30, 13824
    buffer_load_dwordx4 v[84:87], v20, s[8:11], s30 offen
    s_add_u32 s30, s30, 13824
    buffer_load_dwordx4 v[88:91], v20, s[8:11], s30 offen
    s_add_u32 s30, s30, 13824
    buffer_load_dwordx4 v[92:95], v20, s[8:11], s30 offen
    s_add_u32 s30, s30, 13824
    buffer_load_dwordx4 v[96:99], v20, s[8:11], s30 offen
    s_add_u32 s30, s30, 13824
    buffer_load_dwordx4 v[100:103], v20, s[8:11], s30 offen
    s_add_u32 s30, s30, 13824
    buffer_load_dwordx4 v[104:107], v20, s[8:11], s30 offen
    s_add_u32 s30, s30, 13824
    buffer_load_dwordx4 v[108:111], v20, s[8:11], s30 offen
    s_add_u32 s30, s30, 13824
    buffer_load_dwordx4 v[112:115], v20, s[8:11], s30 offen
    s_add_u32 s30, s30, 13824
    buffer_load_dwordx4 v[116:119], v20, s[8:11], s30 offen
    s_add_u32 s30, s30, 13824
    v_mov_b32 v24, 0
    v_mov_b32 v25, 0
    v_mov_b32 v26, 0
    v_mov_b32 v27, 0
    v_mov_b32 v28, 0
    v_mov_b32 v29, 0
    v_mov_b32 v30, 0
    v_mov_b32 v31, 0
    s_waitcnt vmcnt(19)
    v_lshlrev_b32 v32, 16, v40
    v_and_b32 v33, 0xffff0000, v40
    v_lshlrev_b32 v34, 16, v41
    v_and_b32 v35, 0xffff0000, v41
    v_lshlrev_b32 v36, 16, v42
    v_and_b32 v37, 0xffff0000, v42
    v_lshlrev_b32 v38, 16, v43
    v_and_b32 v39, 0xffff0000, v43
    v_pk_add_f32 v[24:25], v[24:25], v[32:33]
    v_pk_add_f32 v[26:27], v[26:27], v[34:35]
    v_pk_add_f32 v[28:29], v[28:29], v[36:37]
    v_pk_add_f32 v[30:31], v[30:31], v[38:39]
    s_waitcnt vmcnt(18)
    v_lshlrev_b32 v32, 16, v44
    v_and_b32 v33, 0xffff0000, v44
    v_lshlrev_b32 v34, 16, v45
    v_and_b32 v35, 0xffff0000, v45
    v_lshlrev_b32 v36, 16, v46
    v_and_b32 v37, 0xffff0000, v46
    v_lshlrev_b32 v38, 16, v47
    v_and_b32 v39, 0xffff0000, v47
    v_pk_add_f32 v[24:25], v[24:25], v[32:33]
    v_pk_add_f32 v[26:27], v[26:27], v[34:35]
    v_pk_add_f32 v[28:29], v[28:29], v[36:37]
    v_pk_add_f32 v[30:31], v[30:31], v[38:39]
    s_waitcnt vmcnt(17)
    v_lshlrev_b32 v32, 16, v48
    v_and_b32 v33, 0xffff0000, v48
    v_lshlrev_b32 v34, 16, v49
    v_and_b32 v35, 0xffff0000, v49
    v_lshlrev_b32 v36, 16, v50
    v_and_b32 v37, 0xffff0000, v50
    v_lshlrev_b32 v38, 16, v51
    v_and_b32 v39, 0xffff0000, v51
    v_pk_add_f32 v[24:25], v[24:25], v[32:33]
    v_pk_add_f32 v[26:27], v[26:27], v[34:35]
    v_pk_add_f32 v[28:29], v[28:29], v[36:37]
    v_pk_add_f32 v[30:31], v[30:31], v[38:39]
    s_waitcnt vmcnt(16)
    v_lshlrev_b32 v32, 16, v52
    v_and_b32 v33, 0xffff0000, v52
    v_lshlrev_b32 v34, 16, v53
    v_and_b32 v35, 0xffff0000, v53
    v_lshlrev_b32 v36, 16, v54
    v_and_b32 v37, 0xffff0000, v54
    v_lshlrev_b32 v38, 16, v55
    v_and_b32 v39, 0xffff0000, v55
    v_pk_add_f32 v[24:25], v[24:25], v[32:33]
    v_pk_add_f32 v[26:27], v[26:27], v[34:35]
    v_pk_add_f32 v[28:29], v[28:29], v[36:37]
    v_pk_add_f32 v[30:31], v[30:31], v[38:39]
    s_waitcnt vmcnt(15)
    v_lshlrev_b32 v32, 16, v56
    v_and_b32 v33, 0xffff0000, v56
    v_lshlrev_b32 v34, 16, v57
    v_and_b32 v35, 0xffff0000, v57
    v_lshlrev_b32 v36, 16, v58
    v_and_b32 v37, 0xffff0000, v58
    v_lshlrev_b32 v38, 16, v59
    v_and_b32 v39, 0xffff0000, v59
    v_pk_add_f32 v[24:25], v[24:25], v[32:33]
    v_pk_add_f32 v[26:27], v[26:27], v[34:35]
    v_pk_add_f32 v[28:29], v[28:29], v[36:37]
    v_pk_add_f32 v[30:31], v[30:31], v[38:39]
    s_waitcnt vmcnt(14)
    v_lshlrev_b32 v32, 16, v60
    v_and_b32 v33, 0xffff0000, v60
    v_lshlrev_b32 v34, 16, v61
    v_and_b32 v35, 0xffff0000, v61
    v_lshlrev_b32 v36, 16, v62
    v_and_b32 v37, 0xffff0000, v62
    v_lshlrev_b32 v38, 16, v63
    v_and_b32 v39, 0xffff0000, v63
    v_pk_add_f32 v[24:25], v[24:25], v[32:33]
    v_pk_add_f32 v[26:27], v[26:27], v[34:35]
    v_pk_add_f32 v[28:29], v[28:29], v[36:37]
    v_pk_add_f32 v[30:31], v[30:31], v[38:39]
    s_waitcnt vmcnt(13)
    v_lshlrev_b32 v32, 16, v64
    v_and_b32 v33, 0xffff0000, v64
    v_lshlrev_b32 v34, 16, v65
    v_and_b32 v35, 0xffff0000, v65
    v_lshlrev_b32 v36, 16, v66
    v_and_b32 v37, 0xffff0000, v66
    v_lshlrev_b32 v38, 16, v67
    v_and_b32 v39, 0xffff0000, v67
    v_pk_add_f32 v[24:25], v[24:25], v[32:33]
    v_pk_add_f32 v[26:27], v[26:27], v[34:35]
    v_pk_add_f32 v[28:29], v[28:29], v[36:37]
    v_pk_add_f32 v[30:31], v[30:31], v[38:39]
    s_waitcnt vmcnt(12)
    v_lshlrev_b32 v32, 16, v68
    v_and_b32 v33, 0xffff0000, v68
    v_lshlrev_b32 v34, 16, v69
    v_and_b32 v35, 0xffff0000, v69
    v_lshlrev_b32 v36, 16, v70
    v_and_b32 v37, 0xffff0000, v70
    v_lshlrev_b32 v38, 16, v71
    v_and_b32 v39, 0xffff0000, v71
    v_pk_add_f32 v[24:25], v[24:25], v[32:33]
    v_pk_add_f32 v[26:27], v[26:27], v[34:35]
    v_pk_add_f32 v[28:29], v[28:29], v[36:37]
    v_pk_add_f32 v[30:31], v[30:31], v[38:39]
    s_waitcnt vmcnt(11)
    v_lshlrev_b32 v32, 16, v72
    v_and_b32 v33, 0xffff0000, v72
    v_lshlrev_b32 v34, 16, v73
    v_and_b32 v35, 0xffff0000, v73
    v_lshlrev_b32 v36, 16, v74
    v_and_b32 v37, 0xffff0000, v74
    v_lshlrev_b32 v38, 16, v75
    v_and_b32 v39, 0xffff0000, v75
    v_pk_add_f32 v[24:25], v[24:25], v[32:33]
    v_pk_add_f32 v[26:27], v[26:27], v[34:35]
    v_pk_add_f32 v[28:29], v[28:29], v[36:37]
    v_pk_add_f32 v[30:31], v[30:31], v[38:39]
    s_waitcnt vmcnt(10)
    v_lshlrev_b32 v32, 16, v76
    v_and_b32 v33, 0xffff0000, v76
    v_lshlrev_b32 v34, 16, v77
    v_and_b32 v35, 0xffff0000, v77
    v_lshlrev_b32 v36, 16, v78
    v_and_b32 v37, 0xffff0000, v78
    v_lshlrev_b32 v38, 16, v79
    v_and_b32 v39, 0xffff0000, v79
    v_pk_add_f32 v[24:25], v[24:25], v[32:33]
    v_pk_add_f32 v[26:27], v[26:27], v[34:35]
    v_pk_add_f32 v[28:29], v[28:29], v[36:37]
    v_pk_add_f32 v[30:31], v[30:31], v[38:39]
    s_waitcnt vmcnt(9)
    v_lshlrev_b32 v32, 16, v80
    v_and_b32 v33, 0xffff0000, v80
    v_lshlrev_b32 v34, 16, v81
    v_and_b32 v35, 0xffff0000, v81
    v_lshlrev_b32 v36, 16, v82
    v_and_b32 v37, 0xffff0000, v82
    v_lshlrev_b32 v38, 16, v83
    v_and_b32 v39, 0xffff0000, v83
    v_pk_add_f32 v[24:25], v[24:25], v[32:33]
    v_pk_add_f32 v[26:27], v[26:27], v[34:35]
    v_pk_add_f32 v[28:29], v[28:29], v[36:37]
    v_pk_add_f32 v[30:31], v[30:31], v[38:39]
    s_waitcnt vmcnt(8)
    v_lshlrev_b32 v32, 16, v84
    v_and_b32 v33, 0xffff0000, v84
    v_lshlrev_b32 v34, 16, v85
    v_and_b32 v35, 0xffff0000, v85
    v_lshlrev_b32 v36, 16, v86
    v_and_b32 v37, 0xffff0000, v86
    v_lshlrev_b32 v38, 16, v87
    v_and_b32 v39, 0xffff0000, v87
    v_pk_add_f32 v[24:25], v[24:25], v[32:33]
    v_pk_add_f32 v[26:27], v[26:27], v[34:35]
    v_pk_add_f32 v[28:29], v[28:29], v[36:37]
    v_pk_add_f32 v[30:31], v[30:31], v[38:39]
    s_waitcnt vmcnt(7)
    v_lshlrev_b32 v32, 16, v88
    v_and_b32 v33, 0xffff0000, v88
    v_lshlrev_b32 v34, 16, v89
    v_and_b32 v35, 0xffff0000, v89
    v_lshlrev_b32 v36, 16, v90
    v_and_b32 v37, 0xffff0000, v90
    v_lshlrev_b32 v38, 16, v91
    v_and_b32 v39, 0xffff0000, v91
    v_pk_add_f32 v[24:25], v[24:25], v[32:33]
    v_pk_add_f32 v[26:27], v[26:27], v[34:35]
    v_pk_add_f32 v[28:29], v[28:29], v[36:37]
    v_pk_add_f32 v[30:31], v[30:31], v[38:39]
    s_waitcnt vmcnt(6)
    v_lshlrev_b32 v32, 16, v92
    v_and_b32 v33, 0xffff0000, v92
    v_lshlrev_b32 v34, 16, v93
    v_and_b32 v35, 0xffff0000, v93
    v_lshlrev_b32 v36, 16, v94
    v_and_b32 v37, 0xffff0000, v94
    v_lshlrev_b32 v38, 16, v95
    v_and_b32 v39, 0xffff0000, v95
    v_pk_add_f32 v[24:25], v[24:25], v[32:33]
    v_pk_add_f32 v[26:27], v[26:27], v[34:35]
    v_pk_add_f32 v[28:29], v[28:29], v[36:37]
    v_pk_add_f32 v[30:31], v[30:31], v[38:39]
    s_waitcnt vmcnt(5)
    v_lshlrev_b32 v32, 16, v96
    v_and_b32 v33, 0xffff0000, v96
    v_lshlrev_b32 v34, 16, v97
    v_and_b32 v35, 0xffff0000, v97
    v_lshlrev_b32 v36, 16, v98
    v_and_b32 v37, 0xffff0000, v98
    v_lshlrev_b32 v38, 16, v99
    v_and_b32 v39, 0xffff0000, v99
    v_pk_add_f32 v[24:25], v[24:25], v[32:33]
    v_pk_add_f32 v[26:27], v[26:27], v[34:35]
    v_pk_add_f32 v[28:29], v[28:29], v[36:37]
    v_pk_add_f32 v[30:31], v[30:31], v[38:39]
    s_waitcnt vmcnt(4)
    v_lshlrev_b32 v32, 16, v100
    v_and_b32 v33, 0xffff0000, v100
    v_lshlrev_b32 v34, 16, v101
    v_and_b32 v35, 0xffff0000, v101
    v_lshlrev_b32 v36, 16, v102
    v_and_b32 v37, 0xffff0000, v102
    v_lshlrev_b32 v38, 16, v103
    v_and_b32 v39, 0xffff0000, v103
    v_pk_add_f32 v[24:25], v[24:25], v[32:33]
    v_pk_add_f32 v[26:27], v[26:27], v[34:35]
    v_pk_add_f32 v[28:29], v[28:29], v[36:37]
    v_pk_add_f32 v[30:31], v[30:31], v[38:39]
    s_waitcnt vmcnt(3)
    v_lshlrev_b32 v32, 16, v104
    v_and_b32 v33, 0xffff0000, v104
    v_lshlrev_b32 v34, 16, v105
    v_and_b32 v35, 0xffff0000, v105
    v_lshlrev_b32 v36, 16, v106
    v_and_b32 v37, 0xffff0000, v106
    v_lshlrev_b32 v38, 16, v107
    v_and_b32 v39, 0xffff0000, v107
    v_pk_add_f32 v[24:25], v[24:25], v[32:33]
    v_pk_add_f32 v[26:27], v[26:27], v[34:35]
    v_pk_add_f32 v[28:29], v[28:29], v[36:37]
    v_pk_add_f32 v[30:31], v[30:31], v[38:39]
    s_waitcnt vmcnt(2)
    v_lshlrev_b32 v32, 16, v108
    v_and_b32 v33, 0xffff0000, v108
    v_lshlrev_b32 v34, 16, v109
    v_and_b32 v35, 0xffff0000, v109
    v_lshlrev_b32 v36, 16, v110
    v_and_b32 v37, 0xffff0000, v110
    v_lshlrev_b32 v38, 16, v111
    v_and_b32 v39, 0xffff0000, v111
    v_pk_add_f32 v[24:25], v[24:25], v[32:33]
    v_pk_add_f32 v[26:27], v[26:27], v[34:35]
    v_pk_add_f32 v[28:29], v[28:29], v[36:37]
    v_pk_add_f32 v[30:31], v[30:31], v[38:39]
    s_waitcnt vmcnt(1)
    v_lshlrev_b32 v32, 16, v112
    v_and_b32 v33, 0xffff0000, v112
    v_lshlrev_b32 v34, 16, v113
    v_and_b32 v35, 0xffff0000, v113
    v_lshlrev_b32 v36, 16, v114
    v_and_b32 v37, 0xffff0000, v114
    v_lshlrev_b32 v38, 16, v115
    v_and_b32 v39, 0xffff0000, v115
    v_pk_add_f32 v[24:25], v[24:25], v[32:33]
    v_pk_add_f32 v[26:27], v[26:27], v[34:35]
    v_pk_add_f32 v[28:29], v[28:29], v[36:37]
    v_pk_add_f32 v[30:31], v[30:31], v[38:39]
    s_waitcnt vmcnt(0)
    v_lshlrev_b32 v32, 16, v116
    v_and_b32 v33, 0xffff0000, v116
    v_lshlrev_b32 v34, 16, v117
    v_and_b32 v35, 0xffff0000, v117
    v_lshlrev_b32 v36, 16, v118
    v_and_b32 v37, 0xffff0000, v118
    v_lshlrev_b32 v38, 16, v119
    v_and_b32 v39, 0xffff0000, v119
    v_pk_add_f32 v[24:25], v[24:25], v[32:33]
    v_pk_add_f32 v[26:27], v[26:27], v[34:35]
    v_pk_add_f32 v[28:29], v[28:29], v[36:37]
    v_pk_add_f32 v[30:31], v[30:31], v[38:39]
    v_lshlrev_b32 v18, 5, v0
    ds_write_b128 v18, v[24:27]
    ds_write_b128 v18, v[28:31] offset:16
    s_waitcnt lgkmcnt(0)
    s_barrier
    s_cmp_ge_u32 s89, 2
    s_cbranch_scc1 L_p1_end
    v_lshlrev_b32 v18, 2, v0
    ds_read_b32 v40, v18 offset:0
    ds_read_b32 v41, v18 offset:512
    ds_read_b32 v42, v18 offset:1024
    ds_read_b32 v43, v18 offset:1536
    ds_read_b32 v44, v18 offset:2048
    ds_read_b32 v45, v18 offset:2560
    ds_read_b32 v46, v18 offset:3072
    ds_read_b32 v47, v18 offset:3584
    s_waitcnt lgkmcnt(0)
    ds_read_b32 v48, v18 offset:4096
    ds_read_b32 v49, v18 offset:4608
    ds_read_b32 v50, v18 offset:5120
    ds_read_b32 v51, v18 offset:5632
    ds_read_b32 v52, v18 offset:6144
    ds_read_b32 v53, v18 offset:6656
    ds_read_b32 v54, v18 offset:7168
    ds_read_b32 v55, v18 offset:7680
    s_waitcnt lgkmcnt(0)
    ds_read_b32 v56, v18 offset:8192
    ds_read_b32 v57, v18 offset:8704
    ds_read_b32 v58, v18 offset:9216
    ds_read_b32 v59, v18 offset:9728
    ds_read_b32 v60, v18 offset:10240
    ds_read_b32 v61, v18 offset:10752
    ds_read_b32 v62, v18 offset:11264
    ds_read_b32 v63, v18 offset:11776
    s_waitcnt lgkmcnt(0)
    ds_read_b32 v64, v18 offset:12288
    ds_read_b32 v65, v18 offset:12800
    ds_read_b32 v66, v18 offset:13312
    ds_read_b32 v67, v18 offset:13824
    ds_read_b32 v68, v18 offset:14336
    ds_read_b32 v69, v18 offset:14848
    ds_read_b32 v70, v18 offset:15360
    ds_read_b32 v71, v18 offset:15872
    s_waitcnt lgkmcnt(0)
    v_add_f32 v40, v40, v41
    v_add_f32 v40, v40, v42
    v_add_f32 v40, v40, v43
    v_add_f32 v40, v40, v44
    v_add_f32 v40, v40, v45
    v_add_f32 v40, v40, v46
    v_add_f32 v40, v40, v47
    v_add_f32 v40, v40, v48
    v_add_f32 v40, v40, v49
    v_add_f32 v40, v40, v50
    v_add_f32 v40, v40, v51
    v_add_f32 v40, v40, v52
    v_add_f32 v40, v40, v53
    v_add_f32 v40, v40, v54
    v_add_f32 v40, v40, v55
    v_add_f32 v40, v40, v56
    v_add_f32 v40, v40, v57
    v_add_f32 v40, v40, v58
    v_add_f32 v40, v40, v59
    v_add_f32 v40, v40, v60
    v_add_f32 v40, v40, v61
    v_add_f32 v40, v40, v62
    v_add_f32 v40, v40, v63
    v_add_f32 v40, v40, v64
    v_add_f32 v40, v40, v65
    v_add_f32 v40, v40, v66
    v_add_f32 v40, v40, v67
    v_add_f32 v40, v40, v68
    v_add_f32 v40, v40, v69
    v_add_f32 v40, v40, v70
    v_add_f32 v40, v40, v71
    v_lshlrev_b32 v17, 16, v17
    v_mul_f32 v17, 0x3eeff558, v17
    s_lshl_b32 s30, s20, 10
    s_add_u32 s30, s30, 20381696
    s_add_u32 s31, s30, 512
    buffer_store_dword v40, v18, s[12:15], s30 offen sc1
    buffer_store_dword v17, v18, s[12:15], s31 offen sc1
L_p1_end:
    s_lshl_b32 s94, s20, 4
    s_add_u32 s94, s94, s21
    v_readfirstlane_b32 s88, v16
    s_load_dwordx2 s[40:41], s[0:1], 80
    s_load_dwordx2 s[44:45], s[0:1], 16
    s_load_dwordx2 s[46:47], s[0:1], 32
    s_load_dwordx2 s[38:39], s[0:1], 48
    s_and_b32 s20, s2, 7
    s_lshl_b32 s20, s20, 2
    s_bfe_u32 s25, s2, 0x20003
    s_add_u32 s20, s20, s25
    s_lshr_b32 s21, s2, 5
    s_and_b32 s23, s89, 3
    s_lshr_b32 s24, s89, 2
    s_and_b32 s30, s20, 1
    s_mov_b32 s34, -1
    s_mov_b32 s35, 0
    s_lshr_b32 s25, s20, 1
    s_mul_i32 s25, s25, 5
    s_mul_i32 s26, s30, 3
    s_add_u32 s26, s26, s25
    v_add_lshl_u32 v4, v3, s26, 15
    v_lshl_add_u32 v4, v2, 4, v4
    s_add_u32 s25, s25, 2
    s_lshl_b32 s25, s25, 15
    s_lshl_b32 s26, s30, 3
    s_add_u32 s25, s25, s26
    v_lshl_add_u32 v5, v2, 4, s25
    s_sub_u32 s25, s25, 512
    v_lshl_add_u32 v207, v1, 4, s25
    s_lshl_b32 s28, s24, 14
    s_add_u32 s28, s28, 2621440
    s_lshl_b32 s58, s21, 12
    s_lshl_b32 s26, s23, 10
    s_add_u32 s58, s58, s26
    v_mov_b32 v28, 0
    v_mov_b32 v29, 0
    v_mov_b32 v30, 0
    v_mov_b32 v31, 0
    s_mov_b32 s42, s28
    s_mov_b32 s32, 0xfffff
    s_mov_b32 s33, 0xfffff
    v_add_u32 v8, 4, v2
    v_subrev_u32 v9, 16, v2
    v_cmp_gt_u32 vcc, 16, v2
    s_nop 1
    v_cndmask_b32 v8, v9, v8, vcc
    s_cmp_eq_u32 s30, 1
    s_cselect_b64 vcc, -1, 0
    v_cndmask_b32 v8, v2, v8, vcc
    s_mul_i32 s25, s20, 20
    v_mul_u32_u24 v9, 640, v3
    v_add3_u32 v6, v8, s25, v9
    v_lshlrev_b32 v6, 4, v6
    v_add_u32 v7, 20480, v6
    s_mul_i32 s29, s24, 1310720
    s_add_u32 s29, s29, 5242880
    s_mov_b32 s43, s29
    s_mov_b32 s22, 40960
    v_cmp_eq_u32 vcc, 0, v3
    v_mov_b32 v210, 0x3f80
    s_nop 0
    v_cndmask_b32 v210, 0, v210, vcc
    v_mov_b32 v211, 0
    v_mov_b32 v213, 0
    v_cmp_eq_u32 vcc, 20, v2
    v_mov_b32 v9, 0x3f803f80
    s_nop 0
    v_cndmask_b32 v9, 0, v9, vcc
    v_mov_b32 v56, v9
    v_mov_b32 v57, v9
    v_mov_b32 v58, v9
    v_mov_b32 v59, v9
    v_mov_b32 v60, v9
    v_mov_b32 v61, v9
    v_mov_b32 v62, v9
    v_mov_b32 v63, v9
    v_mov_b32 v64, v9
    v_mov_b32 v65, v9
    v_mov_b32 v66, v9
    v_mov_b32 v67, v9
    v_mov_b32 v68, v9
    v_mov_b32 v69, v9
    v_mov_b32 v70, v9
    v_mov_b32 v71, v9
    v_mov_b32 v72, v9
    v_mov_b32 v73, v9
    v_mov_b32 v74, v9
    v_mov_b32 v75, v9
    v_mov_b32 v76, v9
    v_mov_b32 v77, v9
    v_mov_b32 v78, v9
    v_mov_b32 v79, v9
    v_mov_b32 v80, v9
    v_mov_b32 v81, v9
    v_mov_b32 v82, v9
    v_mov_b32 v83, v9
    v_mov_b32 v84, v9
    v_mov_b32 v85, v9
    v_mov_b32 v86, v9
    v_mov_b32 v87, v9
    v_mov_b32 v168, 0
    v_mov_b32 v169, 0
    v_mov_b32 v170, 0
    v_mov_b32 v171, 0
    v_mov_b32 v172, 0
    v_mov_b32 v173, 0
    v_mov_b32 v174, 0
    v_mov_b32 v175, 0
    v_mov_b32 v176, 0
    v_mov_b32 v177, 0
    v_mov_b32 v178, 0
    v_mov_b32 v179, 0
    v_mov_b32 v180, 0
    v_mov_b32 v181, 0
    v_mov_b32 v182, 0
    v_mov_b32 v183, 0
    v_mov_b32 v184, 0
    v_mov_b32 v185, 0
    v_mov_b32 v186, 0
    v_mov_b32 v187, 0
    v_mov_b32 v188, 0
    v_mov_b32 v189, 0
    v_mov_b32 v190, 0
    v_mov_b32 v191, 0
    v_mov_b32 v192, 0
    v_mov_b32 v193, 0
    v_mov_b32 v194, 0
    v_mov_b32 v195, 0
    v_mov_b32 v196, 0
    v_mov_b32 v197, 0
    v_mov_b32 v198, 0
    v_mov_b32 v199, 0
    v_mov_b32 v160, 0
    v_mov_b32 v161, 0
    v_mov_b32 v162, 0
    v_mov_b32 v163, 0
    v_mov_b32 v164, 0
    v_mov_b32 v165, 0
    v_mov_b32 v166, 0
    v_mov_b32 v167, 0
    s_lshr_b32 s25, s2, 3
    s_lshl_b32 s25, s25, 3
    s_add_u32 s25, s25, s89
    s_mul_i32 s49, s25, 6144
    s_add_u32 s49, s49, 663552
    v_lshlrev_b32 v10, 8, v1
    v_add_u32 v10, 124, v10
    v_mov_b32 v11, 0x7ffffff0
    v_cmp_gt_u32 vcc, 24, v1
    s_nop 1
    v_cndmask_b32 v18, v11, v10, vcc
    s_lshl_b32 s48, s2, 3
    s_add_u32 s48, s48, s89
    s_mul_i32 s48, s48, 1280
    v_cmp_gt_u32 vcc, 5, v1
    s_nop 1
    v_cndmask_b32 v19, v11, v10, vcc
    s_sub_u32 s50, s23, s24
    s_add_u32 s50, s50, 3
    s_lshl_b32 s92, s2, 3
    s_add_u32 s92, s92, s89
    s_mul_i32 s92, s92, 1536
    s_add_u32 s92, s92, 2621440
    v_lshrrev_b32 v8, 3, v1
    v_and_b32 v9, 7, v1
    v_bfe_u32 v10, v1, 4, 1
    v_lshlrev_b32 v10, 2, v10
    v_xor_b32 v9, v9, v10
    v_mul_u32_u24 v8, 1280, v8
    v_lshl_add_u32 v202, v9, 4, v8
    v_add_u32 v203, 9216, v202
    v_lshrrev_b32 v8, 4, v1
    v_and_b32 v9, 15, v1
    v_lshlrev_b32 v10, 2, v8
    v_xor_b32 v9, v9, v10
    v_mul_u32_u24 v8, 3456, v8
    v_lshl_add_u32 v204, v9, 4, v8
    v_add_u32 v205, 12800, v204
    s_lshr_b32 s25, s2, 3
    s_mul_i32 s26, s25, 43
    s_lshr_b32 s26, s26, 7
    s_lshl_b32 s26, s26, 7
    s_mul_i32 s56, s89, 20480
    s_add_u32 s56, s56, s26
    s_lshr_b32 s25, s25, 1
    s_lshl_b32 s25, s25, 8
    s_mul_i32 s59, s89, 27648
    s_add_u32 s59, s59, s25
    s_lshl_b32 s57, s89, 11
    s_waitcnt lgkmcnt(0)
    s_mov_b32 s4, s40
    s_and_b32 s5, s41, 0xffff
    s_mov_b32 s6, 0x780000
    s_mov_b32 s7, 0x00020000
    s_mov_b32 s52, s40
    s_and_b32 s53, s41, 0xffff
    s_mov_b32 s54, 0x1428800
    s_mov_b32 s55, 0x00020000
    s_mov_b32 s8, s44
    s_and_b32 s9, s45, 0xffff
    s_mov_b32 s10, 0xc8000
    s_mov_b32 s11, 0x00020000
    s_mov_b32 s12, s46
    s_and_b32 s13, s47, 0xffff
    s_mov_b32 s14, 0x21c000
    s_mov_b32 s15, 0x00020000
    s_load_dwordx2 s[44:45], s[0:1], 0
    s_lshr_b32 s25, s2, 3
    s_mul_i32 s26, s25, 43
    s_lshr_b32 s26, s26, 7
    s_mul_i32 s46, s26, 3
    s_sub_u32 s25, s25, s46
    s_mul_i32 s25, s25, 3
    s_add_u32 s25, s25, s89
    s_and_b32 s46, s2, 7
    s_lshl_b32 s46, s46, 3
    s_add_u32 s25, s25, s46
    s_lshl_b32 s25, s25, 5
    v_add_u32 v215, s25, v2
    v_mul_u32_u24 v215, 1280, v215
    v_lshl_add_u32 v215, v3, 4, v215
    s_lshl_b32 s26, s26, 7
    v_add_u32 v215, s26, v215
    s_lshl_b32 s26, s24, 9
    s_add_u32 s58, s58, s26
    s_xor_b32 s47, s58, 512
    s_mov_b32 s16, s38
    s_and_b32 s17, s39, 0xffff
    s_mov_b32 s18, 0x21c000
    s_mov_b32 s19, 0x00020000
    s_getreg_b32 s51, hwreg(HW_REG_XCC_ID)
    s_and_b32 s51, s51, 15
    s_and_b32 s25, s2, 7
    s_lshl_b32 s25, s25, 7
    s_add_u32 s25, s25, 21102592
    v_lshl_add_u32 v206, v2, 10, s25
    s_and_b32 s25, s89, 6
    s_cmp_lg_u32 s25, 4
    s_cbranch_scc1 L_p2_nt
    s_lshr_b32 s25, s20, 1
    s_mul_i32 s25, s25, 5
    s_add_u32 s25, s25, s30
    s_add_u32 s25, s25, s30
    s_add_u32 s26, s25, 2
    s_lshr_b32 s25, s25, 4
    s_lshr_b32 s26, s26, 4
    s_cmp_eq_u32 s89, 4
    s_cbranch_scc1 L_p2_fk
    s_lshl_b32 s25, s2, 7
    s_add_u32 s25, s25, 21102592
    v_mov_b32 v10, s88
    v_mov_b32 v11, s51
    v_mov_b32 v12, 0
    s_mov_b64 exec, 1
    buffer_store_dwordx2 v[10:11], v12, s[52:55], s25 offen sc1
    s_mov_b64 exec, -1
    s_mul_i32 s25, s20, 20
    s_add_u32 s26, s25, 659
    s_add_u32 s25, s25, 640
    s_lshr_b32 s25, s25, 7
    s_lshr_b32 s26, s26, 7
L_p2_fk:
    v_mov_b32 v8, s25
    v_mov_b32 v9, s26
    v_and_b32 v13, 16, v1
    v_cmp_eq_u32 vcc, 0, v13
    s_nop 1
    v_cndmask_b32 v13, v9, v8, vcc
    v_and_b32 v9, 15, v1
    v_lshl_add_u32 v8, v9, 4, v13
    v_add_u32 v8, 5, v8
    v_and_b32 v9, 1, v1
    s_lshl_b32 s25, s21, 1
    v_add_u32 v9, s25, v9
    v_lshl_add_u32 v9, v9, 4, v13
    s_cmp_eq_u32 s89, 4
    s_cselect_b32 s25, 32, 64
    v_cmp_gt_u32 vcc, s25, v1
    s_nop 1
    v_cndmask_b32 v8, v9, v8, vcc
    v_lshlrev_b32 v8, 7, v8
    v_add_u32 v8, 20971520, v8
L_p2_nt:
    s_waitcnt vmcnt(0) lgkmcnt(0)
    s_barrier
    s_and_b32 s25, s89, 6
    s_cmp_lg_u32 s25, 4
    s_cbranch_scc1 L_p2_nw
    s_cmp_lg_u32 s89, 4
    s_cbranch_scc1 L_p2_npb
    s_lshl_b32 s25, s94, 7
    s_add_u32 s25, s25, 20971520
    v_mov_b32 v12, 0
    v_mov_b32 v13, s88
    s_mov_b64 exec, 1
    buffer_store_dword v13, v12, s[52:55], s25 offen sc1
    s_mov_b64 exec, -1
L_p2_npb:
    s_mov_b32 s27, 0
    s_mov_b64 s[90:91], -1
L_p2_poll1:
    buffer_load_dword v248, v8, s[52:55], 0 offen sc1
    s_waitcnt vmcnt(0)
    v_cmp_ne_u32 vcc, s88, v248
    s_nop 1
    s_and_b64 exec, exec, vcc
    s_cbranch_execz L_p2_go1
    s_sleep 1
    s_add_u32 s27, s27, 1
    s_cmp_lt_u32 s27, 0x4000
    s_cbranch_scc1 L_p2_poll1
L_p2_go1:
    s_mov_b64 exec, -1
L_p2_nw:
    s_barrier
    buffer_load_dwordx2 v[48:49], v207, s[4:7], s28 offen offset:512
    buffer_load_dwordx4 v[32:35], v4, s[4:7], s28 offen
    s_add_u32 s28, s28, 512
    buffer_load_dwordx4 v[20:23], v4, s[4:7], s47 offen sc1
    buffer_load_dwordx2 v[52:53], v5, s[4:7], s47 offen sc1
    buffer_load_dwordx4 v[24:27], v4, s[4:7], s58 offen sc1
    buffer_load_dwordx2 v[54:55], v5, s[4:7], s58 offen sc1
    v_mov_b32 v15, 0x7ffffff0
    buffer_load_dwordx4 v[36:39], v4, s[4:7], s28 offen
    s_add_u32 s28, s28, 512
    s_mov_b64 exec, s[32:33]
    buffer_load_dwordx4 v[56:59], v6, s[4:7], s29 offen
    buffer_load_dwordx4 v[60:63], v7, s[4:7], s29 offen
    s_mov_b64 exec, -1
    s_waitcnt vmcnt(3)
    s_mov_b32 exec_hi, 0
    v_mov_b32 v28, v52
    v_mov_b32 v29, v53
    v_mov_b32 v30, v54
    v_mov_b32 v31, v55
    v_mov_b32 v52, 0
    v_mov_b32 v53, 0
    v_mov_b32 v54, 0
    v_mov_b32 v55, 0
    s_mov_b32 exec_hi, -1
    v_mfma_f32_32x32x16_bf16 v[120:135], v[32:35], v[20:23], 0
    v_mfma_f32_32x32x8_bf16 v[120:135], v[48:49], v[28:29], v[120:135]
    v_mfma_f32_32x32x16_bf16 v[136:151], v[32:35], v[24:27], 0
    v_mfma_f32_32x32x8_bf16 v[136:151], v[48:49], v[30:31], v[136:151]
    s_add_u32 s29, s29, s22
    buffer_load_dwordx4 v[40:43], v4, s[4:7], s28 offen
    s_add_u32 s28, s28, 512
    s_mov_b64 exec, s[32:33]
    buffer_load_dwordx4 v[64:67], v6, s[4:7], s29 offen
    buffer_load_dwordx4 v[68:71], v7, s[4:7], s29 offen
    s_mov_b64 exec, -1
    s_add_u32 s29, s29, s22
    buffer_load_dwordx4 v[44:47], v4, s[4:7], s28 offen
    buffer_load_dwordx2 v[50:51], v207, s[4:7], s28 offen
    s_add_u32 s28, s28, 512
    s_mov_b64 exec, s[32:33]
    buffer_load_dwordx4 v[72:75], v6, s[4:7], s29 offen
    buffer_load_dwordx4 v[76:79], v7, s[4:7], s29 offen
    s_mov_b64 exec, -1
    s_add_u32 s29, s29, s22
    buffer_load_dword v200, v15, s[4:7], 0 offen
    buffer_load_dword v200, v15, s[4:7], 0 offen
    v_max3_f32 v16, v120, v121, v122
    v_max3_f32 v16, v16, v123, v124
    v_max3_f32 v16, v16, v125, v126
    v_max3_f32 v16, v16, v127, v128
    v_max3_f32 v16, v16, v129, v130
    v_max3_f32 v16, v16, v131, v132
    v_max3_f32 v16, v16, v133, v134
    v_max_f32 v16, v16, v135
    v_mov_b32 v8, v16
    s_nop 1
    v_permlane32_swap_b32 v16, v8
    v_max_f32 v16, v16, v8
    v_cvt_pk_bf16_f32 v212, -v16, 0
    s_nop 1
    v_mfma_f32_32x32x8_bf16 v[88:103], v[210:211], v[212:213], 0
    v_lshlrev_b32 v16, 16, v212
    v_xor_b32 v16, 0x80000000, v16
    v_max3_f32 v17, v136, v137, v138
    v_max3_f32 v17, v17, v139, v140
    v_max3_f32 v17, v17, v141, v142
    v_max3_f32 v17, v17, v143, v144
    v_max3_f32 v17, v17, v145, v146
    v_max3_f32 v17, v17, v147, v148
    v_max3_f32 v17, v17, v149, v150
    v_max_f32 v17, v17, v151
    v_mov_b32 v8, v17
    s_nop 1
    v_permlane32_swap_b32 v17, v8
    v_max_f32 v17, v17, v8
    v_cvt_pk_bf16_f32 v212, -v17, 0
    s_nop 1
    v_mfma_f32_32x32x8_bf16 v[104:119], v[210:211], v[212:213], 0
    v_lshlrev_b32 v17, 16, v212
    v_xor_b32 v17, 0x80000000, v17
    v_mfma_f32_32x32x16_bf16 v[120:135], v[32:35], v[20:23], v[88:103]
    v_mfma_f32_32x32x8_bf16 v[120:135], v[48:49], v[28:29], v[120:135]
    s_nop 7
    s_mov_b32 s27, 0
    s_nop 1
    s_cmp_eq_u32 s24, 0
    s_cselect_b32 s31, 99, 6
    s_cbranch_scc1 L_p2_np
    s_setprio 1
L_p2_np:
L_p2_loop:
    v_mfma_f32_32x32x16_bf16 v[136:151], v[32:35], v[24:27], v[104:119]
    v_exp_f32 v120, v120
    v_exp_f32 v121, v121
    v_exp_f32 v122, v122
    v_exp_f32 v123, v123
    v_cvt_pk_bf16_f32 v152, v120, v121
    v_mfma_f32_32x32x8_bf16 v[136:151], v[48:49], v[30:31], v[136:151]
    v_exp_f32 v124, v124
    v_exp_f32 v125, v125
    v_cvt_pk_bf16_f32 v153, v122, v123
    buffer_load_dwordx4 v[32:35], v4, s[4:7], s28 offen
    s_add_u32 s28, s28, 512
    v_exp_f32 v126, v126
    v_exp_f32 v127, v127
    v_cvt_pk_bf16_f32 v154, v124, v125
    v_mfma_f32_32x32x16_bf16 v[184:199], v[80:83], v[160:163], v[184:199]
    v_exp_f32 v128, v128
    v_exp_f32 v129, v129
    v_cvt_pk_bf16_f32 v155, v126, v127
    v_exp_f32 v130, v130
    v_exp_f32 v131, v131
    v_cvt_pk_bf16_f32 v156, v128, v129
    v_mfma_f32_32x32x16_bf16 v[184:199], v[84:87], v[164:167], v[184:199]
    v_exp_f32 v132, v132
    v_exp_f32 v133, v133
    v_cvt_pk_bf16_f32 v157, v130, v131
    s_mov_b64 exec, s[32:33]
    buffer_load_dwordx4 v[80:83], v6, s[4:7], s29 offen
    buffer_load_dwordx4 v[84:87], v7, s[4:7], s29 offen
    s_mov_b64 exec, -1
    s_add_u32 s29, s29, s22
    v_exp_f32 v134, v134
    v_exp_f32 v135, v135
    v_cvt_pk_bf16_f32 v158, v132, v133
    v_cvt_pk_bf16_f32 v159, v134, v135
    s_waitcnt vmcnt(12)
    v_mfma_f32_32x32x16_bf16 v[120:135], v[36:39], v[20:23], v[88:103]
    v_exp_f32 v136, v136
    v_exp_f32 v137, v137
    v_exp_f32 v138, v138
    v_exp_f32 v139, v139
    v_cvt_pk_bf16_f32 v160, v136, v137
    v_mfma_f32_32x32x8_bf16 v[120:135], v[48:49], v[52:53], v[120:135]
    v_exp_f32 v140, v140
    v_exp_f32 v141, v141
    v_cvt_pk_bf16_f32 v161, v138, v139
    v_exp_f32 v142, v142
    v_exp_f32 v143, v143
    v_cvt_pk_bf16_f32 v162, v140, v141
    v_mfma_f32_32x32x16_bf16 v[168:183], v[56:59], v[152:155], v[168:183]
    v_exp_f32 v144, v144
    v_exp_f32 v145, v145
    v_cvt_pk_bf16_f32 v163, v142, v143
    v_exp_f32 v146, v146
    v_exp_f32 v147, v147
    v_cvt_pk_bf16_f32 v164, v144, v145
    v_mfma_f32_32x32x16_bf16 v[168:183], v[60:63], v[156:159], v[168:183]
    v_exp_f32 v148, v148
    v_exp_f32 v149, v149
    v_cvt_pk_bf16_f32 v165, v146, v147
    v_exp_f32 v150, v150
    v_exp_f32 v151, v151
    v_cvt_pk_bf16_f32 v166, v148, v149
    v_cvt_pk_bf16_f32 v167, v150, v151
    v_mfma_f32_32x32x16_bf16 v[136:151], v[36:39], v[24:27], v[104:119]
    v_exp_f32 v120, v120
    v_exp_f32 v121, v121
    v_exp_f32 v122, v122
    v_exp_f32 v123, v123
    v_cvt_pk_bf16_f32 v152, v120, v121
    v_mfma_f32_32x32x8_bf16 v[136:151], v[48:49], v[54:55], v[136:151]
    v_exp_f32 v124, v124
    v_exp_f32 v125, v125
    v_cvt_pk_bf16_f32 v153, v122, v123
    buffer_load_dwordx4 v[36:39], v4, s[4:7], s28 offen
    buffer_load_dwordx2 v[48:49], v207, s[4:7], s28 offen
    s_add_u32 s28, s28, 512
    v_exp_f32 v126, v126
    v_exp_f32 v127, v127
    v_cvt_pk_bf16_f32 v154, v124, v125
    v_mfma_f32_32x32x16_bf16 v[184:199], v[56:59], v[160:163], v[184:199]
    v_exp_f32 v128, v128
    v_exp_f32 v129, v129
    v_cvt_pk_bf16_f32 v155, v126, v127
    v_exp_f32 v130, v130
    v_exp_f32 v131, v131
    v_cvt_pk_bf16_f32 v156, v128, v129
    v_mfma_f32_32x32x16_bf16 v[184:199], v[60:63], v[164:167], v[184:199]
    v_exp_f32 v132, v132
    v_exp_f32 v133, v133
    v_cvt_pk_bf16_f32 v157, v130, v131
    s_mov_b64 exec, s[32:33]
    buffer_load_dwordx4 v[56:59], v6, s[4:7], s29 offen
    buffer_load_dwordx4 v[60:63], v7, s[4:7], s29 offen
    s_mov_b64 exec, -1
    s_add_u32 s29, s29, s22
    v_exp_f32 v134, v134
    v_exp_f32 v135, v135
    v_cvt_pk_bf16_f32 v158, v132, v133
    v_cvt_pk_bf16_f32 v159, v134, v135
    s_waitcnt vmcnt(11)
    v_mfma_f32_32x32x16_bf16 v[120:135], v[40:43], v[20:23], v[88:103]
    v_exp_f32 v136, v136
    v_exp_f32 v137, v137
    v_exp_f32 v138, v138
    v_exp_f32 v139, v139
    v_cvt_pk_bf16_f32 v160, v136, v137
    v_mfma_f32_32x32x8_bf16 v[120:135], v[50:51], v[28:29], v[120:135]
    v_exp_f32 v140, v140
    v_exp_f32 v141, v141
    v_cvt_pk_bf16_f32 v161, v138, v139
    v_exp_f32 v142, v142
    v_exp_f32 v143, v143
    v_cvt_pk_bf16_f32 v162, v140, v141
    v_mfma_f32_32x32x16_bf16 v[168:183], v[64:67], v[152:155], v[168:183]
    v_exp_f32 v144, v144
    v_exp_f32 v145, v145
    v_cvt_pk_bf16_f32 v163, v142, v143
    v_exp_f32 v146, v146
    v_exp_f32 v147, v147
    v_cvt_pk_bf16_f32 v164, v144, v145
    v_mfma_f32_32x32x16_bf16 v[168:183], v[68:71], v[156:159], v[168:183]
    v_exp_f32 v148, v148
    v_exp_f32 v149, v149
    v_cvt_pk_bf16_f32 v165, v146, v147
    v_exp_f32 v150, v150
    v_exp_f32 v151, v151
    v_cvt_pk_bf16_f32 v166, v148, v149
    v_cvt_pk_bf16_f32 v167, v150, v151
    s_cmp_lg_u32 s27, s31
    s_cbranch_scc1 L_p2_nph
    s_setprio 0
L_p2_nph:
    v_mfma_f32_32x32x16_bf16 v[136:151], v[40:43], v[24:27], v[104:119]
    v_exp_f32 v120, v120
    v_exp_f32 v121, v121
    v_exp_f32 v122, v122
    v_exp_f32 v123, v123
    v_cvt_pk_bf16_f32 v152, v120, v121
    v_mfma_f32_32x32x8_bf16 v[136:151], v[50:51], v[30:31], v[136:151]
    v_exp_f32 v124, v124
    v_exp_f32 v125, v125
    v_cvt_pk_bf16_f32 v153, v122, v123
    buffer_load_dwordx4 v[40:43], v4, s[4:7], s28 offen
    s_add_u32 s28, s28, 512
    v_exp_f32 v126, v126
    v_exp_f32 v127, v127
    v_cvt_pk_bf16_f32 v154, v124, v125
    v_mfma_f32_32x32x16_bf16 v[184:199], v[64:67], v[160:163], v[184:199]
    v_exp_f32 v128, v128
    v_exp_f32 v129, v129
    v_cvt_pk_bf16_f32 v155, v126, v127
    v_exp_f32 v130, v130
    v_exp_f32 v131, v131
    v_cvt_pk_bf16_f32 v156, v128, v129
    v_mfma_f32_32x32x16_bf16 v[184:199], v[68:71], v[164:167], v[184:199]
    v_exp_f32 v132, v132
    v_exp_f32 v133, v133
    v_cvt_pk_bf16_f32 v157, v130, v131
    s_mov_b64 exec, s[32:33]
    buffer_load_dwordx4 v[64:67], v6, s[4:7], s29 offen
    buffer_load_dwordx4 v[68:71], v7, s[4:7], s29 offen
    s_mov_b64 exec, -1
    s_add_u32 s29, s29, s22
    v_exp_f32 v134, v134
    v_exp_f32 v135, v135
    v_cvt_pk_bf16_f32 v158, v132, v133
    v_cvt_pk_bf16_f32 v159, v134, v135
    s_waitcnt vmcnt(12)
    v_mfma_f32_32x32x16_bf16 v[120:135], v[44:47], v[20:23], v[88:103]
    v_exp_f32 v136, v136
    v_exp_f32 v137, v137
    v_exp_f32 v138, v138
    v_exp_f32 v139, v139
    v_cvt_pk_bf16_f32 v160, v136, v137
    v_mfma_f32_32x32x8_bf16 v[120:135], v[50:51], v[52:53], v[120:135]
    v_exp_f32 v140, v140
    v_exp_f32 v141, v141
    v_cvt_pk_bf16_f32 v161, v138, v139
    v_exp_f32 v142, v142
    v_exp_f32 v143, v143
    v_cvt_pk_bf16_f32 v162, v140, v141
    v_mfma_f32_32x32x16_bf16 v[168:183], v[72:75], v[152:155], v[168:183]
    v_exp_f32 v144, v144
    v_exp_f32 v145, v145
    v_cvt_pk_bf16_f32 v163, v142, v143
    v_exp_f32 v146, v146
    v_exp_f32 v147, v147
    v_cvt_pk_bf16_f32 v164, v144, v145
    v_mfma_f32_32x32x16_bf16 v[168:183], v[76:79], v[156:159], v[168:183]
    v_exp_f32 v148, v148
    v_exp_f32 v149, v149
    v_cvt_pk_bf16_f32 v165, v146, v147
    v_exp_f32 v150, v150
    v_exp_f32 v151, v151
    v_cvt_pk_bf16_f32 v166, v148, v149
    v_cvt_pk_bf16_f32 v167, v150, v151
    v_mfma_f32_32x32x16_bf16 v[136:151], v[44:47], v[24:27], v[104:119]
    v_exp_f32 v120, v120
    v_exp_f32 v121, v121
    v_exp_f32 v122, v122
    v_exp_f32 v123, v123
    v_cvt_pk_bf16_f32 v152, v120, v121
    v_mfma_f32_32x32x8_bf16 v[136:151], v[50:51], v[54:55], v[136:151]
    v_exp_f32 v124, v124
    v_exp_f32 v125, v125
    v_cvt_pk_bf16_f32 v153, v122, v123
    buffer_load_dwordx4 v[44:47], v4, s[4:7], s28 offen
    buffer_load_dwordx2 v[50:51], v207, s[4:7], s28 offen
    s_add_u32 s28, s28, 512
    v_exp_f32 v126, v126
    v_exp_f32 v127, v127
    v_cvt_pk_bf16_f32 v154, v124, v125
    v_mfma_f32_32x32x16_bf16 v[184:199], v[72:75], v[160:163], v[184:199]
    v_exp_f32 v128, v128
    v_exp_f32 v129, v129
    v_cvt_pk_bf16_f32 v155, v126, v127
    v_exp_f32 v130, v130
    v_exp_f32 v131, v131
    v_cvt_pk_bf16_f32 v156, v128, v129
    v_mfma_f32_32x32x16_bf16 v[184:199], v[76:79], v[164:167], v[184:199]
    v_exp_f32 v132, v132
    v_exp_f32 v133, v133
    v_cvt_pk_bf16_f32 v157, v130, v131
    s_mov_b64 exec, s[32:33]
    buffer_load_dwordx4 v[72:75], v6, s[4:7], s29 offen
    buffer_load_dwordx4 v[76:79], v7, s[4:7], s29 offen
    s_mov_b64 exec, -1
    s_add_u32 s29, s29, s22
    v_exp_f32 v134, v134
    v_exp_f32 v135, v135
    v_cvt_pk_bf16_f32 v158, v132, v133
    v_cvt_pk_bf16_f32 v159, v134, v135
    s_waitcnt vmcnt(9)
    v_mfma_f32_32x32x16_bf16 v[120:135], v[32:35], v[20:23], v[88:103]
    v_exp_f32 v136, v136
    v_exp_f32 v137, v137
    v_exp_f32 v138, v138
    v_exp_f32 v139, v139
    v_cvt_pk_bf16_f32 v160, v136, v137
    v_mfma_f32_32x32x8_bf16 v[120:135], v[48:49], v[28:29], v[120:135]
    v_exp_f32 v140, v140
    v_exp_f32 v141, v141
    v_cvt_pk_bf16_f32 v161, v138, v139
    v_exp_f32 v142, v142
    v_exp_f32 v143, v143
    v_cvt_pk_bf16_f32 v162, v140, v141
    v_mfma_f32_32x32x16_bf16 v[168:183], v[80:83], v[152:155], v[168:183]
    v_exp_f32 v144, v144
    v_exp_f32 v145, v145
    v_cvt_pk_bf16_f32 v163, v142, v143
    v_exp_f32 v146, v146
    v_exp_f32 v147, v147
    v_cvt_pk_bf16_f32 v164, v144, v145
    v_mfma_f32_32x32x16_bf16 v[168:183], v[84:87], v[156:159], v[168:183]
    v_exp_f32 v148, v148
    v_exp_f32 v149, v149
    v_cvt_pk_bf16_f32 v165, v146, v147
    v_exp_f32 v150, v150
    v_exp_f32 v151, v151
    v_cvt_pk_bf16_f32 v166, v148, v149
    v_cvt_pk_bf16_f32 v167, v150, v151
    s_add_u32 s27, s27, 1
    s_cmp_lg_u32 s27, s50
    s_cbranch_scc1 L_p2_noe2
    buffer_load_dwordx2 v[200:201], v18, s[12:15], s49 offen
    buffer_load_dwordx2 v[200:201], v19, s[16:19], s48 offen
    s_cmp_lg_u32 s89, 5
    s_cbranch_scc1 L_p2_noe1
    s_lshl_b32 s25, s2, 7
    s_add_u32 s25, s25, 21004288
    s_buffer_load_dword s93, s[52:55], s25 offset:0
    s_buffer_load_dword s93, s[52:55], s25 offset:32768
    s_buffer_load_dword s93, s[52:55], s25 offset:65536
    buffer_load_dwordx2 v[208:209], v206, s[52:55], 0 offen sc1
L_p2_noe1:
    s_cmp_lg_u32 s89, 3
    s_cbranch_scc1 L_p2_noe2
    s_getpc_b64 s[16:17]
L_p2_pc1:
    s_add_u32 s16, s16, L_p2_merge-L_p2_pc1
    s_addc_u32 s17, s17, 0
    s_and_b32 s17, s17, 0xffff
    s_mov_b32 s18, L_code_end-L_p2_merge
    s_mov_b32 s19, 0x00020000
    s_lshr_b32 s25, s2, 3
    s_mul_i32 s25, s25, 1024
    v_lshlrev_b32 v8, 7, v1
    s_mov_b64 exec, 0xff
    buffer_load_dword v200, v8, s[16:19], s25 offen
    s_mov_b64 exec, -1
L_p2_noe2:
    s_cmp_ge_u32 s27, 6
    s_cbranch_scc1 L_p2_d1
    s_mov_b32 m0, s57
    s_add_u32 s57, s57, 16384
    buffer_load_dwordx4 v202, s[8:11], s56 offen lds
    buffer_load_dwordx4 v203, s[8:11], s56 offen offset:1024 lds
    s_add_u32 s56, s56, 163840
    s_branch L_p2_loop
L_p2_d1:
    s_cmp_eq_u32 s27, 7
    s_cselect_b32 s28, 0x10000000, s28
    s_cselect_b32 s22, 0x10000000, s22
    s_mov_b32 m0, s57
    s_add_u32 s57, s57, 16384
    buffer_load_dwordx4 v204, s[12:15], s59 offen lds
    buffer_load_dwordx4 v205, s[12:15], s59 offen offset:1024 lds
    s_add_u32 s59, s59, 221184
    s_cmp_lt_u32 s27, 8
    s_cbranch_scc1 L_p2_loop
L_p2_lend:
    v_mfma_f32_32x32x16_bf16 v[184:199], v[80:83], v[160:163], v[184:199]
    v_mfma_f32_32x32x16_bf16 v[184:199], v[84:87], v[164:167], v[184:199]
    s_cmp_ge_u32 s89, 3
    s_cbranch_scc1 L_p2_d2
    s_mov_b32 s16, s44
    s_and_b32 s17, s45, 0xffff
    s_mov_b32 s18, 0x280000
    s_mov_b32 s19, 0x00020000
    buffer_load_dwordx4 v[216:219], v215, s[16:19], 0 offen offset:0
    buffer_load_dwordx4 v[220:223], v215, s[16:19], 0 offen offset:32
    buffer_load_dwordx4 v[224:227], v215, s[16:19], 0 offen offset:64
    buffer_load_dwordx4 v[228:231], v215, s[16:19], 0 offen offset:96
L_p2_d2:
    s_nop 4
    v_pk_add_f32 v[8:9], v[168:169], v[170:171]
    v_pk_add_f32 v[8:9], v[8:9], v[172:173]
    v_pk_add_f32 v[8:9], v[8:9], v[174:175]
    v_pk_add_f32 v[8:9], v[8:9], v[176:177]
    v_pk_add_f32 v[8:9], v[8:9], v[178:179]
    v_pk_add_f32 v[8:9], v[8:9], v[184:185]
    v_pk_add_f32 v[8:9], v[8:9], v[186:187]
    v_pk_add_f32 v[8:9], v[8:9], v[188:189]
    v_pk_add_f32 v[8:9], v[8:9], v[190:191]
    v_pk_add_f32 v[8:9], v[8:9], v[192:193]
    v_pk_add_f32 v[8:9], v[8:9], v[194:195]
    v_add_f32 v8, v8, v9
    v_add_f32 v9, v176, v192
    v_min_f32 v10, v176, v192
    s_mov_b32 s25, 0x7b800000
    v_cmp_nlt_f32 s[36:37], |v8|, s25
    s_mov_b32 s25, 0x5d800000
    s_mov_b32 s26, 0x21800000
    v_cmp_nlt_f32 vcc, |v9|, s25
    v_cmp_ngt_f32 s[90:91], v10, s26
    s_nop 1
    s_or_b64 vcc, vcc, s[90:91]
    s_andn2_b64 vcc, vcc, s[34:35]
    s_or_b64 s[36:37], s[36:37], vcc
    s_cbranch_scc0 L_p2_merge
    s_waitcnt vmcnt(0)
    s_mov_b32 s22, 40960
    s_mov_b32 s28, s42
    s_mov_b32 s29, s43
    v_mov_b32 v168, 0
    v_mov_b32 v169, 0
    v_mov_b32 v170, 0
    v_mov_b32 v171, 0
    v_mov_b32 v172, 0
    v_mov_b32 v173, 0
    v_mov_b32 v174, 0
    v_mov_b32 v175, 0
    v_mov_b32 v176, 0
    v_mov_b32 v177, 0
    v_mov_b32 v178, 0
    v_mov_b32 v179, 0
    v_mov_b32 v180, 0
    v_mov_b32 v181, 0
    v_mov_b32 v182, 0
    v_mov_b32 v183, 0
    v_mov_b32 v16, 0xff800000
    v_mov_b32 v184, 0
    v_mov_b32 v185, 0
    v_mov_b32 v186, 0
    v_mov_b32 v187, 0
    v_mov_b32 v188, 0
    v_mov_b32 v189, 0
    v_mov_b32 v190, 0
    v_mov_b32 v191, 0
    v_mov_b32 v192, 0
    v_mov_b32 v193, 0
    v_mov_b32 v194, 0
    v_mov_b32 v195, 0
    v_mov_b32 v196, 0
    v_mov_b32 v197, 0
    v_mov_b32 v198, 0
    v_mov_b32 v199, 0
    v_mov_b32 v17, 0xff800000
    s_mov_b32 s27, 0
L_p2_fb:
    buffer_load_dwordx2 v[48:49], v5, s[4:7], s28 offen
    buffer_load_dwordx4 v[32:35], v4, s[4:7], s28 offen
    s_add_u32 s28, s28, 512
    s_mov_b64 exec, s[32:33]
    buffer_load_dwordx4 v[56:59], v6, s[4:7], s29 offen
    buffer_load_dwordx4 v[60:63], v7, s[4:7], s29 offen
    s_mov_b64 exec, -1
    s_add_u32 s29, s29, s22
    s_waitcnt vmcnt(0)
    v_mfma_f32_32x32x16_bf16 v[120:135], v[32:35], v[20:23], 0
    v_mfma_f32_32x32x8_bf16 v[120:135], v[48:49], v[28:29], v[120:135]
    v_mfma_f32_32x32x16_bf16 v[136:151], v[32:35], v[24:27], 0
    v_mfma_f32_32x32x8_bf16 v[136:151], v[48:49], v[30:31], v[136:151]
    s_nop 9
    v_max3_f32 v10, v120, v121, v122
    v_max3_f32 v10, v10, v123, v124
    v_max3_f32 v10, v10, v125, v126
    v_max3_f32 v10, v10, v127, v128
    v_max3_f32 v10, v10, v129, v130
    v_max3_f32 v10, v10, v131, v132
    v_max3_f32 v10, v10, v133, v134
    v_max_f32 v10, v10, v135
    v_mov_b32 v8, v10
    s_nop 1
    v_permlane32_swap_b32 v10, v8
    v_max_f32 v10, v10, v8
    v_max_f32 v10, v10, v16
    v_sub_f32 v11, v16, v10
    v_exp_f32 v11, v11
    v_mov_b32 v16, v10
    v_mul_f32 v168, v168, v11
    v_mul_f32 v169, v169, v11
    v_mul_f32 v170, v170, v11
    v_mul_f32 v171, v171, v11
    v_mul_f32 v172, v172, v11
    v_mul_f32 v173, v173, v11
    v_mul_f32 v174, v174, v11
    v_mul_f32 v175, v175, v11
    v_mul_f32 v176, v176, v11
    v_mul_f32 v177, v177, v11
    v_mul_f32 v178, v178, v11
    v_mul_f32 v179, v179, v11
    v_mul_f32 v180, v180, v11
    v_mul_f32 v181, v181, v11
    v_mul_f32 v182, v182, v11
    v_mul_f32 v183, v183, v11
    v_sub_f32 v120, v120, v10
    v_sub_f32 v121, v121, v10
    v_sub_f32 v122, v122, v10
    v_sub_f32 v123, v123, v10
    v_sub_f32 v124, v124, v10
    v_sub_f32 v125, v125, v10
    v_sub_f32 v126, v126, v10
    v_sub_f32 v127, v127, v10
    v_sub_f32 v128, v128, v10
    v_sub_f32 v129, v129, v10
    v_sub_f32 v130, v130, v10
    v_sub_f32 v131, v131, v10
    v_sub_f32 v132, v132, v10
    v_sub_f32 v133, v133, v10
    v_sub_f32 v134, v134, v10
    v_sub_f32 v135, v135, v10
    v_exp_f32 v120, v120
    v_exp_f32 v121, v121
    v_exp_f32 v122, v122
    v_exp_f32 v123, v123
    v_exp_f32 v124, v124
    v_exp_f32 v125, v125
    v_exp_f32 v126, v126
    v_exp_f32 v127, v127
    v_exp_f32 v128, v128
    v_exp_f32 v129, v129
    v_exp_f32 v130, v130
    v_exp_f32 v131, v131
    v_exp_f32 v132, v132
    v_exp_f32 v133, v133
    v_exp_f32 v134, v134
    v_exp_f32 v135, v135
    v_cvt_pk_bf16_f32 v152, v120, v121
    v_cvt_pk_bf16_f32 v153, v122, v123
    v_cvt_pk_bf16_f32 v154, v124, v125
    v_cvt_pk_bf16_f32 v155, v126, v127
    v_cvt_pk_bf16_f32 v156, v128, v129
    v_cvt_pk_bf16_f32 v157, v130, v131
    v_cvt_pk_bf16_f32 v158, v132, v133
    v_cvt_pk_bf16_f32 v159, v134, v135
    v_mfma_f32_32x32x16_bf16 v[168:183], v[56:59], v[152:155], v[168:183]
    s_nop 0
    v_mfma_f32_32x32x16_bf16 v[168:183], v[60:63], v[156:159], v[168:183]
    v_max3_f32 v10, v136, v137, v138
    v_max3_f32 v10, v10, v139, v140
    v_max3_f32 v10, v10, v141, v142
    v_max3_f32 v10, v10, v143, v144
    v_max3_f32 v10, v10, v145, v146
    v_max3_f32 v10, v10, v147, v148
    v_max3_f32 v10, v10, v149, v150
    v_max_f32 v10, v10, v151
    v_mov_b32 v8, v10
    s_nop 1
    v_permlane32_swap_b32 v10, v8
    v_max_f32 v10, v10, v8
    v_max_f32 v10, v10, v17
    v_sub_f32 v11, v17, v10
    v_exp_f32 v11, v11
    v_mov_b32 v17, v10
    v_mul_f32 v184, v184, v11
    v_mul_f32 v185, v185, v11
    v_mul_f32 v186, v186, v11
    v_mul_f32 v187, v187, v11
    v_mul_f32 v188, v188, v11
    v_mul_f32 v189, v189, v11
    v_mul_f32 v190, v190, v11
    v_mul_f32 v191, v191, v11
    v_mul_f32 v192, v192, v11
    v_mul_f32 v193, v193, v11
    v_mul_f32 v194, v194, v11
    v_mul_f32 v195, v195, v11
    v_mul_f32 v196, v196, v11
    v_mul_f32 v197, v197, v11
    v_mul_f32 v198, v198, v11
    v_mul_f32 v199, v199, v11
    v_sub_f32 v136, v136, v10
    v_sub_f32 v137, v137, v10
    v_sub_f32 v138, v138, v10
    v_sub_f32 v139, v139, v10
    v_sub_f32 v140, v140, v10
    v_sub_f32 v141, v141, v10
    v_sub_f32 v142, v142, v10
    v_sub_f32 v143, v143, v10
    v_sub_f32 v144, v144, v10
    v_sub_f32 v145, v145, v10
    v_sub_f32 v146, v146, v10
    v_sub_f32 v147, v147, v10
    v_sub_f32 v148, v148, v10
    v_sub_f32 v149, v149, v10
    v_sub_f32 v150, v150, v10
    v_sub_f32 v151, v151, v10
    v_exp_f32 v136, v136
    v_exp_f32 v137, v137
    v_exp_f32 v138, v138
    v_exp_f32 v139, v139
    v_exp_f32 v140, v140
    v_exp_f32 v141, v141
    v_exp_f32 v142, v142
    v_exp_f32 v143, v143
    v_exp_f32 v144, v144
    v_exp_f32 v145, v145
    v_exp_f32 v146, v146
    v_exp_f32 v147, v147
    v_exp_f32 v148, v148
    v_exp_f32 v149, v149
    v_exp_f32 v150, v150
    v_exp_f32 v151, v151
    v_cvt_pk_bf16_f32 v160, v136, v137
    v_cvt_pk_bf16_f32 v161, v138, v139
    v_cvt_pk_bf16_f32 v162, v140, v141
    v_cvt_pk_bf16_f32 v163, v142, v143
    v_cvt_pk_bf16_f32 v164, v144, v145
    v_cvt_pk_bf16_f32 v165, v146, v147
    v_cvt_pk_bf16_f32 v166, v148, v149
    v_cvt_pk_bf16_f32 v167, v150, v151
    v_mfma_f32_32x32x16_bf16 v[184:199], v[56:59], v[160:163], v[184:199]
    s_nop 0
    v_mfma_f32_32x32x16_bf16 v[184:199], v[60:63], v[164:167], v[184:199]
    s_nop 7
    s_nop 7
    s_add_u32 s27, s27, 1
    s_cmp_lt_u32 s27, 32
    s_cbranch_scc1 L_p2_fb
L_p2_merge:
    s_mul_i32 s25, s89, 3328
    s_add_u32 s25, s25, 133120
    s_xor_b32 s26, s89, 4
    s_mul_i32 s26, s26, 3328
    s_add_u32 s26, s26, 133120
    v_lshl_add_u32 v8, v1, 4, s25
    v_lshl_add_u32 v10, v1, 2, s25
    ds_write_b128 v8, v[168:171] offset:0
    ds_write_b128 v8, v[172:175] offset:1024
    ds_write_b128 v8, v[176:179] offset:2048
    ds_write_b32 v10, v16 offset:3072
    v_lshl_add_u32 v9, v1, 4, s26
    v_lshl_add_u32 v11, v1, 2, s26
    v_mov_b32 v15, 132096
    s_cmp_lg_u32 s89, 5
    s_cbranch_scc1 L_p2_nl
    v_cmp_ne_u32 vcc, s88, v208
    v_cmp_ne_u32 s[90:91], s51, v209
    s_nop 1
    s_or_b64 vcc, vcc, s[90:91]
    s_cselect_b32 s25, 0, 1
    v_mov_b32 v208, s25
    v_mov_b32 v209, s88
    ds_write_b64 v15, v[208:209]
L_p2_nl:
    s_waitcnt lgkmcnt(0)
    s_barrier
    ds_read_b32 v132, v11 offset:3072
    ds_read_b128 v[120:123], v9 offset:0
    ds_read_b128 v[124:127], v9 offset:1024
    ds_read_b128 v[128:131], v9 offset:2048
    ds_read_b64 v[208:209], v15
    s_add_u32 s25, s58, 0
    s_waitcnt lgkmcnt(4)
    v_max_f32 v10, v17, v132
    v_sub_f32 v11, v17, v10
    v_sub_f32 v12, v132, v10
    v_exp_f32 v11, v11
    v_exp_f32 v12, v12
    v_mul_f32 v13, v192, v11
    s_waitcnt lgkmcnt(0)
    v_fmac_f32 v13, v128, v12
    v_readfirstlane_b32 s95, v208
    v_readfirstlane_b32 s88, v209
    s_mov_b64 vcc, 0
    v_mov_b32 v14, v13
    s_nop 1
    v_permlane32_swap_b32 v13, v14
    v_rcp_f32 v14, v14
    s_nop 0
    v_mul_f32 v10, v11, v14
    v_mul_f32 v11, v12, v14
    v_pk_mul_f32 v[184:185], v[184:185], v[10:11] op_sel_hi:[1,0]
    v_pk_mul_f32 v[186:187], v[186:187], v[10:11] op_sel_hi:[1,0]
    v_pk_mul_f32 v[188:189], v[188:189], v[10:11] op_sel_hi:[1,0]
    v_pk_mul_f32 v[190:191], v[190:191], v[10:11] op_sel_hi:[1,0]
    v_pk_mul_f32 v[192:193], v[192:193], v[10:11] op_sel_hi:[1,0]
    v_pk_mul_f32 v[194:195], v[194:195], v[10:11] op_sel_hi:[1,0]
    v_pk_fma_f32 v[184:185], v[120:121], v[10:11], v[184:185] op_sel:[0,1,0] op_sel_hi:[1,1,1]
    v_pk_fma_f32 v[186:187], v[122:123], v[10:11], v[186:187] op_sel:[0,1,0] op_sel_hi:[1,1,1]
    v_pk_fma_f32 v[188:189], v[124:125], v[10:11], v[188:189] op_sel:[0,1,0] op_sel_hi:[1,1,1]
    v_pk_fma_f32 v[190:191], v[126:127], v[10:11], v[190:191] op_sel:[0,1,0] op_sel_hi:[1,1,1]
    v_pk_fma_f32 v[192:193], v[128:129], v[10:11], v[192:193] op_sel:[0,1,0] op_sel_hi:[1,1,1]
    v_pk_fma_f32 v[194:195], v[130:131], v[10:11], v[194:195] op_sel:[0,1,0] op_sel_hi:[1,1,1]
    v_cvt_pk_bf16_f32 v152, v184, v185
    v_cvt_pk_bf16_f32 v153, v186, v187
    v_cvt_pk_bf16_f32 v154, v188, v189
    v_cvt_pk_bf16_f32 v155, v190, v191
    v_cvt_pk_bf16_f32 v156, v192, v193
    v_cvt_pk_bf16_f32 v157, v194, v195
    v_permlane32_swap_b32 v152, v154
    v_permlane32_swap_b32 v153, v155
    s_cbranch_vccz L_slow0
    buffer_store_dwordx4 v[152:155], v4, s[52:55], s25 offen
    s_mov_b32 exec_hi, 0
    buffer_store_dwordx2 v[156:157], v5, s[52:55], s25 offen
    s_mov_b32 exec_hi, -1
L_back0:
    s_lshl_b32 s94, s21, 5
    s_add_u32 s94, s94, s20
    s_load_dwordx2 s[42:43], s[0:1], 32
    s_load_dwordx4 s[44:47], s[0:1], 48
    s_load_dwordx2 s[56:57], s[0:1], 64
    s_lshr_b32 s31, s2, 3
    s_and_b32 s32, s2, 7
    s_mul_i32 s21, s31, 43
    s_lshr_b32 s21, s21, 7
    s_mul_i32 s24, s21, 3
    s_sub_u32 s20, s31, s24
    s_and_b32 s29, s31, 1
    s_lshr_b32 s30, s31, 1
    s_and_b32 s22, s89, 3
    s_cmp_lt_u32 s89, 4
    s_cbranch_scc1 L_p3_compute
    v_lshrrev_b32 v12, 3, v1
    v_and_b32 v13, 7, v1
    v_bfe_u32 v14, v1, 4, 1
    v_lshlrev_b32 v14, 2, v14
    v_xor_b32 v13, v13, v14
    v_mul_u32_u24 v12, 1280, v12
    v_lshl_add_u32 v4, v13, 4, v12
    v_add_u32 v5, 9216, v4
    v_add_u32 v6, 18432, v4
    v_add_u32 v7, 27648, v4
    s_mul_i32 s27, s22, 40960
    s_lshl_b32 s24, s21, 7
    s_add_u32 s27, s27, s24
    s_add_u32 s37, s27, 2293760
    s_lshl_b32 s33, s22, 12
    v_lshrrev_b32 v12, 4, v1
    v_and_b32 v13, 15, v1
    v_lshlrev_b32 v14, 2, v12
    v_xor_b32 v13, v13, v14
    v_mul_u32_u24 v12, 3456, v12
    v_lshl_add_u32 v8, v13, 4, v12
    v_add_u32 v9, 12800, v8
    v_add_u32 v10, 25600, v8
    v_add_u32 v11, 38400, v8
    s_mul_i32 s26, s22, 55296
    s_lshl_b32 s24, s30, 8
    s_add_u32 s26, s26, s24
    s_add_u32 s26, s26, 663552
    s_lshl_b32 s23, s30, 10
    s_lshl_b32 s24, s22, 8
    s_add_u32 s23, s23, s24
    s_add_u32 s23, s23, 20381696
    v_lshlrev_b32 v15, 2, v1
    v_add_u32 v14, s24, v15
    v_add_u32 v14, 131072, v14
    s_waitcnt lgkmcnt(0)
    s_mov_b32 s12, s42
    s_and_b32 s13, s43, 0xffff
    s_mov_b32 s14, 0x21c000
    s_mov_b32 s15, 0x00020000
    s_mov_b32 s16, s44
    s_and_b32 s17, s45, 0xffff
    s_mov_b32 s18, 0x21c000
    s_mov_b32 s19, 0x00020000
    s_mov_b32 s4, s40
    s_and_b32 s5, s41, 0xffff
    s_mov_b32 s6, 0x1428800
    s_mov_b32 s7, 0x00020000
    s_lshl_b32 s34, s31, 2
    s_add_u32 s34, s34, s22
    s_lshl_b32 s28, s32, 12
    v_lshl_add_u32 v16, v2, 7, s28
    v_lshl_add_u32 v17, v3, 15, v16
    s_waitcnt vmcnt(0)
    s_barrier
    s_cmp_ge_u32 s31, 30
    s_cbranch_scc1 L_exit
    s_barrier
    s_cmp_ge_u32 s31, 28
    s_cbranch_scc1 L_p3_lskip4
    s_barrier
    s_barrier
    s_barrier
    s_barrier
    s_barrier
    s_add_u32 m0, s33, 0
    s_nop 0
    buffer_load_dwordx4 v8, s[12:15], s26 offen offset:0 lds
    buffer_load_dwordx4 v9, s[12:15], s26 offen offset:1024 lds
    buffer_load_dwordx4 v10, s[12:15], s26 offen offset:2048 lds
    buffer_load_dwordx4 v11, s[12:15], s26 offen offset:3072 lds
    s_add_u32 s26, s26, 221184
    s_add_u32 m0, s33, 16384
    s_nop 0
    buffer_load_dwordx4 v8, s[12:15], s26 offen offset:0 lds
    buffer_load_dwordx4 v9, s[12:15], s26 offen offset:1024 lds
    buffer_load_dwordx4 v10, s[12:15], s26 offen offset:2048 lds
    buffer_load_dwordx4 v11, s[12:15], s26 offen offset:3072 lds
    s_add_u32 s26, s26, 221184
    s_add_u32 m0, s33, 32768
    s_nop 0
    buffer_load_dwordx4 v8, s[12:15], s26 offen offset:0 lds
    buffer_load_dwordx4 v9, s[12:15], s26 offen offset:1024 lds
    buffer_load_dwordx4 v10, s[12:15], s26 offen offset:2048 lds
    buffer_load_dwordx4 v11, s[12:15], s26 offen offset:3072 lds
    s_add_u32 s26, s26, 221184
    s_barrier
    s_barrier
    buffer_load_dword v13, v15, s[4:7], s23 offen sc1
    s_barrier
    s_add_u32 m0, s33, 49152
    s_nop 0
    buffer_load_dwordx4 v8, s[12:15], s26 offen offset:0 lds
    buffer_load_dwordx4 v9, s[12:15], s26 offen offset:1024 lds
    buffer_load_dwordx4 v10, s[12:15], s26 offen offset:2048 lds
    s_barrier
    buffer_load_dwordx4 v11, s[12:15], s26 offen offset:3072 lds
    s_add_u32 s26, s26, 221184
    s_add_u32 m0, s33, 65536
    s_nop 0
    buffer_load_dwordx4 v8, s[12:15], s26 offen offset:0 lds
    buffer_load_dwordx4 v9, s[12:15], s26 offen offset:1024 lds
    s_barrier
    buffer_load_dwordx4 v10, s[12:15], s26 offen offset:2048 lds
    buffer_load_dwordx4 v11, s[12:15], s26 offen offset:3072 lds
    s_add_u32 s26, s26, 221184
    s_add_u32 m0, s33, 81920
    s_nop 0
    buffer_load_dwordx4 v8, s[12:15], s26 offen offset:0 lds
    s_waitcnt vmcnt(18)
    s_barrier
    buffer_load_dwordx4 v9, s[12:15], s26 offen offset:1024 lds
    buffer_load_dwordx4 v10, s[12:15], s26 offen offset:2048 lds
    buffer_load_dwordx4 v11, s[12:15], s26 offen offset:3072 lds
    s_add_u32 s26, s26, 221184
    s_waitcnt vmcnt(17)
    s_barrier
    s_add_u32 m0, s33, 98304
    s_nop 0
    buffer_load_dwordx4 v8, s[12:15], s26 offen offset:0 lds
    buffer_load_dwordx4 v9, s[12:15], s26 offen offset:1024 lds
    buffer_load_dwordx4 v10, s[12:15], s26 offen offset:2048 lds
    s_waitcnt vmcnt(16)
    s_barrier
    buffer_load_dwordx4 v11, s[12:15], s26 offen offset:3072 lds
    s_add_u32 s26, s26, 221184
    s_add_u32 m0, s33, 114688
    s_nop 0
    buffer_load_dwordx4 v4, s[16:19], s27 offen offset:0 lds
    buffer_load_dwordx4 v5, s[16:19], s27 offen offset:1024 lds
    s_waitcnt vmcnt(14)
    s_barrier
    ds_write_b32 v14, v13
    buffer_load_dwordx4 v6, s[16:19], s27 offen offset:2048 lds
    buffer_load_dwordx4 v7, s[16:19], s27 offen offset:3072 lds
    s_add_u32 s27, s27, 163840
    s_add_u32 m0, s33, 0
    s_nop 0
    buffer_load_dwordx4 v4, s[16:19], s27 offen offset:0 lds
    s_waitcnt vmcnt(13)
    s_barrier
    buffer_load_dwordx4 v5, s[16:19], s27 offen offset:1024 lds
    buffer_load_dwordx4 v6, s[16:19], s27 offen offset:2048 lds
    buffer_load_dwordx4 v7, s[16:19], s27 offen offset:3072 lds
    s_add_u32 s27, s27, 163840
    s_waitcnt vmcnt(12)
    s_barrier
    s_add_u32 m0, s33, 16384
    s_nop 0
    buffer_load_dwordx4 v4, s[16:19], s27 offen offset:0 lds
    buffer_load_dwordx4 v5, s[16:19], s27 offen offset:1024 lds
    buffer_load_dwordx4 v6, s[16:19], s27 offen offset:2048 lds
    s_waitcnt vmcnt(11)
    s_barrier
    buffer_load_dwordx4 v7, s[16:19], s27 offen offset:3072 lds
    s_add_u32 s27, s27, 163840
    s_add_u32 m0, s33, 32768
    s_nop 0
    buffer_load_dwordx4 v4, s[16:19], s27 offen offset:0 lds
    buffer_load_dwordx4 v5, s[16:19], s27 offen offset:1024 lds
    s_waitcnt lgkmcnt(0)
    s_barrier
    s_waitcnt vmcnt(6)
    buffer_load_dwordx4 v6, s[16:19], s27 offen offset:2048 lds
    buffer_load_dwordx4 v7, s[16:19], s27 offen offset:3072 lds
    s_add_u32 s27, s27, 163840
    s_waitcnt vmcnt(6)
    s_add_u32 m0, s33, 49152
    s_nop 0
    buffer_load_dwordx4 v4, s[16:19], s27 offen offset:0 lds
    buffer_load_dwordx4 v5, s[16:19], s27 offen offset:1024 lds
    s_waitcnt vmcnt(6)
    buffer_load_dwordx4 v6, s[16:19], s27 offen offset:2048 lds
    buffer_load_dwordx4 v7, s[16:19], s27 offen offset:3072 lds
    s_add_u32 s27, s27, 163840
    s_waitcnt vmcnt(6)
    s_add_u32 m0, s33, 65536
    s_nop 0
    buffer_load_dwordx4 v4, s[16:19], s27 offen offset:0 lds
    buffer_load_dwordx4 v5, s[16:19], s27 offen offset:1024 lds
    s_waitcnt vmcnt(6)
    buffer_load_dwordx4 v6, s[16:19], s27 offen offset:2048 lds
    buffer_load_dwordx4 v7, s[16:19], s27 offen offset:3072 lds
    s_add_u32 s27, s27, 163840
    s_waitcnt vmcnt(6)
    s_add_u32 m0, s33, 81920
    s_nop 0
    buffer_load_dwordx4 v4, s[16:19], s27 offen offset:0 lds
    buffer_load_dwordx4 v5, s[16:19], s27 offen offset:1024 lds
    s_waitcnt vmcnt(6)
    buffer_load_dwordx4 v6, s[16:19], s27 offen offset:2048 lds
    buffer_load_dwordx4 v7, s[16:19], s27 offen offset:3072 lds
    s_add_u32 s27, s27, 163840
    s_waitcnt vmcnt(6)
    s_add_u32 m0, s33, 98304
    s_nop 0
    buffer_load_dwordx4 v4, s[16:19], s27 offen offset:0 lds
    buffer_load_dwordx4 v5, s[16:19], s27 offen offset:1024 lds
    s_waitcnt vmcnt(6)
    buffer_load_dwordx4 v6, s[16:19], s27 offen offset:2048 lds
    buffer_load_dwordx4 v7, s[16:19], s27 offen offset:3072 lds
    s_add_u32 s27, s27, 163840
    s_barrier
    s_branch L_p3_l5
L_p3_lskip4:
    s_barrier
    s_barrier
    s_barrier
    s_barrier
    s_barrier
    s_barrier
    s_add_u32 m0, s33, 114688
    s_nop 0
    buffer_load_dwordx4 v4, s[16:19], s27 offen offset:0 lds
    buffer_load_dwordx4 v5, s[16:19], s27 offen offset:1024 lds
    buffer_load_dwordx4 v6, s[16:19], s27 offen offset:2048 lds
    buffer_load_dwordx4 v7, s[16:19], s27 offen offset:3072 lds
    s_add_u32 s27, s27, 163840
    s_add_u32 m0, s33, 0
    s_nop 0
    buffer_load_dwordx4 v4, s[16:19], s27 offen offset:0 lds
    buffer_load_dwordx4 v5, s[16:19], s27 offen offset:1024 lds
    buffer_load_dwordx4 v6, s[16:19], s27 offen offset:2048 lds
    buffer_load_dwordx4 v7, s[16:19], s27 offen offset:3072 lds
    s_add_u32 s27, s27, 163840
    s_add_u32 m0, s33, 16384
    s_nop 0
    buffer_load_dwordx4 v4, s[16:19], s27 offen offset:0 lds
    buffer_load_dwordx4 v5, s[16:19], s27 offen offset:1024 lds
    buffer_load_dwordx4 v6, s[16:19], s27 offen offset:2048 lds
    buffer_load_dwordx4 v7, s[16:19], s27 offen offset:3072 lds
    s_add_u32 s27, s27, 163840
    s_add_u32 m0, s33, 32768
    s_nop 0
    buffer_load_dwordx4 v4, s[16:19], s27 offen offset:0 lds
    buffer_load_dwordx4 v5, s[16:19], s27 offen offset:1024 lds
    buffer_load_dwordx4 v6, s[16:19], s27 offen offset:2048 lds
    buffer_load_dwordx4 v7, s[16:19], s27 offen offset:3072 lds
    s_add_u32 s27, s27, 163840
    s_add_u32 m0, s33, 49152
    s_nop 0
    buffer_load_dwordx4 v4, s[16:19], s27 offen offset:0 lds
    buffer_load_dwordx4 v5, s[16:19], s27 offen offset:1024 lds
    buffer_load_dwordx4 v6, s[16:19], s27 offen offset:2048 lds
    buffer_load_dwordx4 v7, s[16:19], s27 offen offset:3072 lds
    s_add_u32 s27, s27, 163840
    s_add_u32 m0, s33, 65536
    s_nop 0
    buffer_load_dwordx4 v4, s[16:19], s27 offen offset:0 lds
    buffer_load_dwordx4 v5, s[16:19], s27 offen offset:1024 lds
    buffer_load_dwordx4 v6, s[16:19], s27 offen offset:2048 lds
    buffer_load_dwordx4 v7, s[16:19], s27 offen offset:3072 lds
    s_add_u32 s27, s27, 163840
    s_add_u32 m0, s33, 81920
    s_nop 0
    buffer_load_dwordx4 v4, s[16:19], s27 offen offset:0 lds
    buffer_load_dwordx4 v5, s[16:19], s27 offen offset:1024 lds
    buffer_load_dwordx4 v6, s[16:19], s27 offen offset:2048 lds
    buffer_load_dwordx4 v7, s[16:19], s27 offen offset:3072 lds
    s_add_u32 s27, s27, 163840
    s_add_u32 m0, s33, 98304
    s_nop 0
    buffer_load_dwordx4 v4, s[16:19], s27 offen offset:0 lds
    buffer_load_dwordx4 v5, s[16:19], s27 offen offset:1024 lds
    buffer_load_dwordx4 v6, s[16:19], s27 offen offset:2048 lds
    buffer_load_dwordx4 v7, s[16:19], s27 offen offset:3072 lds
    s_add_u32 s27, s27, 163840
L_p3_l5:
    s_waitcnt vmcnt(0)
    s_barrier
    s_cmp_lg_u32 s22, 3
    s_cbranch_scc1 L_exit
    s_sub_u32 s27, s27, 122880
    s_barrier
    s_barrier
    s_barrier
    s_mov_b32 m0, 114688
    s_nop 0
    buffer_load_dwordx4 v4, s[16:19], s27 offen offset:0 lds
    buffer_load_dwordx4 v5, s[16:19], s27 offen offset:1024 lds
    buffer_load_dwordx4 v6, s[16:19], s27 offen offset:2048 lds
    buffer_load_dwordx4 v7, s[16:19], s27 offen offset:3072 lds
    s_add_u32 s27, s27, 40960
    s_mov_b32 m0, 118784
    s_nop 0
    buffer_load_dwordx4 v4, s[16:19], s27 offen offset:0 lds
    buffer_load_dwordx4 v5, s[16:19], s27 offen offset:1024 lds
    buffer_load_dwordx4 v6, s[16:19], s27 offen offset:2048 lds
    buffer_load_dwordx4 v7, s[16:19], s27 offen offset:3072 lds
    s_add_u32 s27, s27, 40960
    s_mov_b32 m0, 122880
    s_nop 0
    buffer_load_dwordx4 v4, s[16:19], s27 offen offset:0 lds
    s_barrier
    buffer_load_dwordx4 v5, s[16:19], s27 offen offset:1024 lds
    buffer_load_dwordx4 v6, s[16:19], s27 offen offset:2048 lds
    buffer_load_dwordx4 v7, s[16:19], s27 offen offset:3072 lds
    s_add_u32 s27, s27, 40960
    s_mov_b32 m0, 126976
    s_nop 0
    buffer_load_dwordx4 v4, s[16:19], s27 offen offset:0 lds
    buffer_load_dwordx4 v5, s[16:19], s27 offen offset:1024 lds
    buffer_load_dwordx4 v6, s[16:19], s27 offen offset:2048 lds
    buffer_load_dwordx4 v7, s[16:19], s27 offen offset:3072 lds
    s_add_u32 s27, s27, 40960
    s_mov_b32 m0, 0
    s_nop 0
    buffer_load_dwordx4 v4, s[16:19], s27 offen offset:0 lds
    buffer_load_dwordx4 v5, s[16:19], s27 offen offset:1024 lds
    s_barrier
    buffer_load_dwordx4 v6, s[16:19], s27 offen offset:2048 lds
    buffer_load_dwordx4 v7, s[16:19], s27 offen offset:3072 lds
    s_add_u32 s27, s27, 40960
    s_mov_b32 m0, 4096
    s_nop 0
    buffer_load_dwordx4 v4, s[16:19], s27 offen offset:0 lds
    buffer_load_dwordx4 v5, s[16:19], s27 offen offset:1024 lds
    buffer_load_dwordx4 v6, s[16:19], s27 offen offset:2048 lds
    buffer_load_dwordx4 v7, s[16:19], s27 offen offset:3072 lds
    s_add_u32 s27, s27, 40960
    s_mov_b32 m0, 8192
    s_nop 0
    buffer_load_dwordx4 v4, s[16:19], s27 offen offset:0 lds
    buffer_load_dwordx4 v5, s[16:19], s27 offen offset:1024 lds
    buffer_load_dwordx4 v6, s[16:19], s27 offen offset:2048 lds
    s_barrier
    buffer_load_dwordx4 v7, s[16:19], s27 offen offset:3072 lds
    s_add_u32 s27, s27, 40960
    s_mov_b32 m0, 12288
    s_nop 0
    buffer_load_dwordx4 v4, s[16:19], s27 offen offset:0 lds
    buffer_load_dwordx4 v5, s[16:19], s27 offen offset:1024 lds
    buffer_load_dwordx4 v6, s[16:19], s27 offen offset:2048 lds
    buffer_load_dwordx4 v7, s[16:19], s27 offen offset:3072 lds
    s_add_u32 s27, s27, 40960
    s_mov_b32 m0, 16384
    s_nop 0
    buffer_load_dwordx4 v4, s[16:19], s27 offen offset:0 lds
    buffer_load_dwordx4 v5, s[16:19], s27 offen offset:1024 lds
    buffer_load_dwordx4 v6, s[16:19], s27 offen offset:2048 lds
    buffer_load_dwordx4 v7, s[16:19], s27 offen offset:3072 lds
    s_add_u32 s27, s27, 40960
    s_barrier
    s_mov_b32 m0, 20480
    s_nop 0
    buffer_load_dwordx4 v4, s[16:19], s27 offen offset:0 lds
    buffer_load_dwordx4 v5, s[16:19], s27 offen offset:1024 lds
    buffer_load_dwordx4 v6, s[16:19], s27 offen offset:2048 lds
    buffer_load_dwordx4 v7, s[16:19], s27 offen offset:3072 lds
    s_add_u32 s27, s27, 40960
    s_mov_b32 m0, 24576
    s_nop 0
    buffer_load_dwordx4 v4, s[16:19], s27 offen offset:0 lds
    buffer_load_dwordx4 v5, s[16:19], s27 offen offset:1024 lds
    buffer_load_dwordx4 v6, s[16:19], s27 offen offset:2048 lds
    buffer_load_dwordx4 v7, s[16:19], s27 offen offset:3072 lds
    s_add_u32 s27, s27, 40960
    s_mov_b32 m0, 28672
    s_nop 0
    buffer_load_dwordx4 v4, s[16:19], s27 offen offset:0 lds
    s_waitcnt vmcnt(40)
    s_barrier
    buffer_load_dwordx4 v5, s[16:19], s27 offen offset:1024 lds
    buffer_load_dwordx4 v6, s[16:19], s27 offen offset:2048 lds
    buffer_load_dwordx4 v7, s[16:19], s27 offen offset:3072 lds
    s_add_u32 s27, s27, 40960
    s_mov_b32 m0, 32768
    s_nop 0
    buffer_load_dwordx4 v4, s[16:19], s27 offen offset:0 lds
    buffer_load_dwordx4 v5, s[16:19], s27 offen offset:1024 lds
    buffer_load_dwordx4 v6, s[16:19], s27 offen offset:2048 lds
    buffer_load_dwordx4 v7, s[16:19], s27 offen offset:3072 lds
    s_add_u32 s27, s27, 40960
    s_mov_b32 m0, 36864
    s_nop 0
    buffer_load_dwordx4 v4, s[16:19], s27 offen offset:0 lds
    buffer_load_dwordx4 v5, s[16:19], s27 offen offset:1024 lds
    s_waitcnt vmcnt(40)
    s_waitcnt vmcnt(38)
    s_barrier
    buffer_load_dwordx4 v6, s[16:19], s27 offen offset:2048 lds
    buffer_load_dwordx4 v7, s[16:19], s27 offen offset:3072 lds
    s_add_u32 s27, s27, 40960
    s_mov_b32 m0, 40960
    s_nop 0
    buffer_load_dwordx4 v4, s[16:19], s27 offen offset:0 lds
    buffer_load_dwordx4 v5, s[16:19], s27 offen offset:1024 lds
    buffer_load_dwordx4 v6, s[16:19], s27 offen offset:2048 lds
    buffer_load_dwordx4 v7, s[16:19], s27 offen offset:3072 lds
    s_add_u32 s27, s27, 40960
    s_mov_b32 m0, 45056
    s_nop 0
    buffer_load_dwordx4 v4, s[16:19], s27 offen offset:0 lds
    buffer_load_dwordx4 v5, s[16:19], s27 offen offset:1024 lds
    buffer_load_dwordx4 v6, s[16:19], s27 offen offset:2048 lds
    s_waitcnt vmcnt(40)
    s_waitcnt vmcnt(31)
    s_barrier
    buffer_load_dwordx4 v7, s[16:19], s27 offen offset:3072 lds
    s_add_u32 s27, s27, 40960
    s_mov_b32 m0, 49152
    s_nop 0
    buffer_load_dwordx4 v4, s[16:19], s27 offen offset:0 lds
    buffer_load_dwordx4 v5, s[16:19], s27 offen offset:1024 lds
    buffer_load_dwordx4 v6, s[16:19], s27 offen offset:2048 lds
    buffer_load_dwordx4 v7, s[16:19], s27 offen offset:3072 lds
    s_add_u32 s27, s27, 40960
    s_mov_b32 m0, 53248
    s_nop 0
    buffer_load_dwordx4 v4, s[16:19], s27 offen offset:0 lds
    buffer_load_dwordx4 v5, s[16:19], s27 offen offset:1024 lds
    buffer_load_dwordx4 v6, s[16:19], s27 offen offset:2048 lds
    buffer_load_dwordx4 v7, s[16:19], s27 offen offset:3072 lds
    s_add_u32 s27, s27, 40960
    s_waitcnt vmcnt(24)
    s_barrier
    s_mov_b32 m0, 57344
    s_nop 0
    buffer_load_dwordx4 v4, s[16:19], s27 offen offset:0 lds
    buffer_load_dwordx4 v5, s[16:19], s27 offen offset:1024 lds
    buffer_load_dwordx4 v6, s[16:19], s27 offen offset:2048 lds
    buffer_load_dwordx4 v7, s[16:19], s27 offen offset:3072 lds
    s_add_u32 s27, s27, 40960
    s_mov_b32 m0, 61440
    s_nop 0
    buffer_load_dwordx4 v4, s[16:19], s27 offen offset:0 lds
    buffer_load_dwordx4 v5, s[16:19], s27 offen offset:1024 lds
    buffer_load_dwordx4 v6, s[16:19], s27 offen offset:2048 lds
    buffer_load_dwordx4 v7, s[16:19], s27 offen offset:3072 lds
    s_add_u32 s27, s27, 40960
    s_mov_b32 m0, 65536
    s_nop 0
    buffer_load_dwordx4 v4, s[16:19], s27 offen offset:0 lds
    s_waitcnt vmcnt(17)
    s_barrier
    buffer_load_dwordx4 v5, s[16:19], s27 offen offset:1024 lds
    buffer_load_dwordx4 v6, s[16:19], s27 offen offset:2048 lds
    buffer_load_dwordx4 v7, s[16:19], s27 offen offset:3072 lds
    s_add_u32 s27, s27, 40960
    s_mov_b32 m0, 69632
    s_nop 0
    buffer_load_dwordx4 v4, s[16:19], s27 offen offset:0 lds
    buffer_load_dwordx4 v5, s[16:19], s27 offen offset:1024 lds
    buffer_load_dwordx4 v6, s[16:19], s27 offen offset:2048 lds
    buffer_load_dwordx4 v7, s[16:19], s27 offen offset:3072 lds
    s_add_u32 s27, s27, 40960
    s_waitcnt vmcnt(8)
    s_barrier
    s_waitcnt vmcnt(0)
    s_barrier
    s_endpgm
L_p3_compute:
    s_mul_i32 s23, s20, 3
    s_add_u32 s23, s23, s22
    s_cmp_eq_u32 s22, 3
    s_cselect_b32 s25, 8, s23
    s_lshl_b32 s24, s32, 3
    s_add_u32 s23, s23, s24
    s_lshl_b32 s34, s23, 5
    s_mov_b32 s48, 0
    s_mov_b32 s49, 65536
    s_mov_b32 s50, 131072
    s_mov_b32 s51, 196608
    v_add_u32 v12, s34, v2
    v_lshlrev_b32 v8, 15, v3
    v_lshl_add_u32 v8, v12, 4, v8
    s_mov_b32 s26, 0
    s_waitcnt lgkmcnt(0)
    s_mov_b32 s4, s40
    s_and_b32 s5, s41, 0xffff
    s_mov_b32 s6, 0x1428800
    s_mov_b32 s7, 0x00020000
    s_lshl_b32 s24, s21, 7
    v_mul_u32_u24 v13, 1280, v12
    v_lshl_add_u32 v13, v3, 4, v13
    v_add_u32 v13, s24, v13
    s_lshl_b32 s23, s21, 18
    s_add_u32 s23, s23, 2621440
    v_add_u32 v10, s23, v8
    s_lshl_b32 s23, s21, 14
    s_add_u32 s23, s23, 5242880
    v_lshl_add_u32 v9, v12, 3, s23
    v_bfe_u32 v12, v1, 2, 2
    v_lshl_add_u32 v12, v3, 3, v12
    v_lshlrev_b32 v12, 7, v12
    v_bfe_u32 v15, v1, 3, 1
    v_lshl_add_u32 v12, v15, 6, v12
    v_bfe_u32 v15, v1, 4, 1
    v_lshl_add_u32 v12, v15, 5, v12
    v_and_b32 v15, 3, v1
    v_lshl_add_u32 v4, v15, 3, v12
    v_xor_b32 v5, 64, v4
    s_cmp_ge_u32 s25, 8
    s_cbranch_scc1 L_p3_nores
    s_waitcnt vmcnt(0)
    s_barrier
    s_cmp_ge_u32 s31, 30
    s_cbranch_scc1 L_exit
    v_permlane32_swap_b32 v216, v218
    v_permlane32_swap_b32 v217, v219
    v_permlane32_swap_b32 v220, v222
    v_permlane32_swap_b32 v221, v223
    v_permlane32_swap_b32 v224, v226
    v_permlane32_swap_b32 v225, v227
    v_permlane32_swap_b32 v228, v230
    v_permlane32_swap_b32 v229, v231
    v_lshlrev_b32 v48, 16, v216
    v_and_b32 v49, 0xffff0000, v216
    v_lshlrev_b32 v50, 16, v217
    v_and_b32 v51, 0xffff0000, v217
    v_lshlrev_b32 v52, 16, v218
    v_and_b32 v53, 0xffff0000, v218
    v_lshlrev_b32 v54, 16, v219
    v_and_b32 v55, 0xffff0000, v219
    v_lshlrev_b32 v56, 16, v220
    v_and_b32 v57, 0xffff0000, v220
    v_lshlrev_b32 v58, 16, v221
    v_and_b32 v59, 0xffff0000, v221
    v_lshlrev_b32 v60, 16, v222
    v_and_b32 v61, 0xffff0000, v222
    v_lshlrev_b32 v62, 16, v223
    v_and_b32 v63, 0xffff0000, v223
    v_lshlrev_b32 v64, 16, v224
    v_and_b32 v65, 0xffff0000, v224
    v_lshlrev_b32 v66, 16, v225
    v_and_b32 v67, 0xffff0000, v225
    v_lshlrev_b32 v68, 16, v226
    v_and_b32 v69, 0xffff0000, v226
    v_lshlrev_b32 v70, 16, v227
    v_and_b32 v71, 0xffff0000, v227
    v_lshlrev_b32 v72, 16, v228
    v_and_b32 v73, 0xffff0000, v228
    v_lshlrev_b32 v74, 16, v229
    v_and_b32 v75, 0xffff0000, v229
    v_lshlrev_b32 v76, 16, v230
    v_and_b32 v77, 0xffff0000, v230
    v_lshlrev_b32 v78, 16, v231
    v_and_b32 v79, 0xffff0000, v231
    s_barrier
    buffer_load_dwordx4 v[112:115], v8, s[4:7], s26 offen sc1
    s_add_u32 s26, s26, 65536
    buffer_load_dwordx4 v[116:119], v8, s[4:7], s26 offen sc1
    s_add_u32 s26, s26, 65536
    buffer_load_dwordx4 v[120:123], v8, s[4:7], s26 offen sc1
    s_add_u32 s26, s26, 65536
    buffer_load_dwordx4 v[124:127], v8, s[4:7], s26 offen sc1
    s_add_u32 s26, s26, 65536
    buffer_load_dwordx4 v[128:131], v8, s[4:7], s26 offen sc1
    s_add_u32 s26, s26, 65536
    buffer_load_dwordx4 v[132:135], v8, s[4:7], s26 offen sc1
    s_add_u32 s26, s26, 65536
    buffer_load_dwordx4 v[136:139], v8, s[4:7], s26 offen sc1
    s_add_u32 s26, s26, 65536
    buffer_load_dwordx4 v[140:143], v8, s[4:7], s26 offen sc1
    s_add_u32 s26, s26, 65536
    s_barrier
    ds_read_b64_tr_b16 v[80:81], v4 offset:0
    ds_read_b64_tr_b16 v[82:83], v4 offset:512
    ds_read_b64_tr_b16 v[84:85], v5 offset:0
    ds_read_b64_tr_b16 v[86:87], v5 offset:512
    ds_read_b64_tr_b16 v[88:89], v4 offset:2048
    ds_read_b64_tr_b16 v[90:91], v4 offset:2560
    ds_read_b64_tr_b16 v[92:93], v5 offset:2048
    ds_read_b64_tr_b16 v[94:95], v5 offset:2560
    ds_read_b64_tr_b16 v[96:97], v4 offset:4096
    ds_read_b64_tr_b16 v[98:99], v4 offset:4608
    ds_read_b64_tr_b16 v[100:101], v5 offset:4096
    ds_read_b64_tr_b16 v[102:103], v5 offset:4608
    s_waitcnt vmcnt(7) lgkmcnt(10)
    v_mfma_f32_32x32x16_bf16 v[48:63], v[80:83], v[112:115], v[48:63]
    ds_read_b64_tr_b16 v[104:105], v4 offset:6144
    ds_read_b64_tr_b16 v[106:107], v4 offset:6656
    buffer_load_dwordx4 v[144:147], v8, s[4:7], s26 offen sc1
    s_add_u32 s26, s26, 65536
    s_waitcnt lgkmcnt(10)
    v_mfma_f32_32x32x16_bf16 v[64:79], v[84:87], v[112:115], v[64:79]
    ds_read_b64_tr_b16 v[108:109], v5 offset:6144
    ds_read_b64_tr_b16 v[110:111], v5 offset:6656
    buffer_load_dwordx4 v[148:151], v8, s[4:7], s26 offen sc1
    s_add_u32 s26, s26, 65536
    s_waitcnt vmcnt(8) lgkmcnt(10)
    v_mfma_f32_32x32x16_bf16 v[48:63], v[88:91], v[116:119], v[48:63]
    ds_read_b64_tr_b16 v[80:81], v4 offset:8192
    ds_read_b64_tr_b16 v[82:83], v4 offset:8704
    buffer_load_dwordx4 v[152:155], v8, s[4:7], s26 offen sc1
    s_add_u32 s26, s26, 65536
    s_waitcnt lgkmcnt(10)
    v_mfma_f32_32x32x16_bf16 v[64:79], v[92:95], v[116:119], v[64:79]
    ds_read_b64_tr_b16 v[84:85], v5 offset:8192
    ds_read_b64_tr_b16 v[86:87], v5 offset:8704
    buffer_load_dwordx4 v[156:159], v8, s[4:7], s26 offen sc1
    s_add_u32 s26, s26, 65536
    s_waitcnt vmcnt(9) lgkmcnt(10)
    v_mfma_f32_32x32x16_bf16 v[48:63], v[96:99], v[120:123], v[48:63]
    ds_read_b64_tr_b16 v[88:89], v4 offset:10240
    ds_read_b64_tr_b16 v[90:91], v4 offset:10752
    buffer_load_dwordx4 v[160:163], v8, s[4:7], s26 offen sc1
    s_add_u32 s26, s26, 65536
    s_waitcnt lgkmcnt(10)
    v_mfma_f32_32x32x16_bf16 v[64:79], v[100:103], v[120:123], v[64:79]
    ds_read_b64_tr_b16 v[92:93], v5 offset:10240
    ds_read_b64_tr_b16 v[94:95], v5 offset:10752
    buffer_load_dwordx4 v[164:167], v8, s[4:7], s26 offen sc1
    s_add_u32 s26, s26, 65536
    s_waitcnt vmcnt(10) lgkmcnt(10)
    v_mfma_f32_32x32x16_bf16 v[48:63], v[104:107], v[124:127], v[48:63]
    ds_read_b64_tr_b16 v[96:97], v4 offset:12288
    ds_read_b64_tr_b16 v[98:99], v4 offset:12800
    buffer_load_dwordx4 v[168:171], v8, s[4:7], s26 offen sc1
    s_add_u32 s26, s26, 65536
    s_waitcnt lgkmcnt(10)
    v_mfma_f32_32x32x16_bf16 v[64:79], v[108:111], v[124:127], v[64:79]
    ds_read_b64_tr_b16 v[100:101], v5 offset:12288
    ds_read_b64_tr_b16 v[102:103], v5 offset:12800
    buffer_load_dwordx4 v[172:175], v8, s[4:7], s26 offen sc1
    s_add_u32 s26, s26, 65536
    s_waitcnt vmcnt(11) lgkmcnt(10)
    v_mfma_f32_32x32x16_bf16 v[48:63], v[80:83], v[128:131], v[48:63]
    ds_read_b64_tr_b16 v[104:105], v4 offset:14336
    ds_read_b64_tr_b16 v[106:107], v4 offset:14848
    buffer_load_dwordx4 v[176:179], v8, s[4:7], s26 offen sc1
    s_add_u32 s26, s26, 65536
    s_waitcnt lgkmcnt(10)
    v_mfma_f32_32x32x16_bf16 v[64:79], v[84:87], v[128:131], v[64:79]
    ds_read_b64_tr_b16 v[108:109], v5 offset:14336
    ds_read_b64_tr_b16 v[110:111], v5 offset:14848
    buffer_load_dwordx4 v[180:183], v8, s[4:7], s26 offen sc1
    s_add_u32 s26, s26, 65536
    s_waitcnt vmcnt(12) lgkmcnt(10)
    v_mfma_f32_32x32x16_bf16 v[48:63], v[88:91], v[132:135], v[48:63]
    s_barrier
    ds_read_b64_tr_b16 v[80:81], v4 offset:16384
    ds_read_b64_tr_b16 v[82:83], v4 offset:16896
    buffer_load_dwordx4 v[184:187], v8, s[4:7], s26 offen sc1
    s_add_u32 s26, s26, 65536
    s_waitcnt lgkmcnt(10)
    v_mfma_f32_32x32x16_bf16 v[64:79], v[92:95], v[132:135], v[64:79]
    ds_read_b64_tr_b16 v[84:85], v5 offset:16384
    ds_read_b64_tr_b16 v[86:87], v5 offset:16896
    buffer_load_dwordx4 v[188:191], v8, s[4:7], s26 offen sc1
    s_add_u32 s26, s26, 65536
    s_waitcnt vmcnt(13) lgkmcnt(10)
    v_mfma_f32_32x32x16_bf16 v[48:63], v[96:99], v[136:139], v[48:63]
    ds_read_b64_tr_b16 v[88:89], v4 offset:18432
    ds_read_b64_tr_b16 v[90:91], v4 offset:18944
    buffer_load_dwordx4 v[192:195], v8, s[4:7], s26 offen sc1
    s_add_u32 s26, s26, 65536
    s_waitcnt lgkmcnt(10)
    v_mfma_f32_32x32x16_bf16 v[64:79], v[100:103], v[136:139], v[64:79]
    ds_read_b64_tr_b16 v[92:93], v5 offset:18432
    ds_read_b64_tr_b16 v[94:95], v5 offset:18944
    s_waitcnt vmcnt(13) lgkmcnt(10)
    v_mfma_f32_32x32x16_bf16 v[48:63], v[104:107], v[140:143], v[48:63]
    ds_read_b64_tr_b16 v[96:97], v4 offset:20480
    ds_read_b64_tr_b16 v[98:99], v4 offset:20992
    buffer_load_dwordx4 v[196:199], v8, s[4:7], s26 offen sc1
    s_add_u32 s26, s26, 65536
    s_waitcnt lgkmcnt(10)
    v_mfma_f32_32x32x16_bf16 v[64:79], v[108:111], v[140:143], v[64:79]
    ds_read_b64_tr_b16 v[100:101], v5 offset:20480
    ds_read_b64_tr_b16 v[102:103], v5 offset:20992
    s_waitcnt vmcnt(13) lgkmcnt(10)
    v_mfma_f32_32x32x16_bf16 v[48:63], v[80:83], v[144:147], v[48:63]
    ds_read_b64_tr_b16 v[104:105], v4 offset:22528
    ds_read_b64_tr_b16 v[106:107], v4 offset:23040
    buffer_load_dwordx4 v[200:203], v8, s[4:7], s26 offen sc1
    s_add_u32 s26, s26, 65536
    s_waitcnt lgkmcnt(10)
    v_mfma_f32_32x32x16_bf16 v[64:79], v[84:87], v[144:147], v[64:79]
    ds_read_b64_tr_b16 v[108:109], v5 offset:22528
    ds_read_b64_tr_b16 v[110:111], v5 offset:23040
    s_waitcnt vmcnt(13) lgkmcnt(10)
    v_mfma_f32_32x32x16_bf16 v[48:63], v[88:91], v[148:151], v[48:63]
    ds_read_b64_tr_b16 v[80:81], v4 offset:24576
    ds_read_b64_tr_b16 v[82:83], v4 offset:25088
    buffer_load_dwordx4 v[204:207], v8, s[4:7], s26 offen sc1
    s_add_u32 s26, s26, 65536
    s_waitcnt lgkmcnt(10)
    v_mfma_f32_32x32x16_bf16 v[64:79], v[92:95], v[148:151], v[64:79]
    ds_read_b64_tr_b16 v[84:85], v5 offset:24576
    ds_read_b64_tr_b16 v[86:87], v5 offset:25088
    s_waitcnt vmcnt(13) lgkmcnt(10)
    v_mfma_f32_32x32x16_bf16 v[48:63], v[96:99], v[152:155], v[48:63]
    ds_read_b64_tr_b16 v[88:89], v4 offset:26624
    ds_read_b64_tr_b16 v[90:91], v4 offset:27136
    buffer_load_dwordx4 v[208:211], v8, s[4:7], s26 offen sc1
    s_add_u32 s26, s26, 65536
    s_waitcnt lgkmcnt(10)
    v_mfma_f32_32x32x16_bf16 v[64:79], v[100:103], v[152:155], v[64:79]
    ds_read_b64_tr_b16 v[92:93], v5 offset:26624
    ds_read_b64_tr_b16 v[94:95], v5 offset:27136
    s_waitcnt vmcnt(13) lgkmcnt(10)
    v_mfma_f32_32x32x16_bf16 v[48:63], v[104:107], v[156:159], v[48:63]
    ds_read_b64_tr_b16 v[96:97], v4 offset:28672
    ds_read_b64_tr_b16 v[98:99], v4 offset:29184
    buffer_load_dwordx4 v[212:215], v8, s[4:7], s26 offen sc1
    s_add_u32 s26, s26, 65536
    s_waitcnt lgkmcnt(10)
    v_mfma_f32_32x32x16_bf16 v[64:79], v[108:111], v[156:159], v[64:79]
    ds_read_b64_tr_b16 v[100:101], v5 offset:28672
    ds_read_b64_tr_b16 v[102:103], v5 offset:29184
    s_waitcnt vmcnt(13) lgkmcnt(10)
    v_mfma_f32_32x32x16_bf16 v[48:63], v[80:83], v[160:163], v[48:63]
    ds_read_b64_tr_b16 v[104:105], v4 offset:30720
    ds_read_b64_tr_b16 v[106:107], v4 offset:31232
    buffer_load_dwordx4 v[216:219], v8, s[4:7], s26 offen sc1
    s_add_u32 s26, s26, 65536
    s_waitcnt lgkmcnt(10)
    v_mfma_f32_32x32x16_bf16 v[64:79], v[84:87], v[160:163], v[64:79]
    ds_read_b64_tr_b16 v[108:109], v5 offset:30720
    ds_read_b64_tr_b16 v[110:111], v5 offset:31232
    s_waitcnt vmcnt(13) lgkmcnt(10)
    v_mfma_f32_32x32x16_bf16 v[48:63], v[88:91], v[164:167], v[48:63]
    s_barrier
    ds_read_b64_tr_b16 v[80:81], v4 offset:32768
    ds_read_b64_tr_b16 v[82:83], v4 offset:33280
    buffer_load_dwordx4 v[220:223], v8, s[4:7], s26 offen sc1
    s_add_u32 s26, s26, 65536
    s_waitcnt lgkmcnt(10)
    v_mfma_f32_32x32x16_bf16 v[64:79], v[92:95], v[164:167], v[64:79]
    ds_read_b64_tr_b16 v[84:85], v5 offset:32768
    ds_read_b64_tr_b16 v[86:87], v5 offset:33280
    s_waitcnt vmcnt(13) lgkmcnt(10)
    v_mfma_f32_32x32x16_bf16 v[48:63], v[96:99], v[168:171], v[48:63]
    ds_read_b64_tr_b16 v[88:89], v4 offset:34816
    ds_read_b64_tr_b16 v[90:91], v4 offset:35328
    buffer_load_dwordx4 v[224:227], v8, s[4:7], s26 offen sc1
    s_add_u32 s26, s26, 65536
    s_waitcnt lgkmcnt(10)
    v_mfma_f32_32x32x16_bf16 v[64:79], v[100:103], v[168:171], v[64:79]
    ds_read_b64_tr_b16 v[92:93], v5 offset:34816
    ds_read_b64_tr_b16 v[94:95], v5 offset:35328
    s_waitcnt vmcnt(13) lgkmcnt(10)
    v_mfma_f32_32x32x16_bf16 v[48:63], v[104:107], v[172:175], v[48:63]
    ds_read_b64_tr_b16 v[96:97], v4 offset:36864
    ds_read_b64_tr_b16 v[98:99], v4 offset:37376
    buffer_load_dwordx4 v[228:231], v8, s[4:7], s26 offen sc1
    s_add_u32 s26, s26, 65536
    s_waitcnt lgkmcnt(10)
    v_mfma_f32_32x32x16_bf16 v[64:79], v[108:111], v[172:175], v[64:79]
    ds_read_b64_tr_b16 v[100:101], v5 offset:36864
    ds_read_b64_tr_b16 v[102:103], v5 offset:37376
    s_waitcnt vmcnt(13) lgkmcnt(10)
    v_mfma_f32_32x32x16_bf16 v[48:63], v[80:83], v[176:179], v[48:63]
    ds_read_b64_tr_b16 v[104:105], v4 offset:38912
    ds_read_b64_tr_b16 v[106:107], v4 offset:39424
    buffer_load_dwordx4 v[232:235], v8, s[4:7], s26 offen sc1
    s_add_u32 s26, s26, 65536
    s_waitcnt lgkmcnt(10)
    v_mfma_f32_32x32x16_bf16 v[64:79], v[84:87], v[176:179], v[64:79]
    ds_read_b64_tr_b16 v[108:109], v5 offset:38912
    ds_read_b64_tr_b16 v[110:111], v5 offset:39424
    s_waitcnt vmcnt(13) lgkmcnt(10)
    v_mfma_f32_32x32x16_bf16 v[48:63], v[88:91], v[180:183], v[48:63]
    ds_read_b64_tr_b16 v[80:81], v4 offset:40960
    ds_read_b64_tr_b16 v[82:83], v4 offset:41472
    buffer_load_dwordx4 v[236:239], v8, s[4:7], s26 offen sc1
    s_add_u32 s26, s26, 65536
    s_waitcnt lgkmcnt(10)
    v_mfma_f32_32x32x16_bf16 v[64:79], v[92:95], v[180:183], v[64:79]
    ds_read_b64_tr_b16 v[84:85], v5 offset:40960
    ds_read_b64_tr_b16 v[86:87], v5 offset:41472
    s_waitcnt vmcnt(13) lgkmcnt(10)
    v_mfma_f32_32x32x16_bf16 v[48:63], v[96:99], v[184:187], v[48:63]
    ds_read_b64_tr_b16 v[88:89], v4 offset:43008
    ds_read_b64_tr_b16 v[90:91], v4 offset:43520
    buffer_load_dwordx4 v[112:115], v8, s[4:7], s26 offen sc1
    s_add_u32 s26, s26, 65536
    s_waitcnt lgkmcnt(10)
    v_mfma_f32_32x32x16_bf16 v[64:79], v[100:103], v[184:187], v[64:79]
    ds_read_b64_tr_b16 v[92:93], v5 offset:43008
    ds_read_b64_tr_b16 v[94:95], v5 offset:43520
    s_waitcnt vmcnt(13) lgkmcnt(10)
    v_mfma_f32_32x32x16_bf16 v[48:63], v[104:107], v[188:191], v[48:63]
    ds_read_b64_tr_b16 v[96:97], v4 offset:45056
    ds_read_b64_tr_b16 v[98:99], v4 offset:45568
    buffer_load_dwordx4 v[116:119], v8, s[4:7], s26 offen sc1
    s_add_u32 s26, s26, 65536
    s_waitcnt lgkmcnt(10)
    v_mfma_f32_32x32x16_bf16 v[64:79], v[108:111], v[188:191], v[64:79]
    ds_read_b64_tr_b16 v[100:101], v5 offset:45056
    ds_read_b64_tr_b16 v[102:103], v5 offset:45568
    s_waitcnt vmcnt(13) lgkmcnt(10)
    v_mfma_f32_32x32x16_bf16 v[48:63], v[80:83], v[192:195], v[48:63]
    ds_read_b64_tr_b16 v[104:105], v4 offset:47104
    ds_read_b64_tr_b16 v[106:107], v4 offset:47616
    buffer_load_dwordx4 v[120:123], v8, s[4:7], s26 offen sc1
    s_add_u32 s26, s26, 65536
    s_waitcnt lgkmcnt(10)
    v_mfma_f32_32x32x16_bf16 v[64:79], v[84:87], v[192:195], v[64:79]
    ds_read_b64_tr_b16 v[108:109], v5 offset:47104
    ds_read_b64_tr_b16 v[110:111], v5 offset:47616
    s_waitcnt vmcnt(13) lgkmcnt(10)
    v_mfma_f32_32x32x16_bf16 v[48:63], v[88:91], v[196:199], v[48:63]
    s_barrier
    ds_read_b64_tr_b16 v[80:81], v4 offset:49152
    ds_read_b64_tr_b16 v[82:83], v4 offset:49664
    buffer_load_dwordx4 v[124:127], v8, s[4:7], s26 offen sc1
    s_add_u32 s26, s26, 65536
    s_waitcnt lgkmcnt(10)
    v_mfma_f32_32x32x16_bf16 v[64:79], v[92:95], v[196:199], v[64:79]
    ds_read_b64_tr_b16 v[84:85], v5 offset:49152
    ds_read_b64_tr_b16 v[86:87], v5 offset:49664
    s_waitcnt vmcnt(13) lgkmcnt(10)
    v_mfma_f32_32x32x16_bf16 v[48:63], v[96:99], v[200:203], v[48:63]
    ds_read_b64_tr_b16 v[88:89], v4 offset:51200
    ds_read_b64_tr_b16 v[90:91], v4 offset:51712
    buffer_load_dwordx4 v[128:131], v8, s[4:7], s26 offen sc1
    s_add_u32 s26, s26, 65536
    s_waitcnt lgkmcnt(10)
    v_mfma_f32_32x32x16_bf16 v[64:79], v[100:103], v[200:203], v[64:79]
    ds_read_b64_tr_b16 v[92:93], v5 offset:51200
    ds_read_b64_tr_b16 v[94:95], v5 offset:51712
    s_waitcnt vmcnt(13) lgkmcnt(10)
    v_mfma_f32_32x32x16_bf16 v[48:63], v[104:107], v[204:207], v[48:63]
    ds_read_b64_tr_b16 v[96:97], v4 offset:53248
    ds_read_b64_tr_b16 v[98:99], v4 offset:53760
    buffer_load_dwordx4 v[132:135], v8, s[4:7], s26 offen sc1
    s_add_u32 s26, s26, 65536
    s_waitcnt lgkmcnt(10)
    v_mfma_f32_32x32x16_bf16 v[64:79], v[108:111], v[204:207], v[64:79]
    ds_read_b64_tr_b16 v[100:101], v5 offset:53248
    ds_read_b64_tr_b16 v[102:103], v5 offset:53760
    s_waitcnt vmcnt(13) lgkmcnt(10)
    v_mfma_f32_32x32x16_bf16 v[48:63], v[80:83], v[208:211], v[48:63]
    ds_read_b64_tr_b16 v[104:105], v4 offset:55296
    ds_read_b64_tr_b16 v[106:107], v4 offset:55808
    buffer_load_dwordx4 v[136:139], v8, s[4:7], s26 offen sc1
    s_add_u32 s26, s26, 65536
    s_waitcnt lgkmcnt(10)
    v_mfma_f32_32x32x16_bf16 v[64:79], v[84:87], v[208:211], v[64:79]
    ds_read_b64_tr_b16 v[108:109], v5 offset:55296
    ds_read_b64_tr_b16 v[110:111], v5 offset:55808
    s_waitcnt vmcnt(13) lgkmcnt(10)
    v_mfma_f32_32x32x16_bf16 v[48:63], v[88:91], v[212:215], v[48:63]
    ds_read_b64_tr_b16 v[80:81], v4 offset:57344
    ds_read_b64_tr_b16 v[82:83], v4 offset:57856
    buffer_load_dwordx4 v[140:143], v8, s[4:7], s26 offen sc1
    s_add_u32 s26, s26, 65536
    s_waitcnt lgkmcnt(10)
    v_mfma_f32_32x32x16_bf16 v[64:79], v[92:95], v[212:215], v[64:79]
    ds_read_b64_tr_b16 v[84:85], v5 offset:57344
    ds_read_b64_tr_b16 v[86:87], v5 offset:57856
    s_waitcnt vmcnt(13) lgkmcnt(10)
    v_mfma_f32_32x32x16_bf16 v[48:63], v[96:99], v[216:219], v[48:63]
    ds_read_b64_tr_b16 v[88:89], v4 offset:59392
    ds_read_b64_tr_b16 v[90:91], v4 offset:59904
    s_waitcnt lgkmcnt(10)
    v_mfma_f32_32x32x16_bf16 v[64:79], v[100:103], v[216:219], v[64:79]
    ds_read_b64_tr_b16 v[92:93], v5 offset:59392
    ds_read_b64_tr_b16 v[94:95], v5 offset:59904
    s_waitcnt vmcnt(12) lgkmcnt(10)
    v_mfma_f32_32x32x16_bf16 v[48:63], v[104:107], v[220:223], v[48:63]
    ds_read_b64_tr_b16 v[96:97], v4 offset:61440
    ds_read_b64_tr_b16 v[98:99], v4 offset:61952
    s_waitcnt lgkmcnt(10)
    v_mfma_f32_32x32x16_bf16 v[64:79], v[108:111], v[220:223], v[64:79]
    ds_read_b64_tr_b16 v[100:101], v5 offset:61440
    ds_read_b64_tr_b16 v[102:103], v5 offset:61952
    s_waitcnt vmcnt(11) lgkmcnt(10)
    v_mfma_f32_32x32x16_bf16 v[48:63], v[80:83], v[224:227], v[48:63]
    ds_read_b64_tr_b16 v[104:105], v4 offset:63488
    ds_read_b64_tr_b16 v[106:107], v4 offset:64000
    s_waitcnt lgkmcnt(10)
    v_mfma_f32_32x32x16_bf16 v[64:79], v[84:87], v[224:227], v[64:79]
    ds_read_b64_tr_b16 v[108:109], v5 offset:63488
    ds_read_b64_tr_b16 v[110:111], v5 offset:64000
    s_waitcnt vmcnt(10) lgkmcnt(10)
    v_mfma_f32_32x32x16_bf16 v[48:63], v[88:91], v[228:231], v[48:63]
    s_barrier
    v_add_u32 v4, 0x10000, v4
    v_add_u32 v5, 0x10000, v5
    ds_read_b64_tr_b16 v[80:81], v4 offset:0
    ds_read_b64_tr_b16 v[82:83], v4 offset:512
    s_waitcnt lgkmcnt(10)
    v_mfma_f32_32x32x16_bf16 v[64:79], v[92:95], v[228:231], v[64:79]
    ds_read_b64_tr_b16 v[84:85], v5 offset:0
    ds_read_b64_tr_b16 v[86:87], v5 offset:512
    s_waitcnt vmcnt(9) lgkmcnt(10)
    v_mfma_f32_32x32x16_bf16 v[48:63], v[96:99], v[232:235], v[48:63]
    ds_read_b64_tr_b16 v[88:89], v4 offset:2048
    ds_read_b64_tr_b16 v[90:91], v4 offset:2560
    s_waitcnt lgkmcnt(10)
    v_mfma_f32_32x32x16_bf16 v[64:79], v[100:103], v[232:235], v[64:79]
    ds_read_b64_tr_b16 v[92:93], v5 offset:2048
    ds_read_b64_tr_b16 v[94:95], v5 offset:2560
    s_waitcnt vmcnt(8) lgkmcnt(10)
    v_mfma_f32_32x32x16_bf16 v[48:63], v[104:107], v[236:239], v[48:63]
    ds_read_b64_tr_b16 v[96:97], v4 offset:4096
    ds_read_b64_tr_b16 v[98:99], v4 offset:4608
    s_waitcnt lgkmcnt(10)
    v_mfma_f32_32x32x16_bf16 v[64:79], v[108:111], v[236:239], v[64:79]
    ds_read_b64_tr_b16 v[100:101], v5 offset:4096
    ds_read_b64_tr_b16 v[102:103], v5 offset:4608
    s_waitcnt vmcnt(7) lgkmcnt(10)
    v_mfma_f32_32x32x16_bf16 v[48:63], v[80:83], v[112:115], v[48:63]
    ds_read_b64_tr_b16 v[104:105], v4 offset:6144
    ds_read_b64_tr_b16 v[106:107], v4 offset:6656
    s_waitcnt lgkmcnt(10)
    v_mfma_f32_32x32x16_bf16 v[64:79], v[84:87], v[112:115], v[64:79]
    ds_read_b64_tr_b16 v[108:109], v5 offset:6144
    ds_read_b64_tr_b16 v[110:111], v5 offset:6656
    s_waitcnt vmcnt(6) lgkmcnt(10)
    v_mfma_f32_32x32x16_bf16 v[48:63], v[88:91], v[116:119], v[48:63]
    ds_read_b64_tr_b16 v[80:81], v4 offset:8192
    ds_read_b64_tr_b16 v[82:83], v4 offset:8704
    s_waitcnt lgkmcnt(10)
    v_mfma_f32_32x32x16_bf16 v[64:79], v[92:95], v[116:119], v[64:79]
    ds_read_b64_tr_b16 v[84:85], v5 offset:8192
    ds_read_b64_tr_b16 v[86:87], v5 offset:8704
    s_waitcnt vmcnt(5) lgkmcnt(10)
    v_mfma_f32_32x32x16_bf16 v[48:63], v[96:99], v[120:123], v[48:63]
    ds_read_b64_tr_b16 v[88:89], v4 offset:10240
    ds_read_b64_tr_b16 v[90:91], v4 offset:10752
    s_waitcnt lgkmcnt(10)
    v_mfma_f32_32x32x16_bf16 v[64:79], v[100:103], v[120:123], v[64:79]
    ds_read_b64_tr_b16 v[92:93], v5 offset:10240
    ds_read_b64_tr_b16 v[94:95], v5 offset:10752
    s_waitcnt vmcnt(4) lgkmcnt(10)
    v_mfma_f32_32x32x16_bf16 v[48:63], v[104:107], v[124:127], v[48:63]
    ds_read_b64_tr_b16 v[96:97], v4 offset:12288
    ds_read_b64_tr_b16 v[98:99], v4 offset:12800
    s_waitcnt lgkmcnt(10)
    v_mfma_f32_32x32x16_bf16 v[64:79], v[108:111], v[124:127], v[64:79]
    ds_read_b64_tr_b16 v[100:101], v5 offset:12288
    ds_read_b64_tr_b16 v[102:103], v5 offset:12800
    s_waitcnt vmcnt(3) lgkmcnt(10)
    v_mfma_f32_32x32x16_bf16 v[48:63], v[80:83], v[128:131], v[48:63]
    ds_read_b64_tr_b16 v[104:105], v4 offset:14336
    ds_read_b64_tr_b16 v[106:107], v4 offset:14848
    s_waitcnt lgkmcnt(10)
    v_mfma_f32_32x32x16_bf16 v[64:79], v[84:87], v[128:131], v[64:79]
    ds_read_b64_tr_b16 v[108:109], v5 offset:14336
    ds_read_b64_tr_b16 v[110:111], v5 offset:14848
    s_waitcnt vmcnt(2) lgkmcnt(10)
    v_mfma_f32_32x32x16_bf16 v[48:63], v[88:91], v[132:135], v[48:63]
    s_waitcnt lgkmcnt(8)
    v_mfma_f32_32x32x16_bf16 v[64:79], v[92:95], v[132:135], v[64:79]
    s_waitcnt vmcnt(1) lgkmcnt(6)
    v_mfma_f32_32x32x16_bf16 v[48:63], v[96:99], v[136:139], v[48:63]
    s_waitcnt lgkmcnt(4)
    v_mfma_f32_32x32x16_bf16 v[64:79], v[100:103], v[136:139], v[64:79]
    s_waitcnt vmcnt(0) lgkmcnt(2)
    v_mfma_f32_32x32x16_bf16 v[48:63], v[104:107], v[140:143], v[48:63]
    s_waitcnt lgkmcnt(0)
    v_mfma_f32_32x32x16_bf16 v[64:79], v[108:111], v[140:143], v[64:79]
    v_mov_b32 v12, 0
    v_mov_b32 v13, 0
    s_mov_b32 s24, 0x3f803f80
    s_cmp_lg_u32 s95, 0
    s_cselect_b64 vcc, -1, 0
    s_nop 4
    v_cvt_pk_bf16_f32 v16, v48, v49
    v_cvt_pk_bf16_f32 v17, v50, v51
    v_cvt_pk_bf16_f32 v18, v52, v53
    v_cvt_pk_bf16_f32 v19, v54, v55
    v_cvt_pk_bf16_f32 v20, v56, v57
    v_cvt_pk_bf16_f32 v21, v58, v59
    v_cvt_pk_bf16_f32 v22, v60, v61
    v_cvt_pk_bf16_f32 v23, v62, v63
    s_cbranch_vccz L_slow1
    buffer_store_dwordx4 v[16:19], v10, s[4:7], s48 offen
    buffer_store_dwordx4 v[20:23], v10, s[4:7], s49 offen
L_back1:
    v_cvt_pk_bf16_f32 v24, v64, v65
    v_cvt_pk_bf16_f32 v25, v66, v67
    v_cvt_pk_bf16_f32 v26, v68, v69
    v_cvt_pk_bf16_f32 v27, v70, v71
    v_cvt_pk_bf16_f32 v28, v72, v73
    v_cvt_pk_bf16_f32 v29, v74, v75
    v_cvt_pk_bf16_f32 v30, v76, v77
    v_cvt_pk_bf16_f32 v31, v78, v79
    s_cbranch_vccz L_slow2
    buffer_store_dwordx4 v[24:27], v10, s[4:7], s50 offen
    buffer_store_dwordx4 v[28:31], v10, s[4:7], s51 offen
L_back2:
    v_dot2c_f32_bf16 v12, s24, v16
    v_dot2c_f32_bf16 v13, v16, v16
    v_dot2c_f32_bf16 v12, s24, v17
    v_dot2c_f32_bf16 v13, v17, v17
    v_dot2c_f32_bf16 v12, s24, v18
    v_dot2c_f32_bf16 v13, v18, v18
    v_dot2c_f32_bf16 v12, s24, v19
    v_dot2c_f32_bf16 v13, v19, v19
    v_dot2c_f32_bf16 v12, s24, v20
    v_dot2c_f32_bf16 v13, v20, v20
    v_dot2c_f32_bf16 v12, s24, v21
    v_dot2c_f32_bf16 v13, v21, v21
    v_dot2c_f32_bf16 v12, s24, v22
    v_dot2c_f32_bf16 v13, v22, v22
    v_dot2c_f32_bf16 v12, s24, v23
    v_dot2c_f32_bf16 v13, v23, v23
    v_dot2c_f32_bf16 v12, s24, v24
    v_dot2c_f32_bf16 v13, v24, v24
    v_dot2c_f32_bf16 v12, s24, v25
    v_dot2c_f32_bf16 v13, v25, v25
    v_dot2c_f32_bf16 v12, s24, v26
    v_dot2c_f32_bf16 v13, v26, v26
    v_dot2c_f32_bf16 v12, s24, v27
    v_dot2c_f32_bf16 v13, v27, v27
    v_dot2c_f32_bf16 v12, s24, v28
    v_dot2c_f32_bf16 v13, v28, v28
    v_dot2c_f32_bf16 v12, s24, v29
    v_dot2c_f32_bf16 v13, v29, v29
    v_dot2c_f32_bf16 v12, s24, v30
    v_dot2c_f32_bf16 v13, v30, v30
    v_dot2c_f32_bf16 v12, s24, v31
    v_dot2c_f32_bf16 v13, v31, v31
    s_nop 1
    v_mov_b32 v14, v12
    v_mov_b32 v15, v13
    s_nop 0
    v_permlane32_swap_b32 v12, v14
    v_permlane32_swap_b32 v13, v15
    v_add_f32 v12, v12, v14
    v_add_f32 v13, v13, v15
    s_mov_b32 exec_hi, 0
    s_cbranch_vccz L_slow3
    buffer_store_dwordx2 v[12:13], v9, s[4:7], 0 offen
L_back3:
    s_mov_b32 exec_hi, -1
    s_branch L_p3_pb3
L_p3_nores:
    s_waitcnt vmcnt(0)
    s_barrier
    s_cmp_lg_u32 s22, 3
    s_cbranch_scc1 L_p3_ns3
    s_cmp_lt_u32 s31, 30
    s_cbranch_scc1 L_p3_s3
    s_lshl_b32 s23, s94, 7
    s_add_u32 s23, s23, 21004288
    v_mov_b32 v12, 0
    v_mov_b32 v13, s88
    s_mov_b64 exec, 1
    buffer_store_dword v13, v12, s[4:7], s23 offen sc1
    s_mov_b64 exec, -1
    s_endpgm
L_p3_s3:
    s_lshl_b32 s23, s94, 7
    s_add_u32 s23, s23, 21004288
    v_mov_b32 v12, 0
    v_mov_b32 v13, s88
    s_mov_b64 exec, 1
    buffer_store_dword v13, v12, s[4:7], s23 offen sc1
    s_mov_b64 exec, -1
    v_min_u32 v12, 31, v1
    s_lshl_b32 s23, s32, 12
    s_add_u32 s23, s23, 21004288
    v_lshl_add_u32 v12, v12, 7, s23
    s_mov_b32 s28, 0
    s_mov_b64 s[90:91], -1
L_p3_poll3:
    buffer_load_dword v248, v12, s[4:7], 0 offen sc1
    s_waitcnt vmcnt(0)
    v_cmp_ne_u32 vcc, s88, v248
    s_nop 1
    s_and_b64 exec, exec, vcc
    s_cbranch_execz L_p3_go3
    s_sleep 1
    s_add_u32 s28, s28, 1
    s_cmp_lt_u32 s28, 0x4000
    s_cbranch_scc1 L_p3_poll3
L_p3_go3:
    s_mov_b64 exec, -1
    s_cmp_lg_u32 s31, 0
    s_cbranch_scc1 L_p3_ns3
    s_lshl_b32 s23, s32, 7
    s_add_u32 s23, s23, 21136384
    v_mov_b32 v12, 0
    v_mov_b32 v13, s88
    s_mov_b64 exec, 1
    buffer_store_dword v13, v12, s[4:7], s23 offen sc1
    s_mov_b64 exec, -1
L_p3_ns3:
    s_cmp_ge_u32 s31, 30
    s_cbranch_scc1 L_exit
    s_barrier
    s_barrier
    s_barrier
    s_barrier
    s_cmp_lg_u32 s22, 3
    s_cbranch_scc1 L_p3_ngd
    v_and_b32 v12, 7, v1
    v_lshlrev_b32 v12, 7, v12
    v_add_u32 v12, 21136384, v12
    buffer_load_dword v13, v12, s[4:7], 0 offen sc1
    s_barrier
    s_waitcnt vmcnt(0)
    v_cmp_ne_u32 vcc, s88, v13
    s_nop 1
    s_cbranch_vccz L_p3_gdok
    s_mov_b32 s28, 0
    s_mov_b64 s[90:91], -1
L_p3_pollgd:
    buffer_load_dword v248, v12, s[4:7], 0 offen sc1
    s_waitcnt vmcnt(0)
    v_cmp_ne_u32 vcc, s88, v248
    s_nop 1
    s_and_b64 exec, exec, vcc
    s_cbranch_execz L_p3_gogd
    s_sleep 1
    s_add_u32 s28, s28, 1
    s_cmp_lt_u32 s28, 0x4000
    s_cbranch_scc1 L_p3_pollgd
L_p3_gogd:
    s_mov_b64 exec, -1
    s_branch L_p3_gdok
L_p3_ngd:
    s_barrier
L_p3_gdok:
    s_barrier
L_p3_pb3:
    s_lshl_b32 s94, s32, 5
    s_add_u32 s94, s94, s31
    s_cmp_ge_u32 s31, 28
    s_cbranch_scc1 L_p3_skip4
    s_lshl_b32 s23, s32, 1
    s_add_u32 s23, s23, s29
    s_lshl_b32 s23, s23, 2
    s_add_u32 s23, s23, s22
    s_lshl_b32 s23, s23, 5
    v_add_u32 v12, s23, v2
    v_lshlrev_b32 v8, 15, v3
    v_lshl_add_u32 v8, v12, 4, v8
    s_mov_b32 s26, 2621440
    s_lshl_b32 s23, s30, 19
    s_add_u32 s23, s23, 7864320
    v_add_u32 v10, s23, v8
    v_mul_u32_u24 v13, 81920, v3
    v_lshl_add_u32 v9, v12, 3, v13
    v_bfe_u32 v12, v1, 2, 2
    v_lshl_add_u32 v13, v3, 2, v12
    v_lshlrev_b32 v13, 8, v13
    v_lshl_add_u32 v12, v12, 6, v13
    v_bfe_u32 v15, v1, 4, 1
    v_lshl_add_u32 v12, v15, 5, v12
    v_and_b32 v15, 3, v1
    v_lshl_add_u32 v4, v15, 3, v12
    v_xor_b32 v5, 64, v4
    v_xor_b32 v6, 128, v4
    v_xor_b32 v7, 192, v4
    s_waitcnt vmcnt(0)
    s_barrier
    s_cmp_lg_u32 s22, 3
    s_cbranch_scc1 L_p3_ns4
    s_lshl_b32 s23, s94, 7
    s_add_u32 s23, s23, 21037056
    v_mov_b32 v12, 0
    v_mov_b32 v13, s88
    s_mov_b64 exec, 1
    s_cmp_lg_u32 s95, 0
    s_cselect_b64 vcc, -1, 0
    s_cbranch_vccz L_slow4
    buffer_store_dword v13, v12, s[4:7], s23 offen
L_back4:
    s_mov_b64 exec, -1
    v_min_u32 v12, 29, v1
    s_lshl_b32 s23, s32, 12
    s_add_u32 s23, s23, 21037056
    v_lshl_add_u32 v12, v12, 7, s23
    s_lshl_b32 s23, s30, 11
    s_add_u32 s23, s23, 20973440
    v_writelane_b32 v12, s23, 63
    s_mov_b32 s28, 0
    s_mov_b64 s[90:91], -1
L_p3_poll4:
    buffer_load_dword v248, v12, s[4:7], 0 offen sc1
    s_waitcnt vmcnt(0)
    v_cmp_ne_u32 vcc, s88, v248
    s_nop 1
    s_and_b64 exec, exec, vcc
    s_cbranch_execz L_p3_go4
    s_sleep 1
    s_add_u32 s28, s28, 1
    s_cmp_lt_u32 s28, 0x4000
    s_cbranch_scc1 L_p3_poll4
L_p3_go4:
    s_mov_b64 exec, -1
L_p3_ns4:
    s_barrier
    buffer_load_dwordx4 v[144:147], v8, s[4:7], s26 offen sc1
    s_add_u32 s26, s26, 65536
    buffer_load_dwordx4 v[148:151], v8, s[4:7], s26 offen sc1
    s_add_u32 s26, s26, 65536
    buffer_load_dwordx4 v[152:155], v8, s[4:7], s26 offen sc1
    s_add_u32 s26, s26, 65536
    buffer_load_dwordx4 v[156:159], v8, s[4:7], s26 offen sc1
    s_add_u32 s26, s26, 65536
    buffer_load_dwordx4 v[160:163], v8, s[4:7], s26 offen sc1
    s_add_u32 s26, s26, 65536
    buffer_load_dwordx4 v[164:167], v8, s[4:7], s26 offen sc1
    s_add_u32 s26, s26, 65536
    s_barrier
    v_add_u32 v4, 0x10000, v4
    v_add_u32 v5, 0x10000, v5
    v_add_u32 v6, 0x10000, v6
    v_add_u32 v7, 0x10000, v7
    ds_read_b64_tr_b16 v[112:113], v4 offset:16384
    ds_read_b64_tr_b16 v[114:115], v4 offset:18432
    ds_read_b64_tr_b16 v[116:117], v5 offset:16384
    ds_read_b64_tr_b16 v[118:119], v5 offset:18432
    ds_read_b64_tr_b16 v[120:121], v6 offset:16384
    ds_read_b64_tr_b16 v[122:123], v6 offset:18432
    ds_read_b64_tr_b16 v[124:125], v7 offset:16384
    ds_read_b64_tr_b16 v[126:127], v7 offset:18432
    ds_read_b64_tr_b16 v[128:129], v4 offset:20480
    ds_read_b64_tr_b16 v[130:131], v4 offset:22528
    ds_read_b64_tr_b16 v[132:133], v5 offset:20480
    ds_read_b64_tr_b16 v[134:135], v5 offset:22528
    s_waitcnt vmcnt(5) lgkmcnt(10)
    v_mfma_f32_32x32x16_bf16 v[48:63], v[112:115], v[144:147], 0
    ds_read_b64_tr_b16 v[136:137], v6 offset:20480
    ds_read_b64_tr_b16 v[138:139], v6 offset:22528
    buffer_load_dwordx4 v[168:171], v8, s[4:7], s26 offen sc1
    s_add_u32 s26, s26, 65536
    s_waitcnt lgkmcnt(10)
    v_mfma_f32_32x32x16_bf16 v[64:79], v[116:119], v[144:147], 0
    ds_read_b64_tr_b16 v[140:141], v7 offset:20480
    ds_read_b64_tr_b16 v[142:143], v7 offset:22528
    s_waitcnt lgkmcnt(10)
    v_mfma_f32_32x32x16_bf16 v[80:95], v[120:123], v[144:147], 0
    ds_read_b64_tr_b16 v[112:113], v4 offset:24576
    ds_read_b64_tr_b16 v[114:115], v4 offset:26624
    buffer_load_dwordx4 v[172:175], v8, s[4:7], s26 offen sc1
    s_add_u32 s26, s26, 65536
    s_waitcnt lgkmcnt(10)
    v_mfma_f32_32x32x16_bf16 v[96:111], v[124:127], v[144:147], 0
    ds_read_b64_tr_b16 v[116:117], v5 offset:24576
    ds_read_b64_tr_b16 v[118:119], v5 offset:26624
    s_waitcnt vmcnt(6) lgkmcnt(10)
    v_mfma_f32_32x32x16_bf16 v[48:63], v[128:131], v[148:151], v[48:63]
    ds_read_b64_tr_b16 v[120:121], v6 offset:24576
    ds_read_b64_tr_b16 v[122:123], v6 offset:26624
    buffer_load_dwordx4 v[176:179], v8, s[4:7], s26 offen sc1
    s_add_u32 s26, s26, 65536
    s_waitcnt lgkmcnt(10)
    v_mfma_f32_32x32x16_bf16 v[64:79], v[132:135], v[148:151], v[64:79]
    ds_read_b64_tr_b16 v[124:125], v7 offset:24576
    ds_read_b64_tr_b16 v[126:127], v7 offset:26624
    s_waitcnt lgkmcnt(10)
    v_mfma_f32_32x32x16_bf16 v[80:95], v[136:139], v[148:151], v[80:95]
    ds_read_b64_tr_b16 v[128:129], v4 offset:28672
    ds_read_b64_tr_b16 v[130:131], v4 offset:30720
    buffer_load_dwordx4 v[180:183], v8, s[4:7], s26 offen sc1
    s_add_u32 s26, s26, 65536
    s_waitcnt lgkmcnt(10)
    v_mfma_f32_32x32x16_bf16 v[96:111], v[140:143], v[148:151], v[96:111]
    ds_read_b64_tr_b16 v[132:133], v5 offset:28672
    ds_read_b64_tr_b16 v[134:135], v5 offset:30720
    s_waitcnt vmcnt(7) lgkmcnt(10)
    v_mfma_f32_32x32x16_bf16 v[48:63], v[112:115], v[152:155], v[48:63]
    ds_read_b64_tr_b16 v[136:137], v6 offset:28672
    ds_read_b64_tr_b16 v[138:139], v6 offset:30720
    buffer_load_dwordx4 v[184:187], v8, s[4:7], s26 offen sc1
    s_add_u32 s26, s26, 65536
    s_waitcnt lgkmcnt(10)
    v_mfma_f32_32x32x16_bf16 v[64:79], v[116:119], v[152:155], v[64:79]
    ds_read_b64_tr_b16 v[140:141], v7 offset:28672
    ds_read_b64_tr_b16 v[142:143], v7 offset:30720
    s_waitcnt lgkmcnt(10)
    v_mfma_f32_32x32x16_bf16 v[80:95], v[120:123], v[152:155], v[80:95]
    s_barrier
    ds_read_b64_tr_b16 v[112:113], v4 offset:32768
    ds_read_b64_tr_b16 v[114:115], v4 offset:34816
    buffer_load_dwordx4 v[188:191], v8, s[4:7], s26 offen sc1
    s_add_u32 s26, s26, 65536
    s_waitcnt lgkmcnt(10)
    v_mfma_f32_32x32x16_bf16 v[96:111], v[124:127], v[152:155], v[96:111]
    ds_read_b64_tr_b16 v[116:117], v5 offset:32768
    ds_read_b64_tr_b16 v[118:119], v5 offset:34816
    s_waitcnt vmcnt(8) lgkmcnt(10)
    v_mfma_f32_32x32x16_bf16 v[48:63], v[128:131], v[156:159], v[48:63]
    ds_read_b64_tr_b16 v[120:121], v6 offset:32768
    ds_read_b64_tr_b16 v[122:123], v6 offset:34816
    buffer_load_dwordx4 v[192:195], v8, s[4:7], s26 offen sc1
    s_add_u32 s26, s26, 65536
    s_waitcnt lgkmcnt(10)
    v_mfma_f32_32x32x16_bf16 v[64:79], v[132:135], v[156:159], v[64:79]
    ds_read_b64_tr_b16 v[124:125], v7 offset:32768
    ds_read_b64_tr_b16 v[126:127], v7 offset:34816
    s_waitcnt lgkmcnt(10)
    v_mfma_f32_32x32x16_bf16 v[80:95], v[136:139], v[156:159], v[80:95]
    ds_read_b64_tr_b16 v[128:129], v4 offset:36864
    ds_read_b64_tr_b16 v[130:131], v4 offset:38912
    buffer_load_dwordx4 v[196:199], v8, s[4:7], s26 offen sc1
    s_add_u32 s26, s26, 65536
    s_waitcnt lgkmcnt(10)
    v_mfma_f32_32x32x16_bf16 v[96:111], v[140:143], v[156:159], v[96:111]
    ds_read_b64_tr_b16 v[132:133], v5 offset:36864
    ds_read_b64_tr_b16 v[134:135], v5 offset:38912
    s_waitcnt vmcnt(9) lgkmcnt(10)
    v_mfma_f32_32x32x16_bf16 v[48:63], v[112:115], v[160:163], v[48:63]
    ds_read_b64_tr_b16 v[136:137], v6 offset:36864
    ds_read_b64_tr_b16 v[138:139], v6 offset:38912
    buffer_load_dwordx4 v[200:203], v8, s[4:7], s26 offen sc1
    s_add_u32 s26, s26, 65536
    s_waitcnt lgkmcnt(10)
    v_mfma_f32_32x32x16_bf16 v[64:79], v[116:119], v[160:163], v[64:79]
    ds_read_b64_tr_b16 v[140:141], v7 offset:36864
    ds_read_b64_tr_b16 v[142:143], v7 offset:38912
    s_waitcnt lgkmcnt(10)
    v_mfma_f32_32x32x16_bf16 v[80:95], v[120:123], v[160:163], v[80:95]
    ds_read_b64_tr_b16 v[112:113], v4 offset:40960
    ds_read_b64_tr_b16 v[114:115], v4 offset:43008
    s_waitcnt lgkmcnt(10)
    v_mfma_f32_32x32x16_bf16 v[96:111], v[124:127], v[160:163], v[96:111]
    ds_read_b64_tr_b16 v[116:117], v5 offset:40960
    ds_read_b64_tr_b16 v[118:119], v5 offset:43008
    s_waitcnt vmcnt(9) lgkmcnt(10)
    v_mfma_f32_32x32x16_bf16 v[48:63], v[128:131], v[164:167], v[48:63]
    ds_read_b64_tr_b16 v[120:121], v6 offset:40960
    ds_read_b64_tr_b16 v[122:123], v6 offset:43008
    buffer_load_dwordx4 v[204:207], v8, s[4:7], s26 offen sc1
    s_add_u32 s26, s26, 65536
    s_waitcnt lgkmcnt(10)
    v_mfma_f32_32x32x16_bf16 v[64:79], v[132:135], v[164:167], v[64:79]
    ds_read_b64_tr_b16 v[124:125], v7 offset:40960
    ds_read_b64_tr_b16 v[126:127], v7 offset:43008
    s_waitcnt lgkmcnt(10)
    v_mfma_f32_32x32x16_bf16 v[80:95], v[136:139], v[164:167], v[80:95]
    ds_read_b64_tr_b16 v[128:129], v4 offset:45056
    ds_read_b64_tr_b16 v[130:131], v4 offset:47104
    s_waitcnt lgkmcnt(10)
    v_mfma_f32_32x32x16_bf16 v[96:111], v[140:143], v[164:167], v[96:111]
    ds_read_b64_tr_b16 v[132:133], v5 offset:45056
    ds_read_b64_tr_b16 v[134:135], v5 offset:47104
    s_waitcnt vmcnt(9) lgkmcnt(10)
    v_mfma_f32_32x32x16_bf16 v[48:63], v[112:115], v[168:171], v[48:63]
    ds_read_b64_tr_b16 v[136:137], v6 offset:45056
    ds_read_b64_tr_b16 v[138:139], v6 offset:47104
    buffer_load_dwordx4 v[208:211], v8, s[4:7], s26 offen sc1
    s_add_u32 s26, s26, 65536
    s_waitcnt lgkmcnt(10)
    v_mfma_f32_32x32x16_bf16 v[64:79], v[116:119], v[168:171], v[64:79]
    ds_read_b64_tr_b16 v[140:141], v7 offset:45056
    ds_read_b64_tr_b16 v[142:143], v7 offset:47104
    s_waitcnt lgkmcnt(10)
    v_mfma_f32_32x32x16_bf16 v[80:95], v[120:123], v[168:171], v[80:95]
    s_barrier
    ds_read_b64_tr_b16 v[112:113], v4 offset:49152
    ds_read_b64_tr_b16 v[114:115], v4 offset:51200
    s_waitcnt lgkmcnt(10)
    v_mfma_f32_32x32x16_bf16 v[96:111], v[124:127], v[168:171], v[96:111]
    ds_read_b64_tr_b16 v[116:117], v5 offset:49152
    ds_read_b64_tr_b16 v[118:119], v5 offset:51200
    s_waitcnt vmcnt(9) lgkmcnt(10)
    v_mfma_f32_32x32x16_bf16 v[48:63], v[128:131], v[172:175], v[48:63]
    ds_read_b64_tr_b16 v[120:121], v6 offset:49152
    ds_read_b64_tr_b16 v[122:123], v6 offset:51200
    buffer_load_dwordx4 v[212:215], v8, s[4:7], s26 offen sc1
    s_add_u32 s26, s26, 65536
    s_waitcnt lgkmcnt(10)
    v_mfma_f32_32x32x16_bf16 v[64:79], v[132:135], v[172:175], v[64:79]
    ds_read_b64_tr_b16 v[124:125], v7 offset:49152
    ds_read_b64_tr_b16 v[126:127], v7 offset:51200
    s_waitcnt lgkmcnt(10)
    v_mfma_f32_32x32x16_bf16 v[80:95], v[136:139], v[172:175], v[80:95]
    ds_read_b64_tr_b16 v[128:129], v4 offset:53248
    ds_read_b64_tr_b16 v[130:131], v4 offset:55296
    s_waitcnt lgkmcnt(10)
    v_mfma_f32_32x32x16_bf16 v[96:111], v[140:143], v[172:175], v[96:111]
    ds_read_b64_tr_b16 v[132:133], v5 offset:53248
    ds_read_b64_tr_b16 v[134:135], v5 offset:55296
    s_waitcnt vmcnt(9) lgkmcnt(10)
    v_mfma_f32_32x32x16_bf16 v[48:63], v[112:115], v[176:179], v[48:63]
    ds_read_b64_tr_b16 v[136:137], v6 offset:53248
    ds_read_b64_tr_b16 v[138:139], v6 offset:55296
    buffer_load_dwordx4 v[216:219], v8, s[4:7], s26 offen sc1
    s_add_u32 s26, s26, 65536
    s_waitcnt lgkmcnt(10)
    v_mfma_f32_32x32x16_bf16 v[64:79], v[116:119], v[176:179], v[64:79]
    ds_read_b64_tr_b16 v[140:141], v7 offset:53248
    ds_read_b64_tr_b16 v[142:143], v7 offset:55296
    s_waitcnt lgkmcnt(10)
    v_mfma_f32_32x32x16_bf16 v[80:95], v[120:123], v[176:179], v[80:95]
    ds_read_b64_tr_b16 v[112:113], v4 offset:57344
    ds_read_b64_tr_b16 v[114:115], v4 offset:59392
    s_waitcnt lgkmcnt(10)
    v_mfma_f32_32x32x16_bf16 v[96:111], v[124:127], v[176:179], v[96:111]
    ds_read_b64_tr_b16 v[116:117], v5 offset:57344
    ds_read_b64_tr_b16 v[118:119], v5 offset:59392
    s_waitcnt vmcnt(9) lgkmcnt(10)
    v_mfma_f32_32x32x16_bf16 v[48:63], v[128:131], v[180:183], v[48:63]
    ds_read_b64_tr_b16 v[120:121], v6 offset:57344
    ds_read_b64_tr_b16 v[122:123], v6 offset:59392
    buffer_load_dwordx4 v[220:223], v8, s[4:7], s26 offen sc1
    s_add_u32 s26, s26, 65536
    s_waitcnt lgkmcnt(10)
    v_mfma_f32_32x32x16_bf16 v[64:79], v[132:135], v[180:183], v[64:79]
    ds_read_b64_tr_b16 v[124:125], v7 offset:57344
    ds_read_b64_tr_b16 v[126:127], v7 offset:59392
    s_waitcnt lgkmcnt(10)
    v_mfma_f32_32x32x16_bf16 v[80:95], v[136:139], v[180:183], v[80:95]
    ds_read_b64_tr_b16 v[128:129], v4 offset:61440
    ds_read_b64_tr_b16 v[130:131], v4 offset:63488
    s_waitcnt lgkmcnt(10)
    v_mfma_f32_32x32x16_bf16 v[96:111], v[140:143], v[180:183], v[96:111]
    ds_read_b64_tr_b16 v[132:133], v5 offset:61440
    ds_read_b64_tr_b16 v[134:135], v5 offset:63488
    s_waitcnt vmcnt(9) lgkmcnt(10)
    v_mfma_f32_32x32x16_bf16 v[48:63], v[112:115], v[184:187], v[48:63]
    ds_read_b64_tr_b16 v[136:137], v6 offset:61440
    ds_read_b64_tr_b16 v[138:139], v6 offset:63488
    buffer_load_dwordx4 v[224:227], v8, s[4:7], s26 offen sc1
    s_add_u32 s26, s26, 65536
    s_waitcnt lgkmcnt(10)
    v_mfma_f32_32x32x16_bf16 v[64:79], v[116:119], v[184:187], v[64:79]
    ds_read_b64_tr_b16 v[140:141], v7 offset:61440
    ds_read_b64_tr_b16 v[142:143], v7 offset:63488
    s_waitcnt lgkmcnt(10)
    v_mfma_f32_32x32x16_bf16 v[80:95], v[120:123], v[184:187], v[80:95]
    s_barrier
    v_add_u32 v4, 0xffff0000, v4
    v_add_u32 v5, 0xffff0000, v5
    v_add_u32 v6, 0xffff0000, v6
    v_add_u32 v7, 0xffff0000, v7
    ds_read_b64_tr_b16 v[112:113], v4 offset:0
    ds_read_b64_tr_b16 v[114:115], v4 offset:2048
    s_waitcnt lgkmcnt(10)
    v_mfma_f32_32x32x16_bf16 v[96:111], v[124:127], v[184:187], v[96:111]
    ds_read_b64_tr_b16 v[116:117], v5 offset:0
    ds_read_b64_tr_b16 v[118:119], v5 offset:2048
    s_waitcnt vmcnt(9) lgkmcnt(10)
    v_mfma_f32_32x32x16_bf16 v[48:63], v[128:131], v[188:191], v[48:63]
    ds_read_b64_tr_b16 v[120:121], v6 offset:0
    ds_read_b64_tr_b16 v[122:123], v6 offset:2048
    buffer_load_dwordx4 v[228:231], v8, s[4:7], s26 offen sc1
    s_add_u32 s26, s26, 65536
    s_waitcnt lgkmcnt(10)
    v_mfma_f32_32x32x16_bf16 v[64:79], v[132:135], v[188:191], v[64:79]
    ds_read_b64_tr_b16 v[124:125], v7 offset:0
    ds_read_b64_tr_b16 v[126:127], v7 offset:2048
    s_waitcnt lgkmcnt(10)
    v_mfma_f32_32x32x16_bf16 v[80:95], v[136:139], v[188:191], v[80:95]
    ds_read_b64_tr_b16 v[128:129], v4 offset:4096
    ds_read_b64_tr_b16 v[130:131], v4 offset:6144
    s_waitcnt lgkmcnt(10)
    v_mfma_f32_32x32x16_bf16 v[96:111], v[140:143], v[188:191], v[96:111]
    ds_read_b64_tr_b16 v[132:133], v5 offset:4096
    ds_read_b64_tr_b16 v[134:135], v5 offset:6144
    s_waitcnt vmcnt(9) lgkmcnt(10)
    v_mfma_f32_32x32x16_bf16 v[48:63], v[112:115], v[192:195], v[48:63]
    ds_read_b64_tr_b16 v[136:137], v6 offset:4096
    ds_read_b64_tr_b16 v[138:139], v6 offset:6144
    buffer_load_dwordx4 v[232:235], v8, s[4:7], s26 offen sc1
    s_add_u32 s26, s26, 65536
    s_waitcnt lgkmcnt(10)
    v_mfma_f32_32x32x16_bf16 v[64:79], v[116:119], v[192:195], v[64:79]
    ds_read_b64_tr_b16 v[140:141], v7 offset:4096
    ds_read_b64_tr_b16 v[142:143], v7 offset:6144
    s_waitcnt lgkmcnt(10)
    v_mfma_f32_32x32x16_bf16 v[80:95], v[120:123], v[192:195], v[80:95]
    ds_read_b64_tr_b16 v[112:113], v4 offset:8192
    ds_read_b64_tr_b16 v[114:115], v4 offset:10240
    s_waitcnt lgkmcnt(10)
    v_mfma_f32_32x32x16_bf16 v[96:111], v[124:127], v[192:195], v[96:111]
    ds_read_b64_tr_b16 v[116:117], v5 offset:8192
    ds_read_b64_tr_b16 v[118:119], v5 offset:10240
    s_waitcnt vmcnt(9) lgkmcnt(10)
    v_mfma_f32_32x32x16_bf16 v[48:63], v[128:131], v[196:199], v[48:63]
    ds_read_b64_tr_b16 v[120:121], v6 offset:8192
    ds_read_b64_tr_b16 v[122:123], v6 offset:10240
    buffer_load_dwordx4 v[236:239], v8, s[4:7], s26 offen sc1
    s_add_u32 s26, s26, 65536
    s_waitcnt lgkmcnt(10)
    v_mfma_f32_32x32x16_bf16 v[64:79], v[132:135], v[196:199], v[64:79]
    ds_read_b64_tr_b16 v[124:125], v7 offset:8192
    ds_read_b64_tr_b16 v[126:127], v7 offset:10240
    s_waitcnt lgkmcnt(10)
    v_mfma_f32_32x32x16_bf16 v[80:95], v[136:139], v[196:199], v[80:95]
    ds_read_b64_tr_b16 v[128:129], v4 offset:12288
    ds_read_b64_tr_b16 v[130:131], v4 offset:14336
    s_waitcnt lgkmcnt(10)
    v_mfma_f32_32x32x16_bf16 v[96:111], v[140:143], v[196:199], v[96:111]
    ds_read_b64_tr_b16 v[132:133], v5 offset:12288
    ds_read_b64_tr_b16 v[134:135], v5 offset:14336
    s_waitcnt vmcnt(9) lgkmcnt(10)
    v_mfma_f32_32x32x16_bf16 v[48:63], v[112:115], v[200:203], v[48:63]
    ds_read_b64_tr_b16 v[136:137], v6 offset:12288
    ds_read_b64_tr_b16 v[138:139], v6 offset:14336
    buffer_load_dwordx4 v[144:147], v8, s[4:7], s26 offen sc1
    s_add_u32 s26, s26, 65536
    s_waitcnt lgkmcnt(10)
    v_mfma_f32_32x32x16_bf16 v[64:79], v[116:119], v[200:203], v[64:79]
    ds_read_b64_tr_b16 v[140:141], v7 offset:12288
    ds_read_b64_tr_b16 v[142:143], v7 offset:14336
    s_waitcnt lgkmcnt(10)
    v_mfma_f32_32x32x16_bf16 v[80:95], v[120:123], v[200:203], v[80:95]
    s_barrier
    ds_read_b64_tr_b16 v[112:113], v4 offset:16384
    ds_read_b64_tr_b16 v[114:115], v4 offset:18432
    s_waitcnt lgkmcnt(10)
    v_mfma_f32_32x32x16_bf16 v[96:111], v[124:127], v[200:203], v[96:111]
    ds_read_b64_tr_b16 v[116:117], v5 offset:16384
    ds_read_b64_tr_b16 v[118:119], v5 offset:18432
    s_waitcnt vmcnt(9) lgkmcnt(10)
    v_mfma_f32_32x32x16_bf16 v[48:63], v[128:131], v[204:207], v[48:63]
    ds_read_b64_tr_b16 v[120:121], v6 offset:16384
    ds_read_b64_tr_b16 v[122:123], v6 offset:18432
    buffer_load_dwordx4 v[148:151], v8, s[4:7], s26 offen sc1
    s_add_u32 s26, s26, 65536
    s_waitcnt lgkmcnt(10)
    v_mfma_f32_32x32x16_bf16 v[64:79], v[132:135], v[204:207], v[64:79]
    ds_read_b64_tr_b16 v[124:125], v7 offset:16384
    ds_read_b64_tr_b16 v[126:127], v7 offset:18432
    s_waitcnt lgkmcnt(10)
    v_mfma_f32_32x32x16_bf16 v[80:95], v[136:139], v[204:207], v[80:95]
    ds_read_b64_tr_b16 v[128:129], v4 offset:20480
    ds_read_b64_tr_b16 v[130:131], v4 offset:22528
    s_waitcnt lgkmcnt(10)
    v_mfma_f32_32x32x16_bf16 v[96:111], v[140:143], v[204:207], v[96:111]
    ds_read_b64_tr_b16 v[132:133], v5 offset:20480
    ds_read_b64_tr_b16 v[134:135], v5 offset:22528
    s_waitcnt vmcnt(9) lgkmcnt(10)
    v_mfma_f32_32x32x16_bf16 v[48:63], v[112:115], v[208:211], v[48:63]
    ds_read_b64_tr_b16 v[136:137], v6 offset:20480
    ds_read_b64_tr_b16 v[138:139], v6 offset:22528
    buffer_load_dwordx4 v[152:155], v8, s[4:7], s26 offen sc1
    s_add_u32 s26, s26, 65536
    s_waitcnt lgkmcnt(10)
    v_mfma_f32_32x32x16_bf16 v[64:79], v[116:119], v[208:211], v[64:79]
    ds_read_b64_tr_b16 v[140:141], v7 offset:20480
    ds_read_b64_tr_b16 v[142:143], v7 offset:22528
    s_waitcnt lgkmcnt(10)
    v_mfma_f32_32x32x16_bf16 v[80:95], v[120:123], v[208:211], v[80:95]
    ds_read_b64_tr_b16 v[112:113], v4 offset:24576
    ds_read_b64_tr_b16 v[114:115], v4 offset:26624
    s_waitcnt lgkmcnt(10)
    v_mfma_f32_32x32x16_bf16 v[96:111], v[124:127], v[208:211], v[96:111]
    ds_read_b64_tr_b16 v[116:117], v5 offset:24576
    ds_read_b64_tr_b16 v[118:119], v5 offset:26624
    s_waitcnt vmcnt(9) lgkmcnt(10)
    v_mfma_f32_32x32x16_bf16 v[48:63], v[128:131], v[212:215], v[48:63]
    ds_read_b64_tr_b16 v[120:121], v6 offset:24576
    ds_read_b64_tr_b16 v[122:123], v6 offset:26624
    buffer_load_dwordx4 v[156:159], v8, s[4:7], s26 offen sc1
    s_add_u32 s26, s26, 65536
    s_waitcnt lgkmcnt(10)
    v_mfma_f32_32x32x16_bf16 v[64:79], v[132:135], v[212:215], v[64:79]
    ds_read_b64_tr_b16 v[124:125], v7 offset:24576
    ds_read_b64_tr_b16 v[126:127], v7 offset:26624
    s_waitcnt lgkmcnt(10)
    v_mfma_f32_32x32x16_bf16 v[80:95], v[136:139], v[212:215], v[80:95]
    ds_read_b64_tr_b16 v[128:129], v4 offset:28672
    ds_read_b64_tr_b16 v[130:131], v4 offset:30720
    s_waitcnt lgkmcnt(10)
    v_mfma_f32_32x32x16_bf16 v[96:111], v[140:143], v[212:215], v[96:111]
    ds_read_b64_tr_b16 v[132:133], v5 offset:28672
    ds_read_b64_tr_b16 v[134:135], v5 offset:30720
    s_waitcnt vmcnt(9) lgkmcnt(10)
    v_mfma_f32_32x32x16_bf16 v[48:63], v[112:115], v[216:219], v[48:63]
    ds_read_b64_tr_b16 v[136:137], v6 offset:28672
    ds_read_b64_tr_b16 v[138:139], v6 offset:30720
    buffer_load_dwordx4 v[160:163], v8, s[4:7], s26 offen sc1
    s_add_u32 s26, s26, 65536
    s_waitcnt lgkmcnt(10)
    v_mfma_f32_32x32x16_bf16 v[64:79], v[116:119], v[216:219], v[64:79]
    ds_read_b64_tr_b16 v[140:141], v7 offset:28672
    ds_read_b64_tr_b16 v[142:143], v7 offset:30720
    s_waitcnt lgkmcnt(10)
    v_mfma_f32_32x32x16_bf16 v[80:95], v[120:123], v[216:219], v[80:95]
    s_barrier
    ds_read_b64_tr_b16 v[112:113], v4 offset:32768
    ds_read_b64_tr_b16 v[114:115], v4 offset:34816
    s_waitcnt lgkmcnt(10)
    v_mfma_f32_32x32x16_bf16 v[96:111], v[124:127], v[216:219], v[96:111]
    ds_read_b64_tr_b16 v[116:117], v5 offset:32768
    ds_read_b64_tr_b16 v[118:119], v5 offset:34816
    s_waitcnt vmcnt(9) lgkmcnt(10)
    v_mfma_f32_32x32x16_bf16 v[48:63], v[128:131], v[220:223], v[48:63]
    ds_read_b64_tr_b16 v[120:121], v6 offset:32768
    ds_read_b64_tr_b16 v[122:123], v6 offset:34816
    buffer_load_dwordx4 v[164:167], v8, s[4:7], s26 offen sc1
    s_add_u32 s26, s26, 65536
    s_waitcnt lgkmcnt(10)
    v_mfma_f32_32x32x16_bf16 v[64:79], v[132:135], v[220:223], v[64:79]
    ds_read_b64_tr_b16 v[124:125], v7 offset:32768
    ds_read_b64_tr_b16 v[126:127], v7 offset:34816
    s_waitcnt lgkmcnt(10)
    v_mfma_f32_32x32x16_bf16 v[80:95], v[136:139], v[220:223], v[80:95]
    ds_read_b64_tr_b16 v[128:129], v4 offset:36864
    ds_read_b64_tr_b16 v[130:131], v4 offset:38912
    s_waitcnt lgkmcnt(10)
    v_mfma_f32_32x32x16_bf16 v[96:111], v[140:143], v[220:223], v[96:111]
    ds_read_b64_tr_b16 v[132:133], v5 offset:36864
    ds_read_b64_tr_b16 v[134:135], v5 offset:38912
    s_waitcnt vmcnt(9) lgkmcnt(10)
    v_mfma_f32_32x32x16_bf16 v[48:63], v[112:115], v[224:227], v[48:63]
    ds_read_b64_tr_b16 v[136:137], v6 offset:36864
    ds_read_b64_tr_b16 v[138:139], v6 offset:38912
    buffer_load_dwordx4 v[168:171], v8, s[4:7], s26 offen sc1
    s_add_u32 s26, s26, 65536
    s_waitcnt lgkmcnt(10)
    v_mfma_f32_32x32x16_bf16 v[64:79], v[116:119], v[224:227], v[64:79]
    ds_read_b64_tr_b16 v[140:141], v7 offset:36864
    ds_read_b64_tr_b16 v[142:143], v7 offset:38912
    s_waitcnt lgkmcnt(10)
    v_mfma_f32_32x32x16_bf16 v[80:95], v[120:123], v[224:227], v[80:95]
    ds_read_b64_tr_b16 v[112:113], v4 offset:40960
    ds_read_b64_tr_b16 v[114:115], v4 offset:43008
    s_waitcnt lgkmcnt(10)
    v_mfma_f32_32x32x16_bf16 v[96:111], v[124:127], v[224:227], v[96:111]
    ds_read_b64_tr_b16 v[116:117], v5 offset:40960
    ds_read_b64_tr_b16 v[118:119], v5 offset:43008
    s_waitcnt vmcnt(9) lgkmcnt(10)
    v_mfma_f32_32x32x16_bf16 v[48:63], v[128:131], v[228:231], v[48:63]
    ds_read_b64_tr_b16 v[120:121], v6 offset:40960
    ds_read_b64_tr_b16 v[122:123], v6 offset:43008
    buffer_load_dwordx4 v[172:175], v8, s[4:7], s26 offen sc1
    s_add_u32 s26, s26, 65536
    s_waitcnt lgkmcnt(10)
    v_mfma_f32_32x32x16_bf16 v[64:79], v[132:135], v[228:231], v[64:79]
    ds_read_b64_tr_b16 v[124:125], v7 offset:40960
    ds_read_b64_tr_b16 v[126:127], v7 offset:43008
    s_waitcnt lgkmcnt(10)
    v_mfma_f32_32x32x16_bf16 v[80:95], v[136:139], v[228:231], v[80:95]
    ds_read_b64_tr_b16 v[128:129], v4 offset:45056
    ds_read_b64_tr_b16 v[130:131], v4 offset:47104
    s_waitcnt lgkmcnt(10)
    v_mfma_f32_32x32x16_bf16 v[96:111], v[140:143], v[228:231], v[96:111]
    ds_read_b64_tr_b16 v[132:133], v5 offset:45056
    ds_read_b64_tr_b16 v[134:135], v5 offset:47104
    s_waitcnt vmcnt(9) lgkmcnt(10)
    v_mfma_f32_32x32x16_bf16 v[48:63], v[112:115], v[232:235], v[48:63]
    ds_read_b64_tr_b16 v[136:137], v6 offset:45056
    ds_read_b64_tr_b16 v[138:139], v6 offset:47104
    buffer_load_dwordx4 v[176:179], v8, s[4:7], s26 offen sc1
    s_add_u32 s26, s26, 65536
    s_waitcnt lgkmcnt(10)
    v_mfma_f32_32x32x16_bf16 v[64:79], v[116:119], v[232:235], v[64:79]
    ds_read_b64_tr_b16 v[140:141], v7 offset:45056
    ds_read_b64_tr_b16 v[142:143], v7 offset:47104
    s_waitcnt lgkmcnt(10)
    v_mfma_f32_32x32x16_bf16 v[80:95], v[120:123], v[232:235], v[80:95]
    s_barrier
    ds_read_b64_tr_b16 v[112:113], v4 offset:49152
    ds_read_b64_tr_b16 v[114:115], v4 offset:51200
    s_waitcnt lgkmcnt(10)
    v_mfma_f32_32x32x16_bf16 v[96:111], v[124:127], v[232:235], v[96:111]
    ds_read_b64_tr_b16 v[116:117], v5 offset:49152
    ds_read_b64_tr_b16 v[118:119], v5 offset:51200
    s_waitcnt vmcnt(9) lgkmcnt(10)
    v_mfma_f32_32x32x16_bf16 v[48:63], v[128:131], v[236:239], v[48:63]
    ds_read_b64_tr_b16 v[120:121], v6 offset:49152
    ds_read_b64_tr_b16 v[122:123], v6 offset:51200
    buffer_load_dwordx4 v[180:183], v8, s[4:7], s26 offen sc1
    s_add_u32 s26, s26, 65536
    s_waitcnt lgkmcnt(10)
    v_mfma_f32_32x32x16_bf16 v[64:79], v[132:135], v[236:239], v[64:79]
    ds_read_b64_tr_b16 v[124:125], v7 offset:49152
    ds_read_b64_tr_b16 v[126:127], v7 offset:51200
    s_waitcnt lgkmcnt(10)
    v_mfma_f32_32x32x16_bf16 v[80:95], v[136:139], v[236:239], v[80:95]
    ds_read_b64_tr_b16 v[128:129], v4 offset:53248
    ds_read_b64_tr_b16 v[130:131], v4 offset:55296
    s_waitcnt lgkmcnt(10)
    v_mfma_f32_32x32x16_bf16 v[96:111], v[140:143], v[236:239], v[96:111]
    ds_read_b64_tr_b16 v[132:133], v5 offset:53248
    ds_read_b64_tr_b16 v[134:135], v5 offset:55296
    s_waitcnt vmcnt(9) lgkmcnt(10)
    v_mfma_f32_32x32x16_bf16 v[48:63], v[112:115], v[144:147], v[48:63]
    ds_read_b64_tr_b16 v[136:137], v6 offset:53248
    ds_read_b64_tr_b16 v[138:139], v6 offset:55296
    buffer_load_dwordx4 v[184:187], v8, s[4:7], s26 offen sc1
    s_add_u32 s26, s26, 65536
    s_waitcnt lgkmcnt(10)
    v_mfma_f32_32x32x16_bf16 v[64:79], v[116:119], v[144:147], v[64:79]
    ds_read_b64_tr_b16 v[140:141], v7 offset:53248
    ds_read_b64_tr_b16 v[142:143], v7 offset:55296
    s_waitcnt lgkmcnt(10)
    v_mfma_f32_32x32x16_bf16 v[80:95], v[120:123], v[144:147], v[80:95]
    ds_read_b64_tr_b16 v[112:113], v4 offset:57344
    ds_read_b64_tr_b16 v[114:115], v4 offset:59392
    s_waitcnt lgkmcnt(10)
    v_mfma_f32_32x32x16_bf16 v[96:111], v[124:127], v[144:147], v[96:111]
    ds_read_b64_tr_b16 v[116:117], v5 offset:57344
    ds_read_b64_tr_b16 v[118:119], v5 offset:59392
    s_waitcnt vmcnt(9) lgkmcnt(10)
    v_mfma_f32_32x32x16_bf16 v[48:63], v[128:131], v[148:151], v[48:63]
    ds_read_b64_tr_b16 v[120:121], v6 offset:57344
    ds_read_b64_tr_b16 v[122:123], v6 offset:59392
    buffer_load_dwordx4 v[188:191], v8, s[4:7], s26 offen sc1
    s_add_u32 s26, s26, 65536
    s_waitcnt lgkmcnt(10)
    v_mfma_f32_32x32x16_bf16 v[64:79], v[132:135], v[148:151], v[64:79]
    ds_read_b64_tr_b16 v[124:125], v7 offset:57344
    ds_read_b64_tr_b16 v[126:127], v7 offset:59392
    s_waitcnt lgkmcnt(10)
    v_mfma_f32_32x32x16_bf16 v[80:95], v[136:139], v[148:151], v[80:95]
    ds_read_b64_tr_b16 v[128:129], v4 offset:61440
    ds_read_b64_tr_b16 v[130:131], v4 offset:63488
    s_waitcnt lgkmcnt(10)
    v_mfma_f32_32x32x16_bf16 v[96:111], v[140:143], v[148:151], v[96:111]
    ds_read_b64_tr_b16 v[132:133], v5 offset:61440
    ds_read_b64_tr_b16 v[134:135], v5 offset:63488
    s_waitcnt vmcnt(9) lgkmcnt(10)
    v_mfma_f32_32x32x16_bf16 v[48:63], v[112:115], v[152:155], v[48:63]
    ds_read_b64_tr_b16 v[136:137], v6 offset:61440
    ds_read_b64_tr_b16 v[138:139], v6 offset:63488
    buffer_load_dwordx4 v[192:195], v8, s[4:7], s26 offen sc1
    s_add_u32 s26, s26, 65536
    s_mov_b32 s23, 5242880
    buffer_load_dwordx2 v[32:33], v9, s[4:7], s23 offen sc1
    s_waitcnt lgkmcnt(10)
    v_mfma_f32_32x32x16_bf16 v[64:79], v[116:119], v[152:155], v[64:79]
    ds_read_b64_tr_b16 v[140:141], v7 offset:61440
    ds_read_b64_tr_b16 v[142:143], v7 offset:63488
    s_waitcnt lgkmcnt(10)
    v_mfma_f32_32x32x16_bf16 v[80:95], v[120:123], v[152:155], v[80:95]
    s_barrier
    v_add_u32 v4, 0x10000, v4
    v_add_u32 v5, 0x10000, v5
    v_add_u32 v6, 0x10000, v6
    v_add_u32 v7, 0x10000, v7
    ds_read_b64_tr_b16 v[112:113], v4 offset:0
    ds_read_b64_tr_b16 v[114:115], v4 offset:2048
    s_waitcnt lgkmcnt(10)
    v_mfma_f32_32x32x16_bf16 v[96:111], v[124:127], v[152:155], v[96:111]
    ds_read_b64_tr_b16 v[116:117], v5 offset:0
    ds_read_b64_tr_b16 v[118:119], v5 offset:2048
    s_waitcnt vmcnt(10) lgkmcnt(10)
    v_mfma_f32_32x32x16_bf16 v[48:63], v[128:131], v[156:159], v[48:63]
    ds_read_b64_tr_b16 v[120:121], v6 offset:0
    ds_read_b64_tr_b16 v[122:123], v6 offset:2048
    buffer_load_dwordx4 v[196:199], v8, s[4:7], s26 offen sc1
    s_add_u32 s26, s26, 65536
    s_mov_b32 s23, 5259264
    buffer_load_dwordx2 v[34:35], v9, s[4:7], s23 offen sc1
    s_waitcnt lgkmcnt(10)
    v_mfma_f32_32x32x16_bf16 v[64:79], v[132:135], v[156:159], v[64:79]
    ds_read_b64_tr_b16 v[124:125], v7 offset:0
    ds_read_b64_tr_b16 v[126:127], v7 offset:2048
    s_waitcnt lgkmcnt(10)
    v_mfma_f32_32x32x16_bf16 v[80:95], v[136:139], v[156:159], v[80:95]
    ds_read_b64_tr_b16 v[128:129], v4 offset:4096
    ds_read_b64_tr_b16 v[130:131], v4 offset:6144
    s_waitcnt lgkmcnt(10)
    v_mfma_f32_32x32x16_bf16 v[96:111], v[140:143], v[156:159], v[96:111]
    ds_read_b64_tr_b16 v[132:133], v5 offset:4096
    ds_read_b64_tr_b16 v[134:135], v5 offset:6144
    s_waitcnt vmcnt(11) lgkmcnt(10)
    v_mfma_f32_32x32x16_bf16 v[48:63], v[112:115], v[160:163], v[48:63]
    ds_read_b64_tr_b16 v[136:137], v6 offset:4096
    ds_read_b64_tr_b16 v[138:139], v6 offset:6144
    buffer_load_dwordx4 v[200:203], v8, s[4:7], s26 offen sc1
    s_add_u32 s26, s26, 65536
    s_mov_b32 s23, 5275648
    buffer_load_dwordx2 v[36:37], v9, s[4:7], s23 offen sc1
    s_waitcnt lgkmcnt(10)
    v_mfma_f32_32x32x16_bf16 v[64:79], v[116:119], v[160:163], v[64:79]
    ds_read_b64_tr_b16 v[140:141], v7 offset:4096
    ds_read_b64_tr_b16 v[142:143], v7 offset:6144
    s_waitcnt lgkmcnt(10)
    v_mfma_f32_32x32x16_bf16 v[80:95], v[120:123], v[160:163], v[80:95]
    ds_read_b64_tr_b16 v[112:113], v4 offset:8192
    ds_read_b64_tr_b16 v[114:115], v4 offset:10240
    s_waitcnt lgkmcnt(10)
    v_mfma_f32_32x32x16_bf16 v[96:111], v[124:127], v[160:163], v[96:111]
    ds_read_b64_tr_b16 v[116:117], v5 offset:8192
    ds_read_b64_tr_b16 v[118:119], v5 offset:10240
    s_waitcnt vmcnt(12) lgkmcnt(10)
    v_mfma_f32_32x32x16_bf16 v[48:63], v[128:131], v[164:167], v[48:63]
    ds_read_b64_tr_b16 v[120:121], v6 offset:8192
    ds_read_b64_tr_b16 v[122:123], v6 offset:10240
    buffer_load_dwordx4 v[204:207], v8, s[4:7], s26 offen sc1
    s_add_u32 s26, s26, 65536
    s_mov_b32 s23, 5292032
    buffer_load_dwordx2 v[38:39], v9, s[4:7], s23 offen sc1
    s_waitcnt lgkmcnt(10)
    v_mfma_f32_32x32x16_bf16 v[64:79], v[132:135], v[164:167], v[64:79]
    ds_read_b64_tr_b16 v[124:125], v7 offset:8192
    ds_read_b64_tr_b16 v[126:127], v7 offset:10240
    s_waitcnt lgkmcnt(10)
    v_mfma_f32_32x32x16_bf16 v[80:95], v[136:139], v[164:167], v[80:95]
    ds_read_b64_tr_b16 v[128:129], v4 offset:12288
    ds_read_b64_tr_b16 v[130:131], v4 offset:14336
    s_waitcnt lgkmcnt(10)
    v_mfma_f32_32x32x16_bf16 v[96:111], v[140:143], v[164:167], v[96:111]
    ds_read_b64_tr_b16 v[132:133], v5 offset:12288
    ds_read_b64_tr_b16 v[134:135], v5 offset:14336
    s_waitcnt vmcnt(13) lgkmcnt(10)
    v_mfma_f32_32x32x16_bf16 v[48:63], v[112:115], v[168:171], v[48:63]
    ds_read_b64_tr_b16 v[136:137], v6 offset:12288
    ds_read_b64_tr_b16 v[138:139], v6 offset:14336
    s_mov_b32 s23, 5308416
    buffer_load_dwordx2 v[40:41], v9, s[4:7], s23 offen sc1
    s_waitcnt lgkmcnt(10)
    v_mfma_f32_32x32x16_bf16 v[64:79], v[116:119], v[168:171], v[64:79]
    ds_read_b64_tr_b16 v[140:141], v7 offset:12288
    ds_read_b64_tr_b16 v[142:143], v7 offset:14336
    s_waitcnt lgkmcnt(10)
    v_mfma_f32_32x32x16_bf16 v[80:95], v[120:123], v[168:171], v[80:95]
    s_barrier
    ds_read_b64_tr_b16 v[112:113], v4 offset:16384
    ds_read_b64_tr_b16 v[114:115], v4 offset:18432
    s_waitcnt lgkmcnt(10)
    v_mfma_f32_32x32x16_bf16 v[96:111], v[124:127], v[168:171], v[96:111]
    ds_read_b64_tr_b16 v[116:117], v5 offset:16384
    ds_read_b64_tr_b16 v[118:119], v5 offset:18432
    s_waitcnt vmcnt(13) lgkmcnt(10)
    v_mfma_f32_32x32x16_bf16 v[48:63], v[128:131], v[172:175], v[48:63]
    ds_read_b64_tr_b16 v[120:121], v6 offset:16384
    ds_read_b64_tr_b16 v[122:123], v6 offset:18432
    s_waitcnt lgkmcnt(10)
    v_mfma_f32_32x32x16_bf16 v[64:79], v[132:135], v[172:175], v[64:79]
    ds_read_b64_tr_b16 v[124:125], v7 offset:16384
    ds_read_b64_tr_b16 v[126:127], v7 offset:18432
    s_waitcnt lgkmcnt(10)
    v_mfma_f32_32x32x16_bf16 v[80:95], v[136:139], v[172:175], v[80:95]
    ds_read_b64_tr_b16 v[128:129], v4 offset:20480
    ds_read_b64_tr_b16 v[130:131], v4 offset:22528
    s_waitcnt lgkmcnt(10)
    v_mfma_f32_32x32x16_bf16 v[96:111], v[140:143], v[172:175], v[96:111]
    ds_read_b64_tr_b16 v[132:133], v5 offset:20480
    ds_read_b64_tr_b16 v[134:135], v5 offset:22528
    s_waitcnt vmcnt(12) lgkmcnt(10)
    v_mfma_f32_32x32x16_bf16 v[48:63], v[112:115], v[176:179], v[48:63]
    ds_read_b64_tr_b16 v[136:137], v6 offset:20480
    ds_read_b64_tr_b16 v[138:139], v6 offset:22528
    s_waitcnt lgkmcnt(10)
    v_mfma_f32_32x32x16_bf16 v[64:79], v[116:119], v[176:179], v[64:79]
    ds_read_b64_tr_b16 v[140:141], v7 offset:20480
    ds_read_b64_tr_b16 v[142:143], v7 offset:22528
    s_waitcnt lgkmcnt(10)
    v_mfma_f32_32x32x16_bf16 v[80:95], v[120:123], v[176:179], v[80:95]
    ds_read_b64_tr_b16 v[112:113], v4 offset:24576
    ds_read_b64_tr_b16 v[114:115], v4 offset:26624
    s_waitcnt lgkmcnt(10)
    v_mfma_f32_32x32x16_bf16 v[96:111], v[124:127], v[176:179], v[96:111]
    ds_read_b64_tr_b16 v[116:117], v5 offset:24576
    ds_read_b64_tr_b16 v[118:119], v5 offset:26624
    s_waitcnt vmcnt(11) lgkmcnt(10)
    v_mfma_f32_32x32x16_bf16 v[48:63], v[128:131], v[180:183], v[48:63]
    ds_read_b64_tr_b16 v[120:121], v6 offset:24576
    ds_read_b64_tr_b16 v[122:123], v6 offset:26624
    s_waitcnt lgkmcnt(10)
    v_mfma_f32_32x32x16_bf16 v[64:79], v[132:135], v[180:183], v[64:79]
    ds_read_b64_tr_b16 v[124:125], v7 offset:24576
    ds_read_b64_tr_b16 v[126:127], v7 offset:26624
    s_waitcnt lgkmcnt(10)
    v_mfma_f32_32x32x16_bf16 v[80:95], v[136:139], v[180:183], v[80:95]
    ds_read_b64_tr_b16 v[128:129], v4 offset:28672
    ds_read_b64_tr_b16 v[130:131], v4 offset:30720
    s_waitcnt lgkmcnt(10)
    v_mfma_f32_32x32x16_bf16 v[96:111], v[140:143], v[180:183], v[96:111]
    ds_read_b64_tr_b16 v[132:133], v5 offset:28672
    ds_read_b64_tr_b16 v[134:135], v5 offset:30720
    s_waitcnt vmcnt(10) lgkmcnt(10)
    v_mfma_f32_32x32x16_bf16 v[48:63], v[112:115], v[184:187], v[48:63]
    ds_read_b64_tr_b16 v[136:137], v6 offset:28672
    ds_read_b64_tr_b16 v[138:139], v6 offset:30720
    s_waitcnt lgkmcnt(10)
    v_mfma_f32_32x32x16_bf16 v[64:79], v[116:119], v[184:187], v[64:79]
    ds_read_b64_tr_b16 v[140:141], v7 offset:28672
    ds_read_b64_tr_b16 v[142:143], v7 offset:30720
    s_waitcnt lgkmcnt(10)
    v_mfma_f32_32x32x16_bf16 v[80:95], v[120:123], v[184:187], v[80:95]
    s_barrier
    ds_read_b64_tr_b16 v[112:113], v4 offset:32768
    ds_read_b64_tr_b16 v[114:115], v4 offset:34816
    s_waitcnt lgkmcnt(10)
    v_mfma_f32_32x32x16_bf16 v[96:111], v[124:127], v[184:187], v[96:111]
    ds_read_b64_tr_b16 v[116:117], v5 offset:32768
    ds_read_b64_tr_b16 v[118:119], v5 offset:34816
    s_waitcnt vmcnt(9) lgkmcnt(10)
    v_mfma_f32_32x32x16_bf16 v[48:63], v[128:131], v[188:191], v[48:63]
    ds_read_b64_tr_b16 v[120:121], v6 offset:32768
    ds_read_b64_tr_b16 v[122:123], v6 offset:34816
    s_waitcnt lgkmcnt(10)
    v_mfma_f32_32x32x16_bf16 v[64:79], v[132:135], v[188:191], v[64:79]
    ds_read_b64_tr_b16 v[124:125], v7 offset:32768
    ds_read_b64_tr_b16 v[126:127], v7 offset:34816
    s_waitcnt lgkmcnt(10)
    v_mfma_f32_32x32x16_bf16 v[80:95], v[136:139], v[188:191], v[80:95]
    ds_read_b64_tr_b16 v[128:129], v4 offset:36864
    ds_read_b64_tr_b16 v[130:131], v4 offset:38912
    s_waitcnt lgkmcnt(10)
    v_mfma_f32_32x32x16_bf16 v[96:111], v[140:143], v[188:191], v[96:111]
    ds_read_b64_tr_b16 v[132:133], v5 offset:36864
    ds_read_b64_tr_b16 v[134:135], v5 offset:38912
    s_waitcnt vmcnt(8) lgkmcnt(10)
    v_mfma_f32_32x32x16_bf16 v[48:63], v[112:115], v[192:195], v[48:63]
    ds_read_b64_tr_b16 v[136:137], v6 offset:36864
    ds_read_b64_tr_b16 v[138:139], v6 offset:38912
    s_waitcnt lgkmcnt(10)
    v_mfma_f32_32x32x16_bf16 v[64:79], v[116:119], v[192:195], v[64:79]
    ds_read_b64_tr_b16 v[140:141], v7 offset:36864
    ds_read_b64_tr_b16 v[142:143], v7 offset:38912
    s_waitcnt vmcnt(0)
    v_add_f32 v32, v32, v34
    v_add_f32 v33, v33, v35
    s_waitcnt lgkmcnt(10)
    v_mfma_f32_32x32x16_bf16 v[80:95], v[120:123], v[192:195], v[80:95]
    ds_read_b64_tr_b16 v[112:113], v4 offset:40960
    ds_read_b64_tr_b16 v[114:115], v4 offset:43008
    v_add_f32 v32, v32, v36
    v_add_f32 v33, v33, v37
    s_waitcnt lgkmcnt(10)
    v_mfma_f32_32x32x16_bf16 v[96:111], v[124:127], v[192:195], v[96:111]
    ds_read_b64_tr_b16 v[116:117], v5 offset:40960
    ds_read_b64_tr_b16 v[118:119], v5 offset:43008
    v_add_f32 v32, v32, v38
    v_add_f32 v33, v33, v39
    s_waitcnt vmcnt(6) lgkmcnt(10)
    v_mfma_f32_32x32x16_bf16 v[48:63], v[128:131], v[196:199], v[48:63]
    ds_read_b64_tr_b16 v[120:121], v6 offset:40960
    ds_read_b64_tr_b16 v[122:123], v6 offset:43008
    v_add_f32 v32, v32, v40
    v_add_f32 v33, v33, v41
    s_waitcnt lgkmcnt(10)
    v_mfma_f32_32x32x16_bf16 v[64:79], v[132:135], v[196:199], v[64:79]
    ds_read_b64_tr_b16 v[124:125], v7 offset:40960
    ds_read_b64_tr_b16 v[126:127], v7 offset:43008
    v_mov_b32 v34, v32
    v_mov_b32 v35, v33
    s_waitcnt lgkmcnt(10)
    v_mfma_f32_32x32x16_bf16 v[80:95], v[136:139], v[196:199], v[80:95]
    ds_read_b64_tr_b16 v[128:129], v4 offset:45056
    ds_read_b64_tr_b16 v[130:131], v4 offset:47104
    v_permlane32_swap_b32 v32, v34
    v_permlane32_swap_b32 v33, v35
    s_waitcnt lgkmcnt(10)
    v_mfma_f32_32x32x16_bf16 v[96:111], v[140:143], v[196:199], v[96:111]
    ds_read_b64_tr_b16 v[132:133], v5 offset:45056
    ds_read_b64_tr_b16 v[134:135], v5 offset:47104
    v_add_f32 v32, v32, v34
    v_add_f32 v33, v33, v35
    s_waitcnt vmcnt(4) lgkmcnt(10)
    v_mfma_f32_32x32x16_bf16 v[48:63], v[112:115], v[200:203], v[48:63]
    ds_read_b64_tr_b16 v[136:137], v6 offset:45056
    ds_read_b64_tr_b16 v[138:139], v6 offset:47104
    v_mul_f32 v44, 0xbacccccd, v32
    v_mul_f32 v33, 0x3acccccd, v33
    s_waitcnt lgkmcnt(10)
    v_mfma_f32_32x32x16_bf16 v[64:79], v[116:119], v[200:203], v[64:79]
    ds_read_b64_tr_b16 v[140:141], v7 offset:45056
    ds_read_b64_tr_b16 v[142:143], v7 offset:47104
    v_fma_f32 v33, -v44, v44, v33
    v_max_f32 v33, 0, v33
    s_waitcnt lgkmcnt(10)
    v_mfma_f32_32x32x16_bf16 v[80:95], v[120:123], v[200:203], v[80:95]
    v_add_f32 v34, 0x3727c5ac, v33
    v_rsq_f32 v45, v34
    s_waitcnt lgkmcnt(8)
    v_mfma_f32_32x32x16_bf16 v[96:111], v[124:127], v[200:203], v[96:111]
    v_mul_f32 v34, v45, v45
    v_mul_f32 v34, v34, v33
    s_waitcnt vmcnt(2) lgkmcnt(6)
    v_mfma_f32_32x32x16_bf16 v[48:63], v[128:131], v[204:207], v[48:63]
    v_add_f32 v34, 0x3727c5ac, v34
    v_rsq_f32 v34, v34
    s_waitcnt lgkmcnt(4)
    v_mfma_f32_32x32x16_bf16 v[64:79], v[132:135], v[204:207], v[64:79]
    v_mul_f32 v45, v45, v34
    v_mul_f32 v45, 0x3eeff558, v45
    s_waitcnt lgkmcnt(2)
    v_mfma_f32_32x32x16_bf16 v[80:95], v[136:139], v[204:207], v[80:95]
    v_lshlrev_b32 v12, 4, v3
    v_add_u32 v12, 131072, v12
    s_waitcnt lgkmcnt(0)
    v_mfma_f32_32x32x16_bf16 v[96:111], v[140:143], v[204:207], v[96:111]
    s_barrier
    ds_read_b128 v[144:147], v12 offset:0
    ds_read_b128 v[148:151], v12 offset:32
    ds_read_b128 v[152:155], v12 offset:64
    ds_read_b128 v[156:159], v12 offset:96
    ds_read_b128 v[160:163], v12 offset:512
    ds_read_b128 v[164:167], v12 offset:544
    ds_read_b128 v[168:171], v12 offset:576
    ds_read_b128 v[172:175], v12 offset:608
    s_mov_b32 s58, 0x409d30fc
    s_mov_b32 s59, 0xbf8bf336
    s_mov_b32 s36, 0x3eeff558
    s_cmp_lg_u32 s95, 0
    s_cselect_b64 vcc, -1, 0
    s_waitcnt lgkmcnt(0)
    ds_read_b128 v[176:179], v12 offset:128
    ds_read_b128 v[180:183], v12 offset:160
    ds_read_b128 v[184:187], v12 offset:192
    ds_read_b128 v[188:191], v12 offset:224
    ds_read_b128 v[192:195], v12 offset:640
    ds_read_b128 v[196:199], v12 offset:672
    ds_read_b128 v[200:203], v12 offset:704
    ds_read_b128 v[204:207], v12 offset:736
    v_pk_fma_f32 v[48:49], v[144:145], v[44:45], v[48:49] op_sel_hi:[1,0,1]
    v_pk_fma_f32 v[50:51], v[146:147], v[44:45], v[50:51] op_sel_hi:[1,0,1]
    v_pk_fma_f32 v[52:53], v[148:149], v[44:45], v[52:53] op_sel_hi:[1,0,1]
    v_pk_fma_f32 v[54:55], v[150:151], v[44:45], v[54:55] op_sel_hi:[1,0,1]
    v_pk_fma_f32 v[56:57], v[152:153], v[44:45], v[56:57] op_sel_hi:[1,0,1]
    v_pk_fma_f32 v[58:59], v[154:155], v[44:45], v[58:59] op_sel_hi:[1,0,1]
    v_pk_fma_f32 v[60:61], v[156:157], v[44:45], v[60:61] op_sel_hi:[1,0,1]
    v_pk_fma_f32 v[62:63], v[158:159], v[44:45], v[62:63] op_sel_hi:[1,0,1]
    v_pk_fma_f32 v[48:49], v[48:49], v[44:45], v[160:161] op_sel:[0,1,0] op_sel_hi:[1,1,1]
    v_pk_fma_f32 v[50:51], v[50:51], v[44:45], v[162:163] op_sel:[0,1,0] op_sel_hi:[1,1,1]
    v_pk_fma_f32 v[52:53], v[52:53], v[44:45], v[164:165] op_sel:[0,1,0] op_sel_hi:[1,1,1]
    v_pk_fma_f32 v[54:55], v[54:55], v[44:45], v[166:167] op_sel:[0,1,0] op_sel_hi:[1,1,1]
    v_pk_fma_f32 v[56:57], v[56:57], v[44:45], v[168:169] op_sel:[0,1,0] op_sel_hi:[1,1,1]
    v_pk_fma_f32 v[58:59], v[58:59], v[44:45], v[170:171] op_sel:[0,1,0] op_sel_hi:[1,1,1]
    v_pk_fma_f32 v[60:61], v[60:61], v[44:45], v[172:173] op_sel:[0,1,0] op_sel_hi:[1,1,1]
    v_pk_fma_f32 v[62:63], v[62:63], v[44:45], v[174:175] op_sel:[0,1,0] op_sel_hi:[1,1,1]
    v_pk_fma_f32 v[112:113], v[48:49], v[48:49], s[58:59] op_sel_hi:[1,1,0]
    v_pk_fma_f32 v[114:115], v[50:51], v[50:51], s[58:59] op_sel_hi:[1,1,0]
    v_pk_fma_f32 v[116:117], v[52:53], v[52:53], s[58:59] op_sel_hi:[1,1,0]
    v_pk_fma_f32 v[118:119], v[54:55], v[54:55], s[58:59] op_sel_hi:[1,1,0]
    v_pk_fma_f32 v[120:121], v[56:57], v[56:57], s[58:59] op_sel_hi:[1,1,0]
    v_pk_fma_f32 v[122:123], v[58:59], v[58:59], s[58:59] op_sel_hi:[1,1,0]
    v_pk_fma_f32 v[124:125], v[60:61], v[60:61], s[58:59] op_sel_hi:[1,1,0]
    v_pk_fma_f32 v[126:127], v[62:63], v[62:63], s[58:59] op_sel_hi:[1,1,0]
    v_pk_fma_f32 v[112:113], v[112:113], v[48:49], s[58:59] op_sel:[0,0,1] op_sel_hi:[1,1,1] neg_lo:[0,1,0] neg_hi:[0,1,0]
    v_pk_fma_f32 v[114:115], v[114:115], v[50:51], s[58:59] op_sel:[0,0,1] op_sel_hi:[1,1,1] neg_lo:[0,1,0] neg_hi:[0,1,0]
    v_pk_fma_f32 v[116:117], v[116:117], v[52:53], s[58:59] op_sel:[0,0,1] op_sel_hi:[1,1,1] neg_lo:[0,1,0] neg_hi:[0,1,0]
    v_pk_fma_f32 v[118:119], v[118:119], v[54:55], s[58:59] op_sel:[0,0,1] op_sel_hi:[1,1,1] neg_lo:[0,1,0] neg_hi:[0,1,0]
    v_pk_fma_f32 v[120:121], v[120:121], v[56:57], s[58:59] op_sel:[0,0,1] op_sel_hi:[1,1,1] neg_lo:[0,1,0] neg_hi:[0,1,0]
    v_pk_fma_f32 v[122:123], v[122:123], v[58:59], s[58:59] op_sel:[0,0,1] op_sel_hi:[1,1,1] neg_lo:[0,1,0] neg_hi:[0,1,0]
    v_pk_fma_f32 v[124:125], v[124:125], v[60:61], s[58:59] op_sel:[0,0,1] op_sel_hi:[1,1,1] neg_lo:[0,1,0] neg_hi:[0,1,0]
    v_pk_fma_f32 v[126:127], v[126:127], v[62:63], s[58:59] op_sel:[0,0,1] op_sel_hi:[1,1,1] neg_lo:[0,1,0] neg_hi:[0,1,0]
    v_exp_f32 v112, v112
    v_exp_f32 v113, v113
    v_exp_f32 v114, v114
    v_exp_f32 v115, v115
    v_exp_f32 v116, v116
    v_exp_f32 v117, v117
    v_exp_f32 v118, v118
    v_exp_f32 v119, v119
    v_exp_f32 v120, v120
    v_exp_f32 v121, v121
    v_exp_f32 v122, v122
    v_exp_f32 v123, v123
    v_exp_f32 v124, v124
    v_exp_f32 v125, v125
    v_exp_f32 v126, v126
    v_exp_f32 v127, v127
    v_pk_add_f32 v[112:113], v[112:113], s[36:37] op_sel_hi:[1,0]
    v_pk_add_f32 v[114:115], v[114:115], s[36:37] op_sel_hi:[1,0]
    v_pk_add_f32 v[116:117], v[116:117], s[36:37] op_sel_hi:[1,0]
    v_pk_add_f32 v[118:119], v[118:119], s[36:37] op_sel_hi:[1,0]
    v_pk_add_f32 v[120:121], v[120:121], s[36:37] op_sel_hi:[1,0]
    v_pk_add_f32 v[122:123], v[122:123], s[36:37] op_sel_hi:[1,0]
    v_pk_add_f32 v[124:125], v[124:125], s[36:37] op_sel_hi:[1,0]
    v_pk_add_f32 v[126:127], v[126:127], s[36:37] op_sel_hi:[1,0]
    v_rcp_f32 v112, v112
    v_rcp_f32 v113, v113
    v_rcp_f32 v114, v114
    v_rcp_f32 v115, v115
    v_rcp_f32 v116, v116
    v_rcp_f32 v117, v117
    v_rcp_f32 v118, v118
    v_rcp_f32 v119, v119
    v_rcp_f32 v120, v120
    v_rcp_f32 v121, v121
    v_rcp_f32 v122, v122
    v_rcp_f32 v123, v123
    v_rcp_f32 v124, v124
    v_rcp_f32 v125, v125
    v_rcp_f32 v126, v126
    v_rcp_f32 v127, v127
    v_pk_mul_f32 v[48:49], v[48:49], v[112:113]
    v_pk_mul_f32 v[50:51], v[50:51], v[114:115]
    v_pk_mul_f32 v[52:53], v[52:53], v[116:117]
    v_pk_mul_f32 v[54:55], v[54:55], v[118:119]
    v_pk_mul_f32 v[56:57], v[56:57], v[120:121]
    v_pk_mul_f32 v[58:59], v[58:59], v[122:123]
    v_pk_mul_f32 v[60:61], v[60:61], v[124:125]
    v_pk_mul_f32 v[62:63], v[62:63], v[126:127]
    v_cvt_pk_bf16_f32 v128, v48, v49
    v_cvt_pk_bf16_f32 v129, v50, v51
    v_cvt_pk_bf16_f32 v130, v52, v53
    v_cvt_pk_bf16_f32 v131, v54, v55
    v_cvt_pk_bf16_f32 v132, v56, v57
    v_cvt_pk_bf16_f32 v133, v58, v59
    v_cvt_pk_bf16_f32 v134, v60, v61
    v_cvt_pk_bf16_f32 v135, v62, v63
    buffer_store_dwordx4 v[128:131], v10, s[4:7], s48 offen sc1
    buffer_store_dwordx4 v[132:135], v10, s[4:7], s49 offen sc1
    s_waitcnt lgkmcnt(0)
    ds_read_b128 v[144:147], v12 offset:256
    ds_read_b128 v[148:151], v12 offset:288
    ds_read_b128 v[152:155], v12 offset:320
    ds_read_b128 v[156:159], v12 offset:352
    ds_read_b128 v[160:163], v12 offset:768
    ds_read_b128 v[164:167], v12 offset:800
    ds_read_b128 v[168:171], v12 offset:832
    ds_read_b128 v[172:175], v12 offset:864
    v_pk_fma_f32 v[64:65], v[176:177], v[44:45], v[64:65] op_sel_hi:[1,0,1]
    v_pk_fma_f32 v[66:67], v[178:179], v[44:45], v[66:67] op_sel_hi:[1,0,1]
    v_pk_fma_f32 v[68:69], v[180:181], v[44:45], v[68:69] op_sel_hi:[1,0,1]
    v_pk_fma_f32 v[70:71], v[182:183], v[44:45], v[70:71] op_sel_hi:[1,0,1]
    v_pk_fma_f32 v[72:73], v[184:185], v[44:45], v[72:73] op_sel_hi:[1,0,1]
    v_pk_fma_f32 v[74:75], v[186:187], v[44:45], v[74:75] op_sel_hi:[1,0,1]
    v_pk_fma_f32 v[76:77], v[188:189], v[44:45], v[76:77] op_sel_hi:[1,0,1]
    v_pk_fma_f32 v[78:79], v[190:191], v[44:45], v[78:79] op_sel_hi:[1,0,1]
    v_pk_fma_f32 v[64:65], v[64:65], v[44:45], v[192:193] op_sel:[0,1,0] op_sel_hi:[1,1,1]
    v_pk_fma_f32 v[66:67], v[66:67], v[44:45], v[194:195] op_sel:[0,1,0] op_sel_hi:[1,1,1]
    v_pk_fma_f32 v[68:69], v[68:69], v[44:45], v[196:197] op_sel:[0,1,0] op_sel_hi:[1,1,1]
    v_pk_fma_f32 v[70:71], v[70:71], v[44:45], v[198:199] op_sel:[0,1,0] op_sel_hi:[1,1,1]
    v_pk_fma_f32 v[72:73], v[72:73], v[44:45], v[200:201] op_sel:[0,1,0] op_sel_hi:[1,1,1]
    v_pk_fma_f32 v[74:75], v[74:75], v[44:45], v[202:203] op_sel:[0,1,0] op_sel_hi:[1,1,1]
    v_pk_fma_f32 v[76:77], v[76:77], v[44:45], v[204:205] op_sel:[0,1,0] op_sel_hi:[1,1,1]
    v_pk_fma_f32 v[78:79], v[78:79], v[44:45], v[206:207] op_sel:[0,1,0] op_sel_hi:[1,1,1]
    v_pk_fma_f32 v[112:113], v[64:65], v[64:65], s[58:59] op_sel_hi:[1,1,0]
    v_pk_fma_f32 v[114:115], v[66:67], v[66:67], s[58:59] op_sel_hi:[1,1,0]
    v_pk_fma_f32 v[116:117], v[68:69], v[68:69], s[58:59] op_sel_hi:[1,1,0]
    v_pk_fma_f32 v[118:119], v[70:71], v[70:71], s[58:59] op_sel_hi:[1,1,0]
    v_pk_fma_f32 v[120:121], v[72:73], v[72:73], s[58:59] op_sel_hi:[1,1,0]
    v_pk_fma_f32 v[122:123], v[74:75], v[74:75], s[58:59] op_sel_hi:[1,1,0]
    v_pk_fma_f32 v[124:125], v[76:77], v[76:77], s[58:59] op_sel_hi:[1,1,0]
    v_pk_fma_f32 v[126:127], v[78:79], v[78:79], s[58:59] op_sel_hi:[1,1,0]
    v_pk_fma_f32 v[112:113], v[112:113], v[64:65], s[58:59] op_sel:[0,0,1] op_sel_hi:[1,1,1] neg_lo:[0,1,0] neg_hi:[0,1,0]
    v_pk_fma_f32 v[114:115], v[114:115], v[66:67], s[58:59] op_sel:[0,0,1] op_sel_hi:[1,1,1] neg_lo:[0,1,0] neg_hi:[0,1,0]
    v_pk_fma_f32 v[116:117], v[116:117], v[68:69], s[58:59] op_sel:[0,0,1] op_sel_hi:[1,1,1] neg_lo:[0,1,0] neg_hi:[0,1,0]
    v_pk_fma_f32 v[118:119], v[118:119], v[70:71], s[58:59] op_sel:[0,0,1] op_sel_hi:[1,1,1] neg_lo:[0,1,0] neg_hi:[0,1,0]
    v_pk_fma_f32 v[120:121], v[120:121], v[72:73], s[58:59] op_sel:[0,0,1] op_sel_hi:[1,1,1] neg_lo:[0,1,0] neg_hi:[0,1,0]
    v_pk_fma_f32 v[122:123], v[122:123], v[74:75], s[58:59] op_sel:[0,0,1] op_sel_hi:[1,1,1] neg_lo:[0,1,0] neg_hi:[0,1,0]
    v_pk_fma_f32 v[124:125], v[124:125], v[76:77], s[58:59] op_sel:[0,0,1] op_sel_hi:[1,1,1] neg_lo:[0,1,0] neg_hi:[0,1,0]
    v_pk_fma_f32 v[126:127], v[126:127], v[78:79], s[58:59] op_sel:[0,0,1] op_sel_hi:[1,1,1] neg_lo:[0,1,0] neg_hi:[0,1,0]
    v_exp_f32 v112, v112
    v_exp_f32 v113, v113
    v_exp_f32 v114, v114
    v_exp_f32 v115, v115
    v_exp_f32 v116, v116
    v_exp_f32 v117, v117
    v_exp_f32 v118, v118
    v_exp_f32 v119, v119
    v_exp_f32 v120, v120
    v_exp_f32 v121, v121
    v_exp_f32 v122, v122
    v_exp_f32 v123, v123
    v_exp_f32 v124, v124
    v_exp_f32 v125, v125
    v_exp_f32 v126, v126
    v_exp_f32 v127, v127
    v_pk_add_f32 v[112:113], v[112:113], s[36:37] op_sel_hi:[1,0]
    v_pk_add_f32 v[114:115], v[114:115], s[36:37] op_sel_hi:[1,0]
    v_pk_add_f32 v[116:117], v[116:117], s[36:37] op_sel_hi:[1,0]
    v_pk_add_f32 v[118:119], v[118:119], s[36:37] op_sel_hi:[1,0]
    v_pk_add_f32 v[120:121], v[120:121], s[36:37] op_sel_hi:[1,0]
    v_pk_add_f32 v[122:123], v[122:123], s[36:37] op_sel_hi:[1,0]
    v_pk_add_f32 v[124:125], v[124:125], s[36:37] op_sel_hi:[1,0]
    v_pk_add_f32 v[126:127], v[126:127], s[36:37] op_sel_hi:[1,0]
    v_rcp_f32 v112, v112
    v_rcp_f32 v113, v113
    v_rcp_f32 v114, v114
    v_rcp_f32 v115, v115
    v_rcp_f32 v116, v116
    v_rcp_f32 v117, v117
    v_rcp_f32 v118, v118
    v_rcp_f32 v119, v119
    v_rcp_f32 v120, v120
    v_rcp_f32 v121, v121
    v_rcp_f32 v122, v122
    v_rcp_f32 v123, v123
    v_rcp_f32 v124, v124
    v_rcp_f32 v125, v125
    v_rcp_f32 v126, v126
    v_rcp_f32 v127, v127
    v_pk_mul_f32 v[64:65], v[64:65], v[112:113]
    v_pk_mul_f32 v[66:67], v[66:67], v[114:115]
    v_pk_mul_f32 v[68:69], v[68:69], v[116:117]
    v_pk_mul_f32 v[70:71], v[70:71], v[118:119]
    v_pk_mul_f32 v[72:73], v[72:73], v[120:121]
    v_pk_mul_f32 v[74:75], v[74:75], v[122:123]
    v_pk_mul_f32 v[76:77], v[76:77], v[124:125]
    v_pk_mul_f32 v[78:79], v[78:79], v[126:127]
    v_cvt_pk_bf16_f32 v136, v64, v65
    v_cvt_pk_bf16_f32 v137, v66, v67
    v_cvt_pk_bf16_f32 v138, v68, v69
    v_cvt_pk_bf16_f32 v139, v70, v71
    v_cvt_pk_bf16_f32 v140, v72, v73
    v_cvt_pk_bf16_f32 v141, v74, v75
    v_cvt_pk_bf16_f32 v142, v76, v77
    v_cvt_pk_bf16_f32 v143, v78, v79
    buffer_store_dwordx4 v[136:139], v10, s[4:7], s50 offen sc1
    buffer_store_dwordx4 v[140:143], v10, s[4:7], s51 offen sc1
    s_cmp_eq_u32 s30, 13
    s_cbranch_scc1 L_p3_done4
    v_add_u32 v10, 262144, v10
    s_waitcnt lgkmcnt(0)
    ds_read_b128 v[176:179], v12 offset:384
    ds_read_b128 v[180:183], v12 offset:416
    ds_read_b128 v[184:187], v12 offset:448
    ds_read_b128 v[188:191], v12 offset:480
    ds_read_b128 v[192:195], v12 offset:896
    ds_read_b128 v[196:199], v12 offset:928
    ds_read_b128 v[200:203], v12 offset:960
    ds_read_b128 v[204:207], v12 offset:992
    v_pk_fma_f32 v[80:81], v[144:145], v[44:45], v[80:81] op_sel_hi:[1,0,1]
    v_pk_fma_f32 v[82:83], v[146:147], v[44:45], v[82:83] op_sel_hi:[1,0,1]
    v_pk_fma_f32 v[84:85], v[148:149], v[44:45], v[84:85] op_sel_hi:[1,0,1]
    v_pk_fma_f32 v[86:87], v[150:151], v[44:45], v[86:87] op_sel_hi:[1,0,1]
    v_pk_fma_f32 v[88:89], v[152:153], v[44:45], v[88:89] op_sel_hi:[1,0,1]
    v_pk_fma_f32 v[90:91], v[154:155], v[44:45], v[90:91] op_sel_hi:[1,0,1]
    v_pk_fma_f32 v[92:93], v[156:157], v[44:45], v[92:93] op_sel_hi:[1,0,1]
    v_pk_fma_f32 v[94:95], v[158:159], v[44:45], v[94:95] op_sel_hi:[1,0,1]
    v_pk_fma_f32 v[80:81], v[80:81], v[44:45], v[160:161] op_sel:[0,1,0] op_sel_hi:[1,1,1]
    v_pk_fma_f32 v[82:83], v[82:83], v[44:45], v[162:163] op_sel:[0,1,0] op_sel_hi:[1,1,1]
    v_pk_fma_f32 v[84:85], v[84:85], v[44:45], v[164:165] op_sel:[0,1,0] op_sel_hi:[1,1,1]
    v_pk_fma_f32 v[86:87], v[86:87], v[44:45], v[166:167] op_sel:[0,1,0] op_sel_hi:[1,1,1]
    v_pk_fma_f32 v[88:89], v[88:89], v[44:45], v[168:169] op_sel:[0,1,0] op_sel_hi:[1,1,1]
    v_pk_fma_f32 v[90:91], v[90:91], v[44:45], v[170:171] op_sel:[0,1,0] op_sel_hi:[1,1,1]
    v_pk_fma_f32 v[92:93], v[92:93], v[44:45], v[172:173] op_sel:[0,1,0] op_sel_hi:[1,1,1]
    v_pk_fma_f32 v[94:95], v[94:95], v[44:45], v[174:175] op_sel:[0,1,0] op_sel_hi:[1,1,1]
    v_pk_fma_f32 v[112:113], v[80:81], v[80:81], s[58:59] op_sel_hi:[1,1,0]
    v_pk_fma_f32 v[114:115], v[82:83], v[82:83], s[58:59] op_sel_hi:[1,1,0]
    v_pk_fma_f32 v[116:117], v[84:85], v[84:85], s[58:59] op_sel_hi:[1,1,0]
    v_pk_fma_f32 v[118:119], v[86:87], v[86:87], s[58:59] op_sel_hi:[1,1,0]
    v_pk_fma_f32 v[120:121], v[88:89], v[88:89], s[58:59] op_sel_hi:[1,1,0]
    v_pk_fma_f32 v[122:123], v[90:91], v[90:91], s[58:59] op_sel_hi:[1,1,0]
    v_pk_fma_f32 v[124:125], v[92:93], v[92:93], s[58:59] op_sel_hi:[1,1,0]
    v_pk_fma_f32 v[126:127], v[94:95], v[94:95], s[58:59] op_sel_hi:[1,1,0]
    v_pk_fma_f32 v[112:113], v[112:113], v[80:81], s[58:59] op_sel:[0,0,1] op_sel_hi:[1,1,1] neg_lo:[0,1,0] neg_hi:[0,1,0]
    v_pk_fma_f32 v[114:115], v[114:115], v[82:83], s[58:59] op_sel:[0,0,1] op_sel_hi:[1,1,1] neg_lo:[0,1,0] neg_hi:[0,1,0]
    v_pk_fma_f32 v[116:117], v[116:117], v[84:85], s[58:59] op_sel:[0,0,1] op_sel_hi:[1,1,1] neg_lo:[0,1,0] neg_hi:[0,1,0]
    v_pk_fma_f32 v[118:119], v[118:119], v[86:87], s[58:59] op_sel:[0,0,1] op_sel_hi:[1,1,1] neg_lo:[0,1,0] neg_hi:[0,1,0]
    v_pk_fma_f32 v[120:121], v[120:121], v[88:89], s[58:59] op_sel:[0,0,1] op_sel_hi:[1,1,1] neg_lo:[0,1,0] neg_hi:[0,1,0]
    v_pk_fma_f32 v[122:123], v[122:123], v[90:91], s[58:59] op_sel:[0,0,1] op_sel_hi:[1,1,1] neg_lo:[0,1,0] neg_hi:[0,1,0]
    v_pk_fma_f32 v[124:125], v[124:125], v[92:93], s[58:59] op_sel:[0,0,1] op_sel_hi:[1,1,1] neg_lo:[0,1,0] neg_hi:[0,1,0]
    v_pk_fma_f32 v[126:127], v[126:127], v[94:95], s[58:59] op_sel:[0,0,1] op_sel_hi:[1,1,1] neg_lo:[0,1,0] neg_hi:[0,1,0]
    v_exp_f32 v112, v112
    v_exp_f32 v113, v113
    v_exp_f32 v114, v114
    v_exp_f32 v115, v115
    v_exp_f32 v116, v116
    v_exp_f32 v117, v117
    v_exp_f32 v118, v118
    v_exp_f32 v119, v119
    v_exp_f32 v120, v120
    v_exp_f32 v121, v121
    v_exp_f32 v122, v122
    v_exp_f32 v123, v123
    v_exp_f32 v124, v124
    v_exp_f32 v125, v125
    v_exp_f32 v126, v126
    v_exp_f32 v127, v127
    v_pk_add_f32 v[112:113], v[112:113], s[36:37] op_sel_hi:[1,0]
    v_pk_add_f32 v[114:115], v[114:115], s[36:37] op_sel_hi:[1,0]
    v_pk_add_f32 v[116:117], v[116:117], s[36:37] op_sel_hi:[1,0]
    v_pk_add_f32 v[118:119], v[118:119], s[36:37] op_sel_hi:[1,0]
    v_pk_add_f32 v[120:121], v[120:121], s[36:37] op_sel_hi:[1,0]
    v_pk_add_f32 v[122:123], v[122:123], s[36:37] op_sel_hi:[1,0]
    v_pk_add_f32 v[124:125], v[124:125], s[36:37] op_sel_hi:[1,0]
    v_pk_add_f32 v[126:127], v[126:127], s[36:37] op_sel_hi:[1,0]
    v_rcp_f32 v112, v112
    v_rcp_f32 v113, v113
    v_rcp_f32 v114, v114
    v_rcp_f32 v115, v115
    v_rcp_f32 v116, v116
    v_rcp_f32 v117, v117
    v_rcp_f32 v118, v118
    v_rcp_f32 v119, v119
    v_rcp_f32 v120, v120
    v_rcp_f32 v121, v121
    v_rcp_f32 v122, v122
    v_rcp_f32 v123, v123
    v_rcp_f32 v124, v124
    v_rcp_f32 v125, v125
    v_rcp_f32 v126, v126
    v_rcp_f32 v127, v127
    v_pk_mul_f32 v[80:81], v[80:81], v[112:113]
    v_pk_mul_f32 v[82:83], v[82:83], v[114:115]
    v_pk_mul_f32 v[84:85], v[84:85], v[116:117]
    v_pk_mul_f32 v[86:87], v[86:87], v[118:119]
    v_pk_mul_f32 v[88:89], v[88:89], v[120:121]
    v_pk_mul_f32 v[90:91], v[90:91], v[122:123]
    v_pk_mul_f32 v[92:93], v[92:93], v[124:125]
    v_pk_mul_f32 v[94:95], v[94:95], v[126:127]
    v_cvt_pk_bf16_f32 v128, v80, v81
    v_cvt_pk_bf16_f32 v129, v82, v83
    v_cvt_pk_bf16_f32 v130, v84, v85
    v_cvt_pk_bf16_f32 v131, v86, v87
    v_cvt_pk_bf16_f32 v132, v88, v89
    v_cvt_pk_bf16_f32 v133, v90, v91
    v_cvt_pk_bf16_f32 v134, v92, v93
    v_cvt_pk_bf16_f32 v135, v94, v95
    buffer_store_dwordx4 v[128:131], v10, s[4:7], s48 offen sc1
    buffer_store_dwordx4 v[132:135], v10, s[4:7], s49 offen sc1
    s_waitcnt lgkmcnt(0)
    v_pk_fma_f32 v[96:97], v[176:177], v[44:45], v[96:97] op_sel_hi:[1,0,1]
    v_pk_fma_f32 v[98:99], v[178:179], v[44:45], v[98:99] op_sel_hi:[1,0,1]
    v_pk_fma_f32 v[100:101], v[180:181], v[44:45], v[100:101] op_sel_hi:[1,0,1]
    v_pk_fma_f32 v[102:103], v[182:183], v[44:45], v[102:103] op_sel_hi:[1,0,1]
    v_pk_fma_f32 v[104:105], v[184:185], v[44:45], v[104:105] op_sel_hi:[1,0,1]
    v_pk_fma_f32 v[106:107], v[186:187], v[44:45], v[106:107] op_sel_hi:[1,0,1]
    v_pk_fma_f32 v[108:109], v[188:189], v[44:45], v[108:109] op_sel_hi:[1,0,1]
    v_pk_fma_f32 v[110:111], v[190:191], v[44:45], v[110:111] op_sel_hi:[1,0,1]
    v_pk_fma_f32 v[96:97], v[96:97], v[44:45], v[192:193] op_sel:[0,1,0] op_sel_hi:[1,1,1]
    v_pk_fma_f32 v[98:99], v[98:99], v[44:45], v[194:195] op_sel:[0,1,0] op_sel_hi:[1,1,1]
    v_pk_fma_f32 v[100:101], v[100:101], v[44:45], v[196:197] op_sel:[0,1,0] op_sel_hi:[1,1,1]
    v_pk_fma_f32 v[102:103], v[102:103], v[44:45], v[198:199] op_sel:[0,1,0] op_sel_hi:[1,1,1]
    v_pk_fma_f32 v[104:105], v[104:105], v[44:45], v[200:201] op_sel:[0,1,0] op_sel_hi:[1,1,1]
    v_pk_fma_f32 v[106:107], v[106:107], v[44:45], v[202:203] op_sel:[0,1,0] op_sel_hi:[1,1,1]
    v_pk_fma_f32 v[108:109], v[108:109], v[44:45], v[204:205] op_sel:[0,1,0] op_sel_hi:[1,1,1]
    v_pk_fma_f32 v[110:111], v[110:111], v[44:45], v[206:207] op_sel:[0,1,0] op_sel_hi:[1,1,1]
    v_pk_fma_f32 v[112:113], v[96:97], v[96:97], s[58:59] op_sel_hi:[1,1,0]
    v_pk_fma_f32 v[114:115], v[98:99], v[98:99], s[58:59] op_sel_hi:[1,1,0]
    v_pk_fma_f32 v[116:117], v[100:101], v[100:101], s[58:59] op_sel_hi:[1,1,0]
    v_pk_fma_f32 v[118:119], v[102:103], v[102:103], s[58:59] op_sel_hi:[1,1,0]
    v_pk_fma_f32 v[120:121], v[104:105], v[104:105], s[58:59] op_sel_hi:[1,1,0]
    v_pk_fma_f32 v[122:123], v[106:107], v[106:107], s[58:59] op_sel_hi:[1,1,0]
    v_pk_fma_f32 v[124:125], v[108:109], v[108:109], s[58:59] op_sel_hi:[1,1,0]
    v_pk_fma_f32 v[126:127], v[110:111], v[110:111], s[58:59] op_sel_hi:[1,1,0]
    v_pk_fma_f32 v[112:113], v[112:113], v[96:97], s[58:59] op_sel:[0,0,1] op_sel_hi:[1,1,1] neg_lo:[0,1,0] neg_hi:[0,1,0]
    v_pk_fma_f32 v[114:115], v[114:115], v[98:99], s[58:59] op_sel:[0,0,1] op_sel_hi:[1,1,1] neg_lo:[0,1,0] neg_hi:[0,1,0]
    v_pk_fma_f32 v[116:117], v[116:117], v[100:101], s[58:59] op_sel:[0,0,1] op_sel_hi:[1,1,1] neg_lo:[0,1,0] neg_hi:[0,1,0]
    v_pk_fma_f32 v[118:119], v[118:119], v[102:103], s[58:59] op_sel:[0,0,1] op_sel_hi:[1,1,1] neg_lo:[0,1,0] neg_hi:[0,1,0]
    v_pk_fma_f32 v[120:121], v[120:121], v[104:105], s[58:59] op_sel:[0,0,1] op_sel_hi:[1,1,1] neg_lo:[0,1,0] neg_hi:[0,1,0]
    v_pk_fma_f32 v[122:123], v[122:123], v[106:107], s[58:59] op_sel:[0,0,1] op_sel_hi:[1,1,1] neg_lo:[0,1,0] neg_hi:[0,1,0]
    v_pk_fma_f32 v[124:125], v[124:125], v[108:109], s[58:59] op_sel:[0,0,1] op_sel_hi:[1,1,1] neg_lo:[0,1,0] neg_hi:[0,1,0]
    v_pk_fma_f32 v[126:127], v[126:127], v[110:111], s[58:59] op_sel:[0,0,1] op_sel_hi:[1,1,1] neg_lo:[0,1,0] neg_hi:[0,1,0]
    v_exp_f32 v112, v112
    v_exp_f32 v113, v113
    v_exp_f32 v114, v114
    v_exp_f32 v115, v115
    v_exp_f32 v116, v116
    v_exp_f32 v117, v117
    v_exp_f32 v118, v118
    v_exp_f32 v119, v119
    v_exp_f32 v120, v120
    v_exp_f32 v121, v121
    v_exp_f32 v122, v122
    v_exp_f32 v123, v123
    v_exp_f32 v124, v124
    v_exp_f32 v125, v125
    v_exp_f32 v126, v126
    v_exp_f32 v127, v127
    v_pk_add_f32 v[112:113], v[112:113], s[36:37] op_sel_hi:[1,0]
    v_pk_add_f32 v[114:115], v[114:115], s[36:37] op_sel_hi:[1,0]
    v_pk_add_f32 v[116:117], v[116:117], s[36:37] op_sel_hi:[1,0]
    v_pk_add_f32 v[118:119], v[118:119], s[36:37] op_sel_hi:[1,0]
    v_pk_add_f32 v[120:121], v[120:121], s[36:37] op_sel_hi:[1,0]
    v_pk_add_f32 v[122:123], v[122:123], s[36:37] op_sel_hi:[1,0]
    v_pk_add_f32 v[124:125], v[124:125], s[36:37] op_sel_hi:[1,0]
    v_pk_add_f32 v[126:127], v[126:127], s[36:37] op_sel_hi:[1,0]
    v_rcp_f32 v112, v112
    v_rcp_f32 v113, v113
    v_rcp_f32 v114, v114
    v_rcp_f32 v115, v115
    v_rcp_f32 v116, v116
    v_rcp_f32 v117, v117
    v_rcp_f32 v118, v118
    v_rcp_f32 v119, v119
    v_rcp_f32 v120, v120
    v_rcp_f32 v121, v121
    v_rcp_f32 v122, v122
    v_rcp_f32 v123, v123
    v_rcp_f32 v124, v124
    v_rcp_f32 v125, v125
    v_rcp_f32 v126, v126
    v_rcp_f32 v127, v127
    v_pk_mul_f32 v[96:97], v[96:97], v[112:113]
    v_pk_mul_f32 v[98:99], v[98:99], v[114:115]
    v_pk_mul_f32 v[100:101], v[100:101], v[116:117]
    v_pk_mul_f32 v[102:103], v[102:103], v[118:119]
    v_pk_mul_f32 v[104:105], v[104:105], v[120:121]
    v_pk_mul_f32 v[106:107], v[106:107], v[122:123]
    v_pk_mul_f32 v[108:109], v[108:109], v[124:125]
    v_pk_mul_f32 v[110:111], v[110:111], v[126:127]
    v_cvt_pk_bf16_f32 v136, v96, v97
    v_cvt_pk_bf16_f32 v137, v98, v99
    v_cvt_pk_bf16_f32 v138, v100, v101
    v_cvt_pk_bf16_f32 v139, v102, v103
    v_cvt_pk_bf16_f32 v140, v104, v105
    v_cvt_pk_bf16_f32 v141, v106, v107
    v_cvt_pk_bf16_f32 v142, v108, v109
    v_cvt_pk_bf16_f32 v143, v110, v111
    buffer_store_dwordx4 v[136:139], v10, s[4:7], s50 offen sc1
    buffer_store_dwordx4 v[140:143], v10, s[4:7], s51 offen sc1
L_p3_done4:
    s_waitcnt vmcnt(0) lgkmcnt(0)
    s_barrier
    s_cmp_lg_u32 s22, 3
    s_cbranch_scc1 L_p3_p5
    s_lshl_b32 s23, s94, 7
    s_add_u32 s23, s23, 21069824
    v_mov_b32 v12, 0
    v_mov_b32 v13, s88
    s_mov_b64 exec, 1
    s_cmp_lg_u32 s95, 0
    s_cselect_b64 vcc, -1, 0
    s_cbranch_vccz L_slow5
    buffer_store_dword v13, v12, s[4:7], s23 offen
L_back5:
    s_mov_b64 exec, -1
    v_min_u32 v12, 27, v1
    s_lshl_b32 s23, s32, 12
    s_add_u32 s23, s23, 21069824
    v_lshl_add_u32 v12, v12, 7, s23
    s_mov_b32 s28, 0
    s_mov_b64 s[90:91], -1
L_p3_poll5:
    buffer_load_dword v248, v12, s[4:7], 0 offen sc1
    s_waitcnt vmcnt(0)
    v_cmp_ne_u32 vcc, s88, v248
    s_nop 1
    s_and_b64 exec, exec, vcc
    s_cbranch_execz L_p3_go5
    s_sleep 1
    s_add_u32 s28, s28, 1
    s_cmp_lt_u32 s28, 0x4000
    s_cbranch_scc1 L_p3_poll5
L_p3_go5:
    s_mov_b64 exec, -1
    s_branch L_p3_p5
L_p3_skip4:
    s_waitcnt vmcnt(0)
    s_barrier
    s_cmp_lg_u32 s22, 3
    s_cbranch_scc1 L_p3_p5
    s_lshl_b32 s23, s94, 7
    s_add_u32 s23, s23, 21037056
    v_mov_b32 v12, 0
    v_mov_b32 v13, s88
    s_mov_b64 exec, 1
    s_cmp_lg_u32 s95, 0
    s_cselect_b64 vcc, -1, 0
    s_cbranch_vccz L_slow6
    buffer_store_dword v13, v12, s[4:7], s23 offen
L_back6:
    s_mov_b64 exec, -1
    v_min_u32 v12, 27, v1
    s_lshl_b32 s23, s32, 12
    s_add_u32 s23, s23, 21069824
    v_lshl_add_u32 v12, v12, 7, s23
    s_mov_b32 s28, 0
    s_mov_b64 s[90:91], -1
L_p3_poll6:
    buffer_load_dword v248, v12, s[4:7], 0 offen sc1
    s_waitcnt vmcnt(0)
    v_cmp_ne_u32 vcc, s88, v248
    s_nop 1
    s_and_b64 exec, exec, vcc
    s_cbranch_execz L_p3_go6
    s_sleep 8
    s_add_u32 s28, s28, 1
    s_cmp_lt_u32 s28, 0x4000
    s_cbranch_scc1 L_p3_poll6
L_p3_go6:
    s_mov_b64 exec, -1
L_p3_p5:
    s_cmp_ge_u32 s25, 8
    s_cbranch_scc1 L_p3_idle5
    v_add_u32 v12, s34, v2
    v_lshlrev_b32 v8, 15, v3
    v_lshl_add_u32 v8, v12, 4, v8
    s_mov_b32 s26, 7864320
    s_lshl_b32 s24, s21, 7
    v_mul_u32_u24 v13, 1280, v12
    v_lshl_add_u32 v13, v3, 4, v13
    v_add_u32 v10, s24, v13
    s_mov_b32 s12, s56
    s_and_b32 s13, s57, 0xffff
    s_mov_b32 s14, 0x280000
    s_mov_b32 s15, 0x00020000
    s_mov_b32 s16, s46
    s_and_b32 s17, s47, 0xffff
    s_mov_b32 s18, 0x500
    s_mov_b32 s19, 0x00020000
    v_lshlrev_b32 v14, 3, v3
    buffer_load_dwordx2 v[32:33], v14, s[16:19], s24 offen offset:0
    buffer_load_dwordx2 v[34:35], v14, s[16:19], s24 offen offset:16
    buffer_load_dwordx2 v[36:37], v14, s[16:19], s24 offen offset:32
    buffer_load_dwordx2 v[38:39], v14, s[16:19], s24 offen offset:48
    buffer_load_dwordx2 v[40:41], v14, s[16:19], s24 offen offset:64
    buffer_load_dwordx2 v[42:43], v14, s[16:19], s24 offen offset:80
    buffer_load_dwordx2 v[44:45], v14, s[16:19], s24 offen offset:96
    buffer_load_dwordx2 v[46:47], v14, s[16:19], s24 offen offset:112
    v_bfe_u32 v12, v1, 2, 2
    v_lshl_add_u32 v12, v3, 2, v12
    v_lshlrev_b32 v12, 7, v12
    v_bfe_u32 v15, v1, 3, 1
    v_lshl_add_u32 v12, v15, 6, v12
    v_bfe_u32 v15, v1, 4, 1
    v_lshl_add_u32 v12, v15, 5, v12
    v_and_b32 v15, 3, v1
    v_lshl_add_u32 v4, v15, 3, v12
    v_xor_b32 v5, 64, v4
    v_lshlrev_b32 v48, 16, v16
    v_and_b32 v49, 0xffff0000, v16
    v_lshlrev_b32 v50, 16, v17
    v_and_b32 v51, 0xffff0000, v17
    v_lshlrev_b32 v52, 16, v18
    v_and_b32 v53, 0xffff0000, v18
    v_lshlrev_b32 v54, 16, v19
    v_and_b32 v55, 0xffff0000, v19
    v_lshlrev_b32 v56, 16, v20
    v_and_b32 v57, 0xffff0000, v20
    v_lshlrev_b32 v58, 16, v21
    v_and_b32 v59, 0xffff0000, v21
    v_lshlrev_b32 v60, 16, v22
    v_and_b32 v61, 0xffff0000, v22
    v_lshlrev_b32 v62, 16, v23
    v_and_b32 v63, 0xffff0000, v23
    v_lshlrev_b32 v64, 16, v24
    v_and_b32 v65, 0xffff0000, v24
    v_lshlrev_b32 v66, 16, v25
    v_and_b32 v67, 0xffff0000, v25
    v_lshlrev_b32 v68, 16, v26
    v_and_b32 v69, 0xffff0000, v26
    v_lshlrev_b32 v70, 16, v27
    v_and_b32 v71, 0xffff0000, v27
    v_lshlrev_b32 v72, 16, v28
    v_and_b32 v73, 0xffff0000, v28
    v_lshlrev_b32 v74, 16, v29
    v_and_b32 v75, 0xffff0000, v29
    v_lshlrev_b32 v76, 16, v30
    v_and_b32 v77, 0xffff0000, v30
    v_lshlrev_b32 v78, 16, v31
    v_and_b32 v79, 0xffff0000, v31
    s_waitcnt vmcnt(0)
    v_lshlrev_b32 v112, 16, v32
    v_and_b32 v113, 0xffff0000, v32
    v_lshlrev_b32 v114, 16, v33
    v_and_b32 v115, 0xffff0000, v33
    v_lshlrev_b32 v116, 16, v34
    v_and_b32 v117, 0xffff0000, v34
    v_lshlrev_b32 v118, 16, v35
    v_and_b32 v119, 0xffff0000, v35
    v_lshlrev_b32 v120, 16, v36
    v_and_b32 v121, 0xffff0000, v36
    v_lshlrev_b32 v122, 16, v37
    v_and_b32 v123, 0xffff0000, v37
    v_lshlrev_b32 v124, 16, v38
    v_and_b32 v125, 0xffff0000, v38
    v_lshlrev_b32 v126, 16, v39
    v_and_b32 v127, 0xffff0000, v39
    v_lshlrev_b32 v128, 16, v40
    v_and_b32 v129, 0xffff0000, v40
    v_lshlrev_b32 v130, 16, v41
    v_and_b32 v131, 0xffff0000, v41
    v_lshlrev_b32 v132, 16, v42
    v_and_b32 v133, 0xffff0000, v42
    v_lshlrev_b32 v134, 16, v43
    v_and_b32 v135, 0xffff0000, v43
    v_lshlrev_b32 v136, 16, v44
    v_and_b32 v137, 0xffff0000, v44
    v_lshlrev_b32 v138, 16, v45
    v_and_b32 v139, 0xffff0000, v45
    v_lshlrev_b32 v140, 16, v46
    v_and_b32 v141, 0xffff0000, v46
    v_lshlrev_b32 v142, 16, v47
    v_and_b32 v143, 0xffff0000, v47
    v_pk_add_f32 v[48:49], v[48:49], v[112:113]
    v_pk_add_f32 v[50:51], v[50:51], v[114:115]
    v_pk_add_f32 v[52:53], v[52:53], v[116:117]
    v_pk_add_f32 v[54:55], v[54:55], v[118:119]
    v_pk_add_f32 v[56:57], v[56:57], v[120:121]
    v_pk_add_f32 v[58:59], v[58:59], v[122:123]
    v_pk_add_f32 v[60:61], v[60:61], v[124:125]
    v_pk_add_f32 v[62:63], v[62:63], v[126:127]
    v_pk_add_f32 v[64:65], v[64:65], v[128:129]
    v_pk_add_f32 v[66:67], v[66:67], v[130:131]
    v_pk_add_f32 v[68:69], v[68:69], v[132:133]
    v_pk_add_f32 v[70:71], v[70:71], v[134:135]
    v_pk_add_f32 v[72:73], v[72:73], v[136:137]
    v_pk_add_f32 v[74:75], v[74:75], v[138:139]
    v_pk_add_f32 v[76:77], v[76:77], v[140:141]
    v_pk_add_f32 v[78:79], v[78:79], v[142:143]
    s_lshl_b32 s23, s22, 12
    s_add_u32 s23, s23, 133120
    v_and_b32 v12, 7, v1
    v_xor_b32 v13, v12, v3
    v_lshl_add_u32 v14, v2, 7, s23
    v_xor_b32 v15, 0, v13
    v_lshl_add_u32 v32, v15, 4, v14
    v_xor_b32 v15, 2, v13
    v_lshl_add_u32 v33, v15, 4, v14
    v_xor_b32 v15, 4, v13
    v_lshl_add_u32 v34, v15, 4, v14
    v_xor_b32 v15, 6, v13
    v_lshl_add_u32 v35, v15, 4, v14
    v_lshrrev_b32 v13, 3, v1
    v_xor_b32 v15, v12, v13
    v_lshl_add_u32 v14, v13, 7, s23
    v_lshl_add_u32 v36, v15, 4, v14
    v_add_u32 v13, s34, v13
    v_mul_u32_u24 v13, 1280, v13
    v_lshl_add_u32 v13, v12, 4, v13
    v_add_u32 v37, s24, v13
    s_mov_b32 s48, 0
    s_mov_b32 s49, 10240
    s_mov_b32 s50, 20480
    s_mov_b32 s51, 30720
    s_barrier
    buffer_load_dwordx4 v[112:115], v8, s[4:7], s26 offen sc1
    s_add_u32 s26, s26, 65536
    buffer_load_dwordx4 v[116:119], v8, s[4:7], s26 offen sc1
    s_add_u32 s26, s26, 65536
    buffer_load_dwordx4 v[120:123], v8, s[4:7], s26 offen sc1
    s_add_u32 s26, s26, 65536
    buffer_load_dwordx4 v[124:127], v8, s[4:7], s26 offen sc1
    s_add_u32 s26, s26, 65536
    buffer_load_dwordx4 v[128:131], v8, s[4:7], s26 offen sc1
    s_add_u32 s26, s26, 65536
    buffer_load_dwordx4 v[132:135], v8, s[4:7], s26 offen sc1
    s_add_u32 s26, s26, 65536
    buffer_load_dwordx4 v[136:139], v8, s[4:7], s26 offen sc1
    s_add_u32 s26, s26, 65536
    buffer_load_dwordx4 v[140:143], v8, s[4:7], s26 offen sc1
    s_add_u32 s26, s26, 65536
    s_barrier
    v_add_u32 v4, 0x10000, v4
    v_add_u32 v5, 0x10000, v5
    ds_read_b64_tr_b16 v[80:81], v4 offset:49152
    ds_read_b64_tr_b16 v[82:83], v4 offset:50176
    ds_read_b64_tr_b16 v[84:85], v5 offset:49152
    ds_read_b64_tr_b16 v[86:87], v5 offset:50176
    ds_read_b64_tr_b16 v[88:89], v4 offset:51200
    ds_read_b64_tr_b16 v[90:91], v4 offset:52224
    ds_read_b64_tr_b16 v[92:93], v5 offset:51200
    ds_read_b64_tr_b16 v[94:95], v5 offset:52224
    ds_read_b64_tr_b16 v[96:97], v4 offset:53248
    ds_read_b64_tr_b16 v[98:99], v4 offset:54272
    ds_read_b64_tr_b16 v[100:101], v5 offset:53248
    ds_read_b64_tr_b16 v[102:103], v5 offset:54272
    s_waitcnt vmcnt(7) lgkmcnt(10)
    v_mfma_f32_32x32x16_bf16 v[48:63], v[80:83], v[112:115], v[48:63]
    ds_read_b64_tr_b16 v[104:105], v4 offset:55296
    ds_read_b64_tr_b16 v[106:107], v4 offset:56320
    buffer_load_dwordx4 v[144:147], v8, s[4:7], s26 offen sc1
    s_add_u32 s26, s26, 65536
    s_waitcnt lgkmcnt(10)
    v_mfma_f32_32x32x16_bf16 v[64:79], v[84:87], v[112:115], v[64:79]
    ds_read_b64_tr_b16 v[108:109], v5 offset:55296
    ds_read_b64_tr_b16 v[110:111], v5 offset:56320
    buffer_load_dwordx4 v[148:151], v8, s[4:7], s26 offen sc1
    s_add_u32 s26, s26, 65536
    s_waitcnt vmcnt(8) lgkmcnt(10)
    v_mfma_f32_32x32x16_bf16 v[48:63], v[88:91], v[116:119], v[48:63]
    ds_read_b64_tr_b16 v[80:81], v4 offset:57344
    ds_read_b64_tr_b16 v[82:83], v4 offset:58368
    buffer_load_dwordx4 v[152:155], v8, s[4:7], s26 offen sc1
    s_add_u32 s26, s26, 65536
    s_waitcnt lgkmcnt(10)
    v_mfma_f32_32x32x16_bf16 v[64:79], v[92:95], v[116:119], v[64:79]
    ds_read_b64_tr_b16 v[84:85], v5 offset:57344
    ds_read_b64_tr_b16 v[86:87], v5 offset:58368
    buffer_load_dwordx4 v[156:159], v8, s[4:7], s26 offen sc1
    s_add_u32 s26, s26, 65536
    s_waitcnt vmcnt(9) lgkmcnt(10)
    v_mfma_f32_32x32x16_bf16 v[48:63], v[96:99], v[120:123], v[48:63]
    ds_read_b64_tr_b16 v[88:89], v4 offset:59392
    ds_read_b64_tr_b16 v[90:91], v4 offset:60416
    buffer_load_dwordx4 v[160:163], v8, s[4:7], s26 offen sc1
    s_add_u32 s26, s26, 65536
    s_waitcnt lgkmcnt(10)
    v_mfma_f32_32x32x16_bf16 v[64:79], v[100:103], v[120:123], v[64:79]
    ds_read_b64_tr_b16 v[92:93], v5 offset:59392
    ds_read_b64_tr_b16 v[94:95], v5 offset:60416
    buffer_load_dwordx4 v[164:167], v8, s[4:7], s26 offen sc1
    s_add_u32 s26, s26, 65536
    s_waitcnt vmcnt(10) lgkmcnt(10)
    v_mfma_f32_32x32x16_bf16 v[48:63], v[104:107], v[124:127], v[48:63]
    ds_read_b64_tr_b16 v[96:97], v4 offset:61440
    ds_read_b64_tr_b16 v[98:99], v4 offset:62464
    buffer_load_dwordx4 v[168:171], v8, s[4:7], s26 offen sc1
    s_add_u32 s26, s26, 65536
    s_waitcnt lgkmcnt(10)
    v_mfma_f32_32x32x16_bf16 v[64:79], v[108:111], v[124:127], v[64:79]
    ds_read_b64_tr_b16 v[100:101], v5 offset:61440
    ds_read_b64_tr_b16 v[102:103], v5 offset:62464
    buffer_load_dwordx4 v[172:175], v8, s[4:7], s26 offen sc1
    s_add_u32 s26, s26, 65536
    s_waitcnt vmcnt(11) lgkmcnt(10)
    v_mfma_f32_32x32x16_bf16 v[48:63], v[80:83], v[128:131], v[48:63]
    ds_read_b64_tr_b16 v[104:105], v4 offset:63488
    ds_read_b64_tr_b16 v[106:107], v4 offset:64512
    buffer_load_dwordx4 v[176:179], v8, s[4:7], s26 offen sc1
    s_add_u32 s26, s26, 65536
    s_waitcnt lgkmcnt(10)
    v_mfma_f32_32x32x16_bf16 v[64:79], v[84:87], v[128:131], v[64:79]
    ds_read_b64_tr_b16 v[108:109], v5 offset:63488
    ds_read_b64_tr_b16 v[110:111], v5 offset:64512
    buffer_load_dwordx4 v[180:183], v8, s[4:7], s26 offen sc1
    s_add_u32 s26, s26, 65536
    s_waitcnt vmcnt(12) lgkmcnt(10)
    v_mfma_f32_32x32x16_bf16 v[48:63], v[88:91], v[132:135], v[48:63]
    s_barrier
    v_add_u32 v4, 0xffff0000, v4
    v_add_u32 v5, 0xffff0000, v5
    ds_read_b64_tr_b16 v[80:81], v4 offset:0
    ds_read_b64_tr_b16 v[82:83], v4 offset:1024
    buffer_load_dwordx4 v[184:187], v8, s[4:7], s26 offen sc1
    s_add_u32 s26, s26, 65536
    s_waitcnt lgkmcnt(10)
    v_mfma_f32_32x32x16_bf16 v[64:79], v[92:95], v[132:135], v[64:79]
    ds_read_b64_tr_b16 v[84:85], v5 offset:0
    ds_read_b64_tr_b16 v[86:87], v5 offset:1024
    buffer_load_dwordx4 v[188:191], v8, s[4:7], s26 offen sc1
    s_add_u32 s26, s26, 65536
    s_waitcnt vmcnt(13) lgkmcnt(10)
    v_mfma_f32_32x32x16_bf16 v[48:63], v[96:99], v[136:139], v[48:63]
    ds_read_b64_tr_b16 v[88:89], v4 offset:2048
    ds_read_b64_tr_b16 v[90:91], v4 offset:3072
    buffer_load_dwordx4 v[192:195], v8, s[4:7], s26 offen sc1
    s_add_u32 s26, s26, 65536
    s_waitcnt lgkmcnt(10)
    v_mfma_f32_32x32x16_bf16 v[64:79], v[100:103], v[136:139], v[64:79]
    ds_read_b64_tr_b16 v[92:93], v5 offset:2048
    ds_read_b64_tr_b16 v[94:95], v5 offset:3072
    s_waitcnt vmcnt(13) lgkmcnt(10)
    v_mfma_f32_32x32x16_bf16 v[48:63], v[104:107], v[140:143], v[48:63]
    ds_read_b64_tr_b16 v[96:97], v4 offset:4096
    ds_read_b64_tr_b16 v[98:99], v4 offset:5120
    buffer_load_dwordx4 v[196:199], v8, s[4:7], s26 offen sc1
    s_add_u32 s26, s26, 65536
    s_waitcnt lgkmcnt(10)
    v_mfma_f32_32x32x16_bf16 v[64:79], v[108:111], v[140:143], v[64:79]
    ds_read_b64_tr_b16 v[100:101], v5 offset:4096
    ds_read_b64_tr_b16 v[102:103], v5 offset:5120
    s_waitcnt vmcnt(13) lgkmcnt(10)
    v_mfma_f32_32x32x16_bf16 v[48:63], v[80:83], v[144:147], v[48:63]
    ds_read_b64_tr_b16 v[104:105], v4 offset:6144
    ds_read_b64_tr_b16 v[106:107], v4 offset:7168
    buffer_load_dwordx4 v[200:203], v8, s[4:7], s26 offen sc1
    s_add_u32 s26, s26, 65536
    s_waitcnt lgkmcnt(10)
    v_mfma_f32_32x32x16_bf16 v[64:79], v[84:87], v[144:147], v[64:79]
    ds_read_b64_tr_b16 v[108:109], v5 offset:6144
    ds_read_b64_tr_b16 v[110:111], v5 offset:7168
    s_waitcnt vmcnt(13) lgkmcnt(10)
    v_mfma_f32_32x32x16_bf16 v[48:63], v[88:91], v[148:151], v[48:63]
    ds_read_b64_tr_b16 v[80:81], v4 offset:8192
    ds_read_b64_tr_b16 v[82:83], v4 offset:9216
    buffer_load_dwordx4 v[204:207], v8, s[4:7], s26 offen sc1
    s_add_u32 s26, s26, 65536
    s_waitcnt lgkmcnt(10)
    v_mfma_f32_32x32x16_bf16 v[64:79], v[92:95], v[148:151], v[64:79]
    ds_read_b64_tr_b16 v[84:85], v5 offset:8192
    ds_read_b64_tr_b16 v[86:87], v5 offset:9216
    s_waitcnt vmcnt(13) lgkmcnt(10)
    v_mfma_f32_32x32x16_bf16 v[48:63], v[96:99], v[152:155], v[48:63]
    ds_read_b64_tr_b16 v[88:89], v4 offset:10240
    ds_read_b64_tr_b16 v[90:91], v4 offset:11264
    buffer_load_dwordx4 v[208:211], v8, s[4:7], s26 offen sc1
    s_add_u32 s26, s26, 65536
    s_waitcnt lgkmcnt(10)
    v_mfma_f32_32x32x16_bf16 v[64:79], v[100:103], v[152:155], v[64:79]
    ds_read_b64_tr_b16 v[92:93], v5 offset:10240
    ds_read_b64_tr_b16 v[94:95], v5 offset:11264
    s_waitcnt vmcnt(13) lgkmcnt(10)
    v_mfma_f32_32x32x16_bf16 v[48:63], v[104:107], v[156:159], v[48:63]
    ds_read_b64_tr_b16 v[96:97], v4 offset:12288
    ds_read_b64_tr_b16 v[98:99], v4 offset:13312
    buffer_load_dwordx4 v[212:215], v8, s[4:7], s26 offen sc1
    s_add_u32 s26, s26, 65536
    s_waitcnt lgkmcnt(10)
    v_mfma_f32_32x32x16_bf16 v[64:79], v[108:111], v[156:159], v[64:79]
    ds_read_b64_tr_b16 v[100:101], v5 offset:12288
    ds_read_b64_tr_b16 v[102:103], v5 offset:13312
    s_waitcnt vmcnt(13) lgkmcnt(10)
    v_mfma_f32_32x32x16_bf16 v[48:63], v[80:83], v[160:163], v[48:63]
    ds_read_b64_tr_b16 v[104:105], v4 offset:14336
    ds_read_b64_tr_b16 v[106:107], v4 offset:15360
    buffer_load_dwordx4 v[216:219], v8, s[4:7], s26 offen sc1
    s_add_u32 s26, s26, 65536
    s_waitcnt lgkmcnt(10)
    v_mfma_f32_32x32x16_bf16 v[64:79], v[84:87], v[160:163], v[64:79]
    ds_read_b64_tr_b16 v[108:109], v5 offset:14336
    ds_read_b64_tr_b16 v[110:111], v5 offset:15360
    s_waitcnt vmcnt(13) lgkmcnt(10)
    v_mfma_f32_32x32x16_bf16 v[48:63], v[88:91], v[164:167], v[48:63]
    s_barrier
    ds_read_b64_tr_b16 v[80:81], v4 offset:16384
    ds_read_b64_tr_b16 v[82:83], v4 offset:17408
    buffer_load_dwordx4 v[220:223], v8, s[4:7], s26 offen sc1
    s_add_u32 s26, s26, 65536
    s_waitcnt lgkmcnt(10)
    v_mfma_f32_32x32x16_bf16 v[64:79], v[92:95], v[164:167], v[64:79]
    ds_read_b64_tr_b16 v[84:85], v5 offset:16384
    ds_read_b64_tr_b16 v[86:87], v5 offset:17408
    s_waitcnt vmcnt(13) lgkmcnt(10)
    v_mfma_f32_32x32x16_bf16 v[48:63], v[96:99], v[168:171], v[48:63]
    ds_read_b64_tr_b16 v[88:89], v4 offset:18432
    ds_read_b64_tr_b16 v[90:91], v4 offset:19456
    buffer_load_dwordx4 v[224:227], v8, s[4:7], s26 offen sc1
    s_add_u32 s26, s26, 65536
    s_waitcnt lgkmcnt(10)
    v_mfma_f32_32x32x16_bf16 v[64:79], v[100:103], v[168:171], v[64:79]
    ds_read_b64_tr_b16 v[92:93], v5 offset:18432
    ds_read_b64_tr_b16 v[94:95], v5 offset:19456
    s_waitcnt vmcnt(13) lgkmcnt(10)
    v_mfma_f32_32x32x16_bf16 v[48:63], v[104:107], v[172:175], v[48:63]
    ds_read_b64_tr_b16 v[96:97], v4 offset:20480
    ds_read_b64_tr_b16 v[98:99], v4 offset:21504
    buffer_load_dwordx4 v[228:231], v8, s[4:7], s26 offen sc1
    s_add_u32 s26, s26, 65536
    s_waitcnt lgkmcnt(10)
    v_mfma_f32_32x32x16_bf16 v[64:79], v[108:111], v[172:175], v[64:79]
    ds_read_b64_tr_b16 v[100:101], v5 offset:20480
    ds_read_b64_tr_b16 v[102:103], v5 offset:21504
    s_waitcnt vmcnt(13) lgkmcnt(10)
    v_mfma_f32_32x32x16_bf16 v[48:63], v[80:83], v[176:179], v[48:63]
    ds_read_b64_tr_b16 v[104:105], v4 offset:22528
    ds_read_b64_tr_b16 v[106:107], v4 offset:23552
    buffer_load_dwordx4 v[232:235], v8, s[4:7], s26 offen sc1
    s_add_u32 s26, s26, 65536
    s_waitcnt lgkmcnt(10)
    v_mfma_f32_32x32x16_bf16 v[64:79], v[84:87], v[176:179], v[64:79]
    ds_read_b64_tr_b16 v[108:109], v5 offset:22528
    ds_read_b64_tr_b16 v[110:111], v5 offset:23552
    s_waitcnt vmcnt(13) lgkmcnt(10)
    v_mfma_f32_32x32x16_bf16 v[48:63], v[88:91], v[180:183], v[48:63]
    ds_read_b64_tr_b16 v[80:81], v4 offset:24576
    ds_read_b64_tr_b16 v[82:83], v4 offset:25600
    buffer_load_dwordx4 v[236:239], v8, s[4:7], s26 offen sc1
    s_add_u32 s26, s26, 65536
    s_waitcnt lgkmcnt(10)
    v_mfma_f32_32x32x16_bf16 v[64:79], v[92:95], v[180:183], v[64:79]
    ds_read_b64_tr_b16 v[84:85], v5 offset:24576
    ds_read_b64_tr_b16 v[86:87], v5 offset:25600
    s_waitcnt vmcnt(13) lgkmcnt(10)
    v_mfma_f32_32x32x16_bf16 v[48:63], v[96:99], v[184:187], v[48:63]
    ds_read_b64_tr_b16 v[88:89], v4 offset:26624
    ds_read_b64_tr_b16 v[90:91], v4 offset:27648
    buffer_load_dwordx4 v[112:115], v8, s[4:7], s26 offen sc1
    s_add_u32 s26, s26, 65536
    s_waitcnt lgkmcnt(10)
    v_mfma_f32_32x32x16_bf16 v[64:79], v[100:103], v[184:187], v[64:79]
    ds_read_b64_tr_b16 v[92:93], v5 offset:26624
    ds_read_b64_tr_b16 v[94:95], v5 offset:27648
    s_waitcnt vmcnt(13) lgkmcnt(10)
    v_mfma_f32_32x32x16_bf16 v[48:63], v[104:107], v[188:191], v[48:63]
    ds_read_b64_tr_b16 v[96:97], v4 offset:28672
    ds_read_b64_tr_b16 v[98:99], v4 offset:29696
    buffer_load_dwordx4 v[116:119], v8, s[4:7], s26 offen sc1
    s_add_u32 s26, s26, 65536
    s_waitcnt lgkmcnt(10)
    v_mfma_f32_32x32x16_bf16 v[64:79], v[108:111], v[188:191], v[64:79]
    ds_read_b64_tr_b16 v[100:101], v5 offset:28672
    ds_read_b64_tr_b16 v[102:103], v5 offset:29696
    s_waitcnt vmcnt(13) lgkmcnt(10)
    v_mfma_f32_32x32x16_bf16 v[48:63], v[80:83], v[192:195], v[48:63]
    ds_read_b64_tr_b16 v[104:105], v4 offset:30720
    ds_read_b64_tr_b16 v[106:107], v4 offset:31744
    buffer_load_dwordx4 v[120:123], v8, s[4:7], s26 offen sc1
    s_add_u32 s26, s26, 65536
    s_waitcnt lgkmcnt(10)
    v_mfma_f32_32x32x16_bf16 v[64:79], v[84:87], v[192:195], v[64:79]
    ds_read_b64_tr_b16 v[108:109], v5 offset:30720
    ds_read_b64_tr_b16 v[110:111], v5 offset:31744
    s_waitcnt vmcnt(13) lgkmcnt(10)
    v_mfma_f32_32x32x16_bf16 v[48:63], v[88:91], v[196:199], v[48:63]
    s_barrier
    ds_read_b64_tr_b16 v[80:81], v4 offset:32768
    ds_read_b64_tr_b16 v[82:83], v4 offset:33792
    buffer_load_dwordx4 v[124:127], v8, s[4:7], s26 offen sc1
    s_add_u32 s26, s26, 65536
    s_waitcnt lgkmcnt(10)
    v_mfma_f32_32x32x16_bf16 v[64:79], v[92:95], v[196:199], v[64:79]
    ds_read_b64_tr_b16 v[84:85], v5 offset:32768
    ds_read_b64_tr_b16 v[86:87], v5 offset:33792
    s_waitcnt vmcnt(13) lgkmcnt(10)
    v_mfma_f32_32x32x16_bf16 v[48:63], v[96:99], v[200:203], v[48:63]
    ds_read_b64_tr_b16 v[88:89], v4 offset:34816
    ds_read_b64_tr_b16 v[90:91], v4 offset:35840
    buffer_load_dwordx4 v[128:131], v8, s[4:7], s26 offen sc1
    s_add_u32 s26, s26, 65536
    s_waitcnt lgkmcnt(10)
    v_mfma_f32_32x32x16_bf16 v[64:79], v[100:103], v[200:203], v[64:79]
    ds_read_b64_tr_b16 v[92:93], v5 offset:34816
    ds_read_b64_tr_b16 v[94:95], v5 offset:35840
    s_waitcnt vmcnt(13) lgkmcnt(10)
    v_mfma_f32_32x32x16_bf16 v[48:63], v[104:107], v[204:207], v[48:63]
    ds_read_b64_tr_b16 v[96:97], v4 offset:36864
    ds_read_b64_tr_b16 v[98:99], v4 offset:37888
    buffer_load_dwordx4 v[132:135], v8, s[4:7], s26 offen sc1
    s_add_u32 s26, s26, 65536
    s_waitcnt lgkmcnt(10)
    v_mfma_f32_32x32x16_bf16 v[64:79], v[108:111], v[204:207], v[64:79]
    ds_read_b64_tr_b16 v[100:101], v5 offset:36864
    ds_read_b64_tr_b16 v[102:103], v5 offset:37888
    s_waitcnt vmcnt(13) lgkmcnt(10)
    v_mfma_f32_32x32x16_bf16 v[48:63], v[80:83], v[208:211], v[48:63]
    ds_read_b64_tr_b16 v[104:105], v4 offset:38912
    ds_read_b64_tr_b16 v[106:107], v4 offset:39936
    buffer_load_dwordx4 v[136:139], v8, s[4:7], s26 offen sc1
    s_add_u32 s26, s26, 65536
    s_waitcnt lgkmcnt(10)
    v_mfma_f32_32x32x16_bf16 v[64:79], v[84:87], v[208:211], v[64:79]
    ds_read_b64_tr_b16 v[108:109], v5 offset:38912
    ds_read_b64_tr_b16 v[110:111], v5 offset:39936
    s_waitcnt vmcnt(13) lgkmcnt(10)
    v_mfma_f32_32x32x16_bf16 v[48:63], v[88:91], v[212:215], v[48:63]
    ds_read_b64_tr_b16 v[80:81], v4 offset:40960
    ds_read_b64_tr_b16 v[82:83], v4 offset:41984
    buffer_load_dwordx4 v[140:143], v8, s[4:7], s26 offen sc1
    s_add_u32 s26, s26, 65536
    s_waitcnt lgkmcnt(10)
    v_mfma_f32_32x32x16_bf16 v[64:79], v[92:95], v[212:215], v[64:79]
    ds_read_b64_tr_b16 v[84:85], v5 offset:40960
    ds_read_b64_tr_b16 v[86:87], v5 offset:41984
    s_waitcnt vmcnt(13) lgkmcnt(10)
    v_mfma_f32_32x32x16_bf16 v[48:63], v[96:99], v[216:219], v[48:63]
    ds_read_b64_tr_b16 v[88:89], v4 offset:43008
    ds_read_b64_tr_b16 v[90:91], v4 offset:44032
    buffer_load_dwordx4 v[144:147], v8, s[4:7], s26 offen sc1
    s_add_u32 s26, s26, 65536
    s_waitcnt lgkmcnt(10)
    v_mfma_f32_32x32x16_bf16 v[64:79], v[100:103], v[216:219], v[64:79]
    ds_read_b64_tr_b16 v[92:93], v5 offset:43008
    ds_read_b64_tr_b16 v[94:95], v5 offset:44032
    s_waitcnt vmcnt(13) lgkmcnt(10)
    v_mfma_f32_32x32x16_bf16 v[48:63], v[104:107], v[220:223], v[48:63]
    ds_read_b64_tr_b16 v[96:97], v4 offset:45056
    ds_read_b64_tr_b16 v[98:99], v4 offset:46080
    buffer_load_dwordx4 v[148:151], v8, s[4:7], s26 offen sc1
    s_add_u32 s26, s26, 65536
    s_waitcnt lgkmcnt(10)
    v_mfma_f32_32x32x16_bf16 v[64:79], v[108:111], v[220:223], v[64:79]
    ds_read_b64_tr_b16 v[100:101], v5 offset:45056
    ds_read_b64_tr_b16 v[102:103], v5 offset:46080
    s_waitcnt vmcnt(13) lgkmcnt(10)
    v_mfma_f32_32x32x16_bf16 v[48:63], v[80:83], v[224:227], v[48:63]
    ds_read_b64_tr_b16 v[104:105], v4 offset:47104
    ds_read_b64_tr_b16 v[106:107], v4 offset:48128
    buffer_load_dwordx4 v[152:155], v8, s[4:7], s26 offen sc1
    s_add_u32 s26, s26, 65536
    s_waitcnt lgkmcnt(10)
    v_mfma_f32_32x32x16_bf16 v[64:79], v[84:87], v[224:227], v[64:79]
    ds_read_b64_tr_b16 v[108:109], v5 offset:47104
    ds_read_b64_tr_b16 v[110:111], v5 offset:48128
    s_waitcnt vmcnt(13) lgkmcnt(10)
    v_mfma_f32_32x32x16_bf16 v[48:63], v[88:91], v[228:231], v[48:63]
    s_barrier
    ds_read_b64_tr_b16 v[80:81], v4 offset:49152
    ds_read_b64_tr_b16 v[82:83], v4 offset:50176
    buffer_load_dwordx4 v[156:159], v8, s[4:7], s26 offen sc1
    s_add_u32 s26, s26, 65536
    s_waitcnt lgkmcnt(10)
    v_mfma_f32_32x32x16_bf16 v[64:79], v[92:95], v[228:231], v[64:79]
    ds_read_b64_tr_b16 v[84:85], v5 offset:49152
    ds_read_b64_tr_b16 v[86:87], v5 offset:50176
    s_waitcnt vmcnt(13) lgkmcnt(10)
    v_mfma_f32_32x32x16_bf16 v[48:63], v[96:99], v[232:235], v[48:63]
    ds_read_b64_tr_b16 v[88:89], v4 offset:51200
    ds_read_b64_tr_b16 v[90:91], v4 offset:52224
    buffer_load_dwordx4 v[160:163], v8, s[4:7], s26 offen sc1
    s_add_u32 s26, s26, 65536
    s_waitcnt lgkmcnt(10)
    v_mfma_f32_32x32x16_bf16 v[64:79], v[100:103], v[232:235], v[64:79]
    ds_read_b64_tr_b16 v[92:93], v5 offset:51200
    ds_read_b64_tr_b16 v[94:95], v5 offset:52224
    s_waitcnt vmcnt(13) lgkmcnt(10)
    v_mfma_f32_32x32x16_bf16 v[48:63], v[104:107], v[236:239], v[48:63]
    ds_read_b64_tr_b16 v[96:97], v4 offset:53248
    ds_read_b64_tr_b16 v[98:99], v4 offset:54272
    buffer_load_dwordx4 v[164:167], v8, s[4:7], s26 offen sc1
    s_add_u32 s26, s26, 65536
    s_waitcnt lgkmcnt(10)
    v_mfma_f32_32x32x16_bf16 v[64:79], v[108:111], v[236:239], v[64:79]
    ds_read_b64_tr_b16 v[100:101], v5 offset:53248
    ds_read_b64_tr_b16 v[102:103], v5 offset:54272
    s_waitcnt vmcnt(13) lgkmcnt(10)
    v_mfma_f32_32x32x16_bf16 v[48:63], v[80:83], v[112:115], v[48:63]
    ds_read_b64_tr_b16 v[104:105], v4 offset:55296
    ds_read_b64_tr_b16 v[106:107], v4 offset:56320
    buffer_load_dwordx4 v[168:171], v8, s[4:7], s26 offen sc1
    s_add_u32 s26, s26, 65536
    s_waitcnt lgkmcnt(10)
    v_mfma_f32_32x32x16_bf16 v[64:79], v[84:87], v[112:115], v[64:79]
    ds_read_b64_tr_b16 v[108:109], v5 offset:55296
    ds_read_b64_tr_b16 v[110:111], v5 offset:56320
    s_waitcnt vmcnt(13) lgkmcnt(10)
    v_mfma_f32_32x32x16_bf16 v[48:63], v[88:91], v[116:119], v[48:63]
    ds_read_b64_tr_b16 v[80:81], v4 offset:57344
    ds_read_b64_tr_b16 v[82:83], v4 offset:58368
    buffer_load_dwordx4 v[172:175], v8, s[4:7], s26 offen sc1
    s_add_u32 s26, s26, 65536
    s_waitcnt lgkmcnt(10)
    v_mfma_f32_32x32x16_bf16 v[64:79], v[92:95], v[116:119], v[64:79]
    ds_read_b64_tr_b16 v[84:85], v5 offset:57344
    ds_read_b64_tr_b16 v[86:87], v5 offset:58368
    s_waitcnt vmcnt(13) lgkmcnt(10)
    v_mfma_f32_32x32x16_bf16 v[48:63], v[96:99], v[120:123], v[48:63]
    ds_read_b64_tr_b16 v[88:89], v4 offset:59392
    ds_read_b64_tr_b16 v[90:91], v4 offset:60416
    buffer_load_dwordx4 v[176:179], v8, s[4:7], s26 offen sc1
    s_add_u32 s26, s26, 65536
    s_waitcnt lgkmcnt(10)
    v_mfma_f32_32x32x16_bf16 v[64:79], v[100:103], v[120:123], v[64:79]
    ds_read_b64_tr_b16 v[92:93], v5 offset:59392
    ds_read_b64_tr_b16 v[94:95], v5 offset:60416
    s_waitcnt vmcnt(13) lgkmcnt(10)
    v_mfma_f32_32x32x16_bf16 v[48:63], v[104:107], v[124:127], v[48:63]
    ds_read_b64_tr_b16 v[96:97], v4 offset:61440
    ds_read_b64_tr_b16 v[98:99], v4 offset:62464
    buffer_load_dwordx4 v[180:183], v8, s[4:7], s26 offen sc1
    s_add_u32 s26, s26, 65536
    s_waitcnt lgkmcnt(10)
    v_mfma_f32_32x32x16_bf16 v[64:79], v[108:111], v[124:127], v[64:79]
    ds_read_b64_tr_b16 v[100:101], v5 offset:61440
    ds_read_b64_tr_b16 v[102:103], v5 offset:62464
    s_waitcnt vmcnt(13) lgkmcnt(10)
    v_mfma_f32_32x32x16_bf16 v[48:63], v[80:83], v[128:131], v[48:63]
    ds_read_b64_tr_b16 v[104:105], v4 offset:63488
    ds_read_b64_tr_b16 v[106:107], v4 offset:64512
    buffer_load_dwordx4 v[184:187], v8, s[4:7], s26 offen sc1
    s_add_u32 s26, s26, 65536
    s_waitcnt lgkmcnt(10)
    v_mfma_f32_32x32x16_bf16 v[64:79], v[84:87], v[128:131], v[64:79]
    ds_read_b64_tr_b16 v[108:109], v5 offset:63488
    ds_read_b64_tr_b16 v[110:111], v5 offset:64512
    s_waitcnt vmcnt(13) lgkmcnt(10)
    v_mfma_f32_32x32x16_bf16 v[48:63], v[88:91], v[132:135], v[48:63]
    s_barrier
    v_add_u32 v4, 0x10000, v4
    v_add_u32 v5, 0x10000, v5
    ds_read_b64_tr_b16 v[80:81], v4 offset:0
    ds_read_b64_tr_b16 v[82:83], v4 offset:1024
    buffer_load_dwordx4 v[188:191], v8, s[4:7], s26 offen sc1
    s_add_u32 s26, s26, 65536
    s_waitcnt lgkmcnt(10)
    v_mfma_f32_32x32x16_bf16 v[64:79], v[92:95], v[132:135], v[64:79]
    ds_read_b64_tr_b16 v[84:85], v5 offset:0
    ds_read_b64_tr_b16 v[86:87], v5 offset:1024
    s_waitcnt vmcnt(13) lgkmcnt(10)
    v_mfma_f32_32x32x16_bf16 v[48:63], v[96:99], v[136:139], v[48:63]
    ds_read_b64_tr_b16 v[88:89], v4 offset:2048
    ds_read_b64_tr_b16 v[90:91], v4 offset:3072
    buffer_load_dwordx4 v[192:195], v8, s[4:7], s26 offen sc1
    s_add_u32 s26, s26, 65536
    s_waitcnt lgkmcnt(10)
    v_mfma_f32_32x32x16_bf16 v[64:79], v[100:103], v[136:139], v[64:79]
    ds_read_b64_tr_b16 v[92:93], v5 offset:2048
    ds_read_b64_tr_b16 v[94:95], v5 offset:3072
    s_waitcnt vmcnt(13) lgkmcnt(10)
    v_mfma_f32_32x32x16_bf16 v[48:63], v[104:107], v[140:143], v[48:63]
    ds_read_b64_tr_b16 v[96:97], v4 offset:4096
    ds_read_b64_tr_b16 v[98:99], v4 offset:5120
    buffer_load_dwordx4 v[196:199], v8, s[4:7], s26 offen sc1
    s_add_u32 s26, s26, 65536
    s_waitcnt lgkmcnt(10)
    v_mfma_f32_32x32x16_bf16 v[64:79], v[108:111], v[140:143], v[64:79]
    ds_read_b64_tr_b16 v[100:101], v5 offset:4096
    ds_read_b64_tr_b16 v[102:103], v5 offset:5120
    s_waitcnt vmcnt(13) lgkmcnt(10)
    v_mfma_f32_32x32x16_bf16 v[48:63], v[80:83], v[144:147], v[48:63]
    ds_read_b64_tr_b16 v[104:105], v4 offset:6144
    ds_read_b64_tr_b16 v[106:107], v4 offset:7168
    buffer_load_dwordx4 v[200:203], v8, s[4:7], s26 offen sc1
    s_add_u32 s26, s26, 65536
    s_waitcnt lgkmcnt(10)
    v_mfma_f32_32x32x16_bf16 v[64:79], v[84:87], v[144:147], v[64:79]
    ds_read_b64_tr_b16 v[108:109], v5 offset:6144
    ds_read_b64_tr_b16 v[110:111], v5 offset:7168
    s_waitcnt vmcnt(13) lgkmcnt(10)
    v_mfma_f32_32x32x16_bf16 v[48:63], v[88:91], v[148:151], v[48:63]
    ds_read_b64_tr_b16 v[80:81], v4 offset:8192
    ds_read_b64_tr_b16 v[82:83], v4 offset:9216
    buffer_load_dwordx4 v[204:207], v8, s[4:7], s26 offen sc1
    s_add_u32 s26, s26, 65536
    s_waitcnt lgkmcnt(10)
    v_mfma_f32_32x32x16_bf16 v[64:79], v[92:95], v[148:151], v[64:79]
    ds_read_b64_tr_b16 v[84:85], v5 offset:8192
    ds_read_b64_tr_b16 v[86:87], v5 offset:9216
    s_waitcnt vmcnt(13) lgkmcnt(10)
    v_mfma_f32_32x32x16_bf16 v[48:63], v[96:99], v[152:155], v[48:63]
    ds_read_b64_tr_b16 v[88:89], v4 offset:10240
    ds_read_b64_tr_b16 v[90:91], v4 offset:11264
    buffer_load_dwordx4 v[208:211], v8, s[4:7], s26 offen sc1
    s_add_u32 s26, s26, 65536
    s_waitcnt lgkmcnt(10)
    v_mfma_f32_32x32x16_bf16 v[64:79], v[100:103], v[152:155], v[64:79]
    ds_read_b64_tr_b16 v[92:93], v5 offset:10240
    ds_read_b64_tr_b16 v[94:95], v5 offset:11264
    s_waitcnt vmcnt(13) lgkmcnt(10)
    v_mfma_f32_32x32x16_bf16 v[48:63], v[104:107], v[156:159], v[48:63]
    ds_read_b64_tr_b16 v[96:97], v4 offset:12288
    ds_read_b64_tr_b16 v[98:99], v4 offset:13312
    buffer_load_dwordx4 v[212:215], v8, s[4:7], s26 offen sc1
    s_add_u32 s26, s26, 65536
    s_waitcnt lgkmcnt(10)
    v_mfma_f32_32x32x16_bf16 v[64:79], v[108:111], v[156:159], v[64:79]
    ds_read_b64_tr_b16 v[100:101], v5 offset:12288
    ds_read_b64_tr_b16 v[102:103], v5 offset:13312
    s_waitcnt vmcnt(13) lgkmcnt(10)
    v_mfma_f32_32x32x16_bf16 v[48:63], v[80:83], v[160:163], v[48:63]
    ds_read_b64_tr_b16 v[104:105], v4 offset:14336
    ds_read_b64_tr_b16 v[106:107], v4 offset:15360
    buffer_load_dwordx4 v[216:219], v8, s[4:7], s26 offen sc1
    s_add_u32 s26, s26, 65536
    s_waitcnt lgkmcnt(10)
    v_mfma_f32_32x32x16_bf16 v[64:79], v[84:87], v[160:163], v[64:79]
    ds_read_b64_tr_b16 v[108:109], v5 offset:14336
    ds_read_b64_tr_b16 v[110:111], v5 offset:15360
    s_waitcnt vmcnt(13) lgkmcnt(10)
    v_mfma_f32_32x32x16_bf16 v[48:63], v[88:91], v[164:167], v[48:63]
    s_barrier
    ds_read_b64_tr_b16 v[80:81], v4 offset:16384
    ds_read_b64_tr_b16 v[82:83], v4 offset:17408
    buffer_load_dwordx4 v[220:223], v8, s[4:7], s26 offen sc1
    s_add_u32 s26, s26, 65536
    s_waitcnt lgkmcnt(10)
    v_mfma_f32_32x32x16_bf16 v[64:79], v[92:95], v[164:167], v[64:79]
    ds_read_b64_tr_b16 v[84:85], v5 offset:16384
    ds_read_b64_tr_b16 v[86:87], v5 offset:17408
    s_waitcnt vmcnt(13) lgkmcnt(10)
    v_mfma_f32_32x32x16_bf16 v[48:63], v[96:99], v[168:171], v[48:63]
    ds_read_b64_tr_b16 v[88:89], v4 offset:18432
    ds_read_b64_tr_b16 v[90:91], v4 offset:19456
    buffer_load_dwordx4 v[224:227], v8, s[4:7], s26 offen sc1
    s_add_u32 s26, s26, 65536
    s_waitcnt lgkmcnt(10)
    v_mfma_f32_32x32x16_bf16 v[64:79], v[100:103], v[168:171], v[64:79]
    ds_read_b64_tr_b16 v[92:93], v5 offset:18432
    ds_read_b64_tr_b16 v[94:95], v5 offset:19456
    s_waitcnt vmcnt(13) lgkmcnt(10)
    v_mfma_f32_32x32x16_bf16 v[48:63], v[104:107], v[172:175], v[48:63]
    ds_read_b64_tr_b16 v[96:97], v4 offset:20480
    ds_read_b64_tr_b16 v[98:99], v4 offset:21504
    buffer_load_dwordx4 v[228:231], v8, s[4:7], s26 offen sc1
    s_add_u32 s26, s26, 65536
    s_waitcnt lgkmcnt(10)
    v_mfma_f32_32x32x16_bf16 v[64:79], v[108:111], v[172:175], v[64:79]
    ds_read_b64_tr_b16 v[100:101], v5 offset:20480
    ds_read_b64_tr_b16 v[102:103], v5 offset:21504
    s_waitcnt vmcnt(13) lgkmcnt(10)
    v_mfma_f32_32x32x16_bf16 v[48:63], v[80:83], v[176:179], v[48:63]
    ds_read_b64_tr_b16 v[104:105], v4 offset:22528
    ds_read_b64_tr_b16 v[106:107], v4 offset:23552
    buffer_load_dwordx4 v[232:235], v8, s[4:7], s26 offen sc1
    s_add_u32 s26, s26, 65536
    s_waitcnt lgkmcnt(10)
    v_mfma_f32_32x32x16_bf16 v[64:79], v[84:87], v[176:179], v[64:79]
    ds_read_b64_tr_b16 v[108:109], v5 offset:22528
    ds_read_b64_tr_b16 v[110:111], v5 offset:23552
    s_waitcnt vmcnt(13) lgkmcnt(10)
    v_mfma_f32_32x32x16_bf16 v[48:63], v[88:91], v[180:183], v[48:63]
    ds_read_b64_tr_b16 v[80:81], v4 offset:24576
    ds_read_b64_tr_b16 v[82:83], v4 offset:25600
    buffer_load_dwordx4 v[236:239], v8, s[4:7], s26 offen sc1
    s_add_u32 s26, s26, 65536
    s_waitcnt lgkmcnt(10)
    v_mfma_f32_32x32x16_bf16 v[64:79], v[92:95], v[180:183], v[64:79]
    ds_read_b64_tr_b16 v[84:85], v5 offset:24576
    ds_read_b64_tr_b16 v[86:87], v5 offset:25600
    s_waitcnt vmcnt(13) lgkmcnt(10)
    v_mfma_f32_32x32x16_bf16 v[48:63], v[96:99], v[184:187], v[48:63]
    ds_read_b64_tr_b16 v[88:89], v4 offset:26624
    ds_read_b64_tr_b16 v[90:91], v4 offset:27648
    buffer_load_dwordx4 v[112:115], v8, s[4:7], s26 offen sc1
    s_add_u32 s26, s26, 65536
    s_waitcnt lgkmcnt(10)
    v_mfma_f32_32x32x16_bf16 v[64:79], v[100:103], v[184:187], v[64:79]
    ds_read_b64_tr_b16 v[92:93], v5 offset:26624
    ds_read_b64_tr_b16 v[94:95], v5 offset:27648
    s_waitcnt vmcnt(13) lgkmcnt(10)
    v_mfma_f32_32x32x16_bf16 v[48:63], v[104:107], v[188:191], v[48:63]
    ds_read_b64_tr_b16 v[96:97], v4 offset:28672
    ds_read_b64_tr_b16 v[98:99], v4 offset:29696
    buffer_load_dwordx4 v[116:119], v8, s[4:7], s26 offen sc1
    s_add_u32 s26, s26, 65536
    s_waitcnt lgkmcnt(10)
    v_mfma_f32_32x32x16_bf16 v[64:79], v[108:111], v[188:191], v[64:79]
    ds_read_b64_tr_b16 v[100:101], v5 offset:28672
    ds_read_b64_tr_b16 v[102:103], v5 offset:29696
    s_waitcnt vmcnt(13) lgkmcnt(10)
    v_mfma_f32_32x32x16_bf16 v[48:63], v[80:83], v[192:195], v[48:63]
    ds_read_b64_tr_b16 v[104:105], v4 offset:30720
    ds_read_b64_tr_b16 v[106:107], v4 offset:31744
    buffer_load_dwordx4 v[120:123], v8, s[4:7], s26 offen sc1
    s_add_u32 s26, s26, 65536
    s_waitcnt lgkmcnt(10)
    v_mfma_f32_32x32x16_bf16 v[64:79], v[84:87], v[192:195], v[64:79]
    ds_read_b64_tr_b16 v[108:109], v5 offset:30720
    ds_read_b64_tr_b16 v[110:111], v5 offset:31744
    s_waitcnt vmcnt(13) lgkmcnt(10)
    v_mfma_f32_32x32x16_bf16 v[48:63], v[88:91], v[196:199], v[48:63]
    s_barrier
    ds_read_b64_tr_b16 v[80:81], v4 offset:32768
    ds_read_b64_tr_b16 v[82:83], v4 offset:33792
    buffer_load_dwordx4 v[124:127], v8, s[4:7], s26 offen sc1
    s_add_u32 s26, s26, 65536
    s_waitcnt lgkmcnt(10)
    v_mfma_f32_32x32x16_bf16 v[64:79], v[92:95], v[196:199], v[64:79]
    ds_read_b64_tr_b16 v[84:85], v5 offset:32768
    ds_read_b64_tr_b16 v[86:87], v5 offset:33792
    s_waitcnt vmcnt(13) lgkmcnt(10)
    v_mfma_f32_32x32x16_bf16 v[48:63], v[96:99], v[200:203], v[48:63]
    ds_read_b64_tr_b16 v[88:89], v4 offset:34816
    ds_read_b64_tr_b16 v[90:91], v4 offset:35840
    buffer_load_dwordx4 v[128:131], v8, s[4:7], s26 offen sc1
    s_add_u32 s26, s26, 65536
    s_waitcnt lgkmcnt(10)
    v_mfma_f32_32x32x16_bf16 v[64:79], v[100:103], v[200:203], v[64:79]
    ds_read_b64_tr_b16 v[92:93], v5 offset:34816
    ds_read_b64_tr_b16 v[94:95], v5 offset:35840
    s_waitcnt vmcnt(13) lgkmcnt(10)
    v_mfma_f32_32x32x16_bf16 v[48:63], v[104:107], v[204:207], v[48:63]
    ds_read_b64_tr_b16 v[96:97], v4 offset:36864
    ds_read_b64_tr_b16 v[98:99], v4 offset:37888
    buffer_load_dwordx4 v[132:135], v8, s[4:7], s26 offen sc1
    s_add_u32 s26, s26, 65536
    s_waitcnt lgkmcnt(10)
    v_mfma_f32_32x32x16_bf16 v[64:79], v[108:111], v[204:207], v[64:79]
    ds_read_b64_tr_b16 v[100:101], v5 offset:36864
    ds_read_b64_tr_b16 v[102:103], v5 offset:37888
    s_waitcnt vmcnt(13) lgkmcnt(10)
    v_mfma_f32_32x32x16_bf16 v[48:63], v[80:83], v[208:211], v[48:63]
    ds_read_b64_tr_b16 v[104:105], v4 offset:38912
    ds_read_b64_tr_b16 v[106:107], v4 offset:39936
    buffer_load_dwordx4 v[136:139], v8, s[4:7], s26 offen sc1
    s_add_u32 s26, s26, 65536
    s_waitcnt lgkmcnt(10)
    v_mfma_f32_32x32x16_bf16 v[64:79], v[84:87], v[208:211], v[64:79]
    ds_read_b64_tr_b16 v[108:109], v5 offset:38912
    ds_read_b64_tr_b16 v[110:111], v5 offset:39936
    s_waitcnt vmcnt(13) lgkmcnt(10)
    v_mfma_f32_32x32x16_bf16 v[48:63], v[88:91], v[212:215], v[48:63]
    ds_read_b64_tr_b16 v[80:81], v4 offset:40960
    ds_read_b64_tr_b16 v[82:83], v4 offset:41984
    buffer_load_dwordx4 v[140:143], v8, s[4:7], s26 offen sc1
    s_add_u32 s26, s26, 65536
    s_waitcnt lgkmcnt(10)
    v_mfma_f32_32x32x16_bf16 v[64:79], v[92:95], v[212:215], v[64:79]
    ds_read_b64_tr_b16 v[84:85], v5 offset:40960
    ds_read_b64_tr_b16 v[86:87], v5 offset:41984
    s_waitcnt vmcnt(13) lgkmcnt(10)
    v_mfma_f32_32x32x16_bf16 v[48:63], v[96:99], v[216:219], v[48:63]
    ds_read_b64_tr_b16 v[88:89], v4 offset:43008
    ds_read_b64_tr_b16 v[90:91], v4 offset:44032
    buffer_load_dwordx4 v[144:147], v8, s[4:7], s26 offen sc1
    s_add_u32 s26, s26, 65536
    s_waitcnt lgkmcnt(10)
    v_mfma_f32_32x32x16_bf16 v[64:79], v[100:103], v[216:219], v[64:79]
    ds_read_b64_tr_b16 v[92:93], v5 offset:43008
    ds_read_b64_tr_b16 v[94:95], v5 offset:44032
    s_waitcnt vmcnt(13) lgkmcnt(10)
    v_mfma_f32_32x32x16_bf16 v[48:63], v[104:107], v[220:223], v[48:63]
    ds_read_b64_tr_b16 v[96:97], v4 offset:45056
    ds_read_b64_tr_b16 v[98:99], v4 offset:46080
    buffer_load_dwordx4 v[148:151], v8, s[4:7], s26 offen sc1
    s_add_u32 s26, s26, 65536
    s_waitcnt lgkmcnt(10)
    v_mfma_f32_32x32x16_bf16 v[64:79], v[108:111], v[220:223], v[64:79]
    ds_read_b64_tr_b16 v[100:101], v5 offset:45056
    ds_read_b64_tr_b16 v[102:103], v5 offset:46080
    s_waitcnt vmcnt(13) lgkmcnt(10)
    v_mfma_f32_32x32x16_bf16 v[48:63], v[80:83], v[224:227], v[48:63]
    ds_read_b64_tr_b16 v[104:105], v4 offset:47104
    ds_read_b64_tr_b16 v[106:107], v4 offset:48128
    buffer_load_dwordx4 v[152:155], v8, s[4:7], s26 offen sc1
    s_add_u32 s26, s26, 65536
    s_waitcnt lgkmcnt(10)
    v_mfma_f32_32x32x16_bf16 v[64:79], v[84:87], v[224:227], v[64:79]
    ds_read_b64_tr_b16 v[108:109], v5 offset:47104
    ds_read_b64_tr_b16 v[110:111], v5 offset:48128
    s_waitcnt vmcnt(13) lgkmcnt(10)
    v_mfma_f32_32x32x16_bf16 v[48:63], v[88:91], v[228:231], v[48:63]
    s_barrier
    ds_read_b64_tr_b16 v[80:81], v4 offset:49152
    ds_read_b64_tr_b16 v[82:83], v4 offset:50176
    buffer_load_dwordx4 v[156:159], v8, s[4:7], s26 offen sc1
    s_add_u32 s26, s26, 65536
    s_waitcnt lgkmcnt(10)
    v_mfma_f32_32x32x16_bf16 v[64:79], v[92:95], v[228:231], v[64:79]
    ds_read_b64_tr_b16 v[84:85], v5 offset:49152
    ds_read_b64_tr_b16 v[86:87], v5 offset:50176
    s_waitcnt vmcnt(13) lgkmcnt(10)
    v_mfma_f32_32x32x16_bf16 v[48:63], v[96:99], v[232:235], v[48:63]
    ds_read_b64_tr_b16 v[88:89], v4 offset:51200
    ds_read_b64_tr_b16 v[90:91], v4 offset:52224
    buffer_load_dwordx4 v[160:163], v8, s[4:7], s26 offen sc1
    s_add_u32 s26, s26, 65536
    s_waitcnt lgkmcnt(10)
    v_mfma_f32_32x32x16_bf16 v[64:79], v[100:103], v[232:235], v[64:79]
    ds_read_b64_tr_b16 v[92:93], v5 offset:51200
    ds_read_b64_tr_b16 v[94:95], v5 offset:52224
    s_waitcnt vmcnt(13) lgkmcnt(10)
    v_mfma_f32_32x32x16_bf16 v[48:63], v[104:107], v[236:239], v[48:63]
    ds_read_b64_tr_b16 v[96:97], v4 offset:53248
    ds_read_b64_tr_b16 v[98:99], v4 offset:54272
    buffer_load_dwordx4 v[164:167], v8, s[4:7], s26 offen sc1
    s_add_u32 s26, s26, 65536
    s_waitcnt lgkmcnt(10)
    v_mfma_f32_32x32x16_bf16 v[64:79], v[108:111], v[236:239], v[64:79]
    ds_read_b64_tr_b16 v[100:101], v5 offset:53248
    ds_read_b64_tr_b16 v[102:103], v5 offset:54272
    s_waitcnt vmcnt(13) lgkmcnt(10)
    v_mfma_f32_32x32x16_bf16 v[48:63], v[80:83], v[112:115], v[48:63]
    ds_read_b64_tr_b16 v[104:105], v4 offset:55296
    ds_read_b64_tr_b16 v[106:107], v4 offset:56320
    buffer_load_dwordx4 v[168:171], v8, s[4:7], s26 offen sc1
    s_add_u32 s26, s26, 65536
    s_waitcnt lgkmcnt(10)
    v_mfma_f32_32x32x16_bf16 v[64:79], v[84:87], v[112:115], v[64:79]
    ds_read_b64_tr_b16 v[108:109], v5 offset:55296
    ds_read_b64_tr_b16 v[110:111], v5 offset:56320
    s_waitcnt vmcnt(13) lgkmcnt(10)
    v_mfma_f32_32x32x16_bf16 v[48:63], v[88:91], v[116:119], v[48:63]
    ds_read_b64_tr_b16 v[80:81], v4 offset:57344
    ds_read_b64_tr_b16 v[82:83], v4 offset:58368
    buffer_load_dwordx4 v[172:175], v8, s[4:7], s26 offen sc1
    s_add_u32 s26, s26, 65536
    s_waitcnt lgkmcnt(10)
    v_mfma_f32_32x32x16_bf16 v[64:79], v[92:95], v[116:119], v[64:79]
    ds_read_b64_tr_b16 v[84:85], v5 offset:57344
    ds_read_b64_tr_b16 v[86:87], v5 offset:58368
    s_waitcnt vmcnt(13) lgkmcnt(10)
    v_mfma_f32_32x32x16_bf16 v[48:63], v[96:99], v[120:123], v[48:63]
    ds_read_b64_tr_b16 v[88:89], v4 offset:59392
    ds_read_b64_tr_b16 v[90:91], v4 offset:60416
    buffer_load_dwordx4 v[176:179], v8, s[4:7], s26 offen sc1
    s_add_u32 s26, s26, 65536
    s_waitcnt lgkmcnt(10)
    v_mfma_f32_32x32x16_bf16 v[64:79], v[100:103], v[120:123], v[64:79]
    ds_read_b64_tr_b16 v[92:93], v5 offset:59392
    ds_read_b64_tr_b16 v[94:95], v5 offset:60416
    s_waitcnt vmcnt(13) lgkmcnt(10)
    v_mfma_f32_32x32x16_bf16 v[48:63], v[104:107], v[124:127], v[48:63]
    ds_read_b64_tr_b16 v[96:97], v4 offset:61440
    ds_read_b64_tr_b16 v[98:99], v4 offset:62464
    buffer_load_dwordx4 v[180:183], v8, s[4:7], s26 offen sc1
    s_add_u32 s26, s26, 65536
    s_waitcnt lgkmcnt(10)
    v_mfma_f32_32x32x16_bf16 v[64:79], v[108:111], v[124:127], v[64:79]
    ds_read_b64_tr_b16 v[100:101], v5 offset:61440
    ds_read_b64_tr_b16 v[102:103], v5 offset:62464
    s_waitcnt vmcnt(13) lgkmcnt(10)
    v_mfma_f32_32x32x16_bf16 v[48:63], v[80:83], v[128:131], v[48:63]
    ds_read_b64_tr_b16 v[104:105], v4 offset:63488
    ds_read_b64_tr_b16 v[106:107], v4 offset:64512
    buffer_load_dwordx4 v[184:187], v8, s[4:7], s26 offen sc1
    s_add_u32 s26, s26, 65536
    s_waitcnt lgkmcnt(10)
    v_mfma_f32_32x32x16_bf16 v[64:79], v[84:87], v[128:131], v[64:79]
    ds_read_b64_tr_b16 v[108:109], v5 offset:63488
    ds_read_b64_tr_b16 v[110:111], v5 offset:64512
    s_waitcnt vmcnt(13) lgkmcnt(10)
    v_mfma_f32_32x32x16_bf16 v[48:63], v[88:91], v[132:135], v[48:63]
    s_barrier
    v_add_u32 v4, 0xffff0000, v4
    v_add_u32 v5, 0xffff0000, v5
    ds_read_b64_tr_b16 v[80:81], v4 offset:0
    ds_read_b64_tr_b16 v[82:83], v4 offset:1024
    buffer_load_dwordx4 v[188:191], v8, s[4:7], s26 offen sc1
    s_add_u32 s26, s26, 65536
    s_waitcnt lgkmcnt(10)
    v_mfma_f32_32x32x16_bf16 v[64:79], v[92:95], v[132:135], v[64:79]
    ds_read_b64_tr_b16 v[84:85], v5 offset:0
    ds_read_b64_tr_b16 v[86:87], v5 offset:1024
    s_waitcnt vmcnt(13) lgkmcnt(10)
    v_mfma_f32_32x32x16_bf16 v[48:63], v[96:99], v[136:139], v[48:63]
    ds_read_b64_tr_b16 v[88:89], v4 offset:2048
    ds_read_b64_tr_b16 v[90:91], v4 offset:3072
    buffer_load_dwordx4 v[192:195], v8, s[4:7], s26 offen sc1
    s_add_u32 s26, s26, 65536
    s_waitcnt lgkmcnt(10)
    v_mfma_f32_32x32x16_bf16 v[64:79], v[100:103], v[136:139], v[64:79]
    ds_read_b64_tr_b16 v[92:93], v5 offset:2048
    ds_read_b64_tr_b16 v[94:95], v5 offset:3072
    s_waitcnt vmcnt(13) lgkmcnt(10)
    v_mfma_f32_32x32x16_bf16 v[48:63], v[104:107], v[140:143], v[48:63]
    ds_read_b64_tr_b16 v[96:97], v4 offset:4096
    ds_read_b64_tr_b16 v[98:99], v4 offset:5120
    buffer_load_dwordx4 v[196:199], v8, s[4:7], s26 offen sc1
    s_add_u32 s26, s26, 65536
    s_waitcnt lgkmcnt(10)
    v_mfma_f32_32x32x16_bf16 v[64:79], v[108:111], v[140:143], v[64:79]
    ds_read_b64_tr_b16 v[100:101], v5 offset:4096
    ds_read_b64_tr_b16 v[102:103], v5 offset:5120
    s_waitcnt vmcnt(13) lgkmcnt(10)
    v_mfma_f32_32x32x16_bf16 v[48:63], v[80:83], v[144:147], v[48:63]
    ds_read_b64_tr_b16 v[104:105], v4 offset:6144
    ds_read_b64_tr_b16 v[106:107], v4 offset:7168
    buffer_load_dwordx4 v[200:203], v8, s[4:7], s26 offen sc1
    s_add_u32 s26, s26, 65536
    s_waitcnt lgkmcnt(10)
    v_mfma_f32_32x32x16_bf16 v[64:79], v[84:87], v[144:147], v[64:79]
    ds_read_b64_tr_b16 v[108:109], v5 offset:6144
    ds_read_b64_tr_b16 v[110:111], v5 offset:7168
    s_waitcnt vmcnt(13) lgkmcnt(10)
    v_mfma_f32_32x32x16_bf16 v[48:63], v[88:91], v[148:151], v[48:63]
    ds_read_b64_tr_b16 v[80:81], v4 offset:8192
    ds_read_b64_tr_b16 v[82:83], v4 offset:9216
    buffer_load_dwordx4 v[204:207], v8, s[4:7], s26 offen sc1
    s_add_u32 s26, s26, 65536
    s_waitcnt lgkmcnt(10)
    v_mfma_f32_32x32x16_bf16 v[64:79], v[92:95], v[148:151], v[64:79]
    ds_read_b64_tr_b16 v[84:85], v5 offset:8192
    ds_read_b64_tr_b16 v[86:87], v5 offset:9216
    s_waitcnt vmcnt(13) lgkmcnt(10)
    v_mfma_f32_32x32x16_bf16 v[48:63], v[96:99], v[152:155], v[48:63]
    ds_read_b64_tr_b16 v[88:89], v4 offset:10240
    ds_read_b64_tr_b16 v[90:91], v4 offset:11264
    buffer_load_dwordx4 v[208:211], v8, s[4:7], s26 offen sc1
    s_add_u32 s26, s26, 65536
    s_waitcnt lgkmcnt(10)
    v_mfma_f32_32x32x16_bf16 v[64:79], v[100:103], v[152:155], v[64:79]
    ds_read_b64_tr_b16 v[92:93], v5 offset:10240
    ds_read_b64_tr_b16 v[94:95], v5 offset:11264
    s_waitcnt vmcnt(13) lgkmcnt(10)
    v_mfma_f32_32x32x16_bf16 v[48:63], v[104:107], v[156:159], v[48:63]
    ds_read_b64_tr_b16 v[96:97], v4 offset:12288
    ds_read_b64_tr_b16 v[98:99], v4 offset:13312
    buffer_load_dwordx4 v[212:215], v8, s[4:7], s26 offen sc1
    s_add_u32 s26, s26, 65536
    s_waitcnt lgkmcnt(10)
    v_mfma_f32_32x32x16_bf16 v[64:79], v[108:111], v[156:159], v[64:79]
    ds_read_b64_tr_b16 v[100:101], v5 offset:12288
    ds_read_b64_tr_b16 v[102:103], v5 offset:13312
    s_waitcnt vmcnt(13) lgkmcnt(10)
    v_mfma_f32_32x32x16_bf16 v[48:63], v[80:83], v[160:163], v[48:63]
    ds_read_b64_tr_b16 v[104:105], v4 offset:14336
    ds_read_b64_tr_b16 v[106:107], v4 offset:15360
    buffer_load_dwordx4 v[216:219], v8, s[4:7], s26 offen sc1
    s_add_u32 s26, s26, 65536
    s_waitcnt lgkmcnt(10)
    v_mfma_f32_32x32x16_bf16 v[64:79], v[84:87], v[160:163], v[64:79]
    ds_read_b64_tr_b16 v[108:109], v5 offset:14336
    ds_read_b64_tr_b16 v[110:111], v5 offset:15360
    s_waitcnt vmcnt(13) lgkmcnt(10)
    v_mfma_f32_32x32x16_bf16 v[48:63], v[88:91], v[164:167], v[48:63]
    s_barrier
    ds_read_b64_tr_b16 v[80:81], v4 offset:16384
    ds_read_b64_tr_b16 v[82:83], v4 offset:17408
    buffer_load_dwordx4 v[220:223], v8, s[4:7], s26 offen sc1
    s_add_u32 s26, s26, 65536
    s_waitcnt lgkmcnt(10)
    v_mfma_f32_32x32x16_bf16 v[64:79], v[92:95], v[164:167], v[64:79]
    ds_read_b64_tr_b16 v[84:85], v5 offset:16384
    ds_read_b64_tr_b16 v[86:87], v5 offset:17408
    s_waitcnt vmcnt(13) lgkmcnt(10)
    v_mfma_f32_32x32x16_bf16 v[48:63], v[96:99], v[168:171], v[48:63]
    ds_read_b64_tr_b16 v[88:89], v4 offset:18432
    ds_read_b64_tr_b16 v[90:91], v4 offset:19456
    buffer_load_dwordx4 v[224:227], v8, s[4:7], s26 offen sc1
    s_add_u32 s26, s26, 65536
    s_waitcnt lgkmcnt(10)
    v_mfma_f32_32x32x16_bf16 v[64:79], v[100:103], v[168:171], v[64:79]
    ds_read_b64_tr_b16 v[92:93], v5 offset:18432
    ds_read_b64_tr_b16 v[94:95], v5 offset:19456
    s_waitcnt vmcnt(13) lgkmcnt(10)
    v_mfma_f32_32x32x16_bf16 v[48:63], v[104:107], v[172:175], v[48:63]
    ds_read_b64_tr_b16 v[96:97], v4 offset:20480
    ds_read_b64_tr_b16 v[98:99], v4 offset:21504
    buffer_load_dwordx4 v[228:231], v8, s[4:7], s26 offen sc1
    s_add_u32 s26, s26, 65536
    s_waitcnt lgkmcnt(10)
    v_mfma_f32_32x32x16_bf16 v[64:79], v[108:111], v[172:175], v[64:79]
    ds_read_b64_tr_b16 v[100:101], v5 offset:20480
    ds_read_b64_tr_b16 v[102:103], v5 offset:21504
    s_waitcnt vmcnt(13) lgkmcnt(10)
    v_mfma_f32_32x32x16_bf16 v[48:63], v[80:83], v[176:179], v[48:63]
    ds_read_b64_tr_b16 v[104:105], v4 offset:22528
    ds_read_b64_tr_b16 v[106:107], v4 offset:23552
    buffer_load_dwordx4 v[232:235], v8, s[4:7], s26 offen sc1
    s_add_u32 s26, s26, 65536
    s_waitcnt lgkmcnt(10)
    v_mfma_f32_32x32x16_bf16 v[64:79], v[84:87], v[176:179], v[64:79]
    ds_read_b64_tr_b16 v[108:109], v5 offset:22528
    ds_read_b64_tr_b16 v[110:111], v5 offset:23552
    s_waitcnt vmcnt(13) lgkmcnt(10)
    v_mfma_f32_32x32x16_bf16 v[48:63], v[88:91], v[180:183], v[48:63]
    ds_read_b64_tr_b16 v[80:81], v4 offset:24576
    ds_read_b64_tr_b16 v[82:83], v4 offset:25600
    buffer_load_dwordx4 v[236:239], v8, s[4:7], s26 offen sc1
    s_add_u32 s26, s26, 65536
    s_waitcnt lgkmcnt(10)
    v_mfma_f32_32x32x16_bf16 v[64:79], v[92:95], v[180:183], v[64:79]
    ds_read_b64_tr_b16 v[84:85], v5 offset:24576
    ds_read_b64_tr_b16 v[86:87], v5 offset:25600
    s_waitcnt vmcnt(13) lgkmcnt(10)
    v_mfma_f32_32x32x16_bf16 v[48:63], v[96:99], v[184:187], v[48:63]
    ds_read_b64_tr_b16 v[88:89], v4 offset:26624
    ds_read_b64_tr_b16 v[90:91], v4 offset:27648
    buffer_load_dwordx4 v[112:115], v8, s[4:7], s26 offen sc1
    s_add_u32 s26, s26, 65536
    s_waitcnt lgkmcnt(10)
    v_mfma_f32_32x32x16_bf16 v[64:79], v[100:103], v[184:187], v[64:79]
    ds_read_b64_tr_b16 v[92:93], v5 offset:26624
    ds_read_b64_tr_b16 v[94:95], v5 offset:27648
    s_waitcnt vmcnt(13) lgkmcnt(10)
    v_mfma_f32_32x32x16_bf16 v[48:63], v[104:107], v[188:191], v[48:63]
    ds_read_b64_tr_b16 v[96:97], v4 offset:28672
    ds_read_b64_tr_b16 v[98:99], v4 offset:29696
    buffer_load_dwordx4 v[116:119], v8, s[4:7], s26 offen sc1
    s_add_u32 s26, s26, 65536
    s_waitcnt lgkmcnt(10)
    v_mfma_f32_32x32x16_bf16 v[64:79], v[108:111], v[188:191], v[64:79]
    ds_read_b64_tr_b16 v[100:101], v5 offset:28672
    ds_read_b64_tr_b16 v[102:103], v5 offset:29696
    s_waitcnt vmcnt(13) lgkmcnt(10)
    v_mfma_f32_32x32x16_bf16 v[48:63], v[80:83], v[192:195], v[48:63]
    ds_read_b64_tr_b16 v[104:105], v4 offset:30720
    ds_read_b64_tr_b16 v[106:107], v4 offset:31744
    buffer_load_dwordx4 v[120:123], v8, s[4:7], s26 offen sc1
    s_add_u32 s26, s26, 65536
    s_waitcnt lgkmcnt(10)
    v_mfma_f32_32x32x16_bf16 v[64:79], v[84:87], v[192:195], v[64:79]
    ds_read_b64_tr_b16 v[108:109], v5 offset:30720
    ds_read_b64_tr_b16 v[110:111], v5 offset:31744
    s_waitcnt vmcnt(13) lgkmcnt(10)
    v_mfma_f32_32x32x16_bf16 v[48:63], v[88:91], v[196:199], v[48:63]
    s_barrier
    ds_read_b64_tr_b16 v[80:81], v4 offset:32768
    ds_read_b64_tr_b16 v[82:83], v4 offset:33792
    buffer_load_dwordx4 v[124:127], v8, s[4:7], s26 offen sc1
    s_add_u32 s26, s26, 65536
    s_waitcnt lgkmcnt(10)
    v_mfma_f32_32x32x16_bf16 v[64:79], v[92:95], v[196:199], v[64:79]
    ds_read_b64_tr_b16 v[84:85], v5 offset:32768
    ds_read_b64_tr_b16 v[86:87], v5 offset:33792
    s_waitcnt vmcnt(13) lgkmcnt(10)
    v_mfma_f32_32x32x16_bf16 v[48:63], v[96:99], v[200:203], v[48:63]
    ds_read_b64_tr_b16 v[88:89], v4 offset:34816
    ds_read_b64_tr_b16 v[90:91], v4 offset:35840
    buffer_load_dwordx4 v[128:131], v8, s[4:7], s26 offen sc1
    s_add_u32 s26, s26, 65536
    s_waitcnt lgkmcnt(10)
    v_mfma_f32_32x32x16_bf16 v[64:79], v[100:103], v[200:203], v[64:79]
    ds_read_b64_tr_b16 v[92:93], v5 offset:34816
    ds_read_b64_tr_b16 v[94:95], v5 offset:35840
    s_waitcnt vmcnt(13) lgkmcnt(10)
    v_mfma_f32_32x32x16_bf16 v[48:63], v[104:107], v[204:207], v[48:63]
    ds_read_b64_tr_b16 v[96:97], v4 offset:36864
    ds_read_b64_tr_b16 v[98:99], v4 offset:37888
    buffer_load_dwordx4 v[132:135], v8, s[4:7], s26 offen sc1
    s_add_u32 s26, s26, 65536
    s_waitcnt lgkmcnt(10)
    v_mfma_f32_32x32x16_bf16 v[64:79], v[108:111], v[204:207], v[64:79]
    ds_read_b64_tr_b16 v[100:101], v5 offset:36864
    ds_read_b64_tr_b16 v[102:103], v5 offset:37888
    s_waitcnt vmcnt(13) lgkmcnt(10)
    v_mfma_f32_32x32x16_bf16 v[48:63], v[80:83], v[208:211], v[48:63]
    ds_read_b64_tr_b16 v[104:105], v4 offset:38912
    ds_read_b64_tr_b16 v[106:107], v4 offset:39936
    buffer_load_dwordx4 v[136:139], v8, s[4:7], s26 offen sc1
    s_add_u32 s26, s26, 65536
    s_waitcnt lgkmcnt(10)
    v_mfma_f32_32x32x16_bf16 v[64:79], v[84:87], v[208:211], v[64:79]
    ds_read_b64_tr_b16 v[108:109], v5 offset:38912
    ds_read_b64_tr_b16 v[110:111], v5 offset:39936
    s_waitcnt vmcnt(13) lgkmcnt(10)
    v_mfma_f32_32x32x16_bf16 v[48:63], v[88:91], v[212:215], v[48:63]
    ds_read_b64_tr_b16 v[80:81], v4 offset:40960
    ds_read_b64_tr_b16 v[82:83], v4 offset:41984
    buffer_load_dwordx4 v[140:143], v8, s[4:7], s26 offen sc1
    s_add_u32 s26, s26, 65536
    s_waitcnt lgkmcnt(10)
    v_mfma_f32_32x32x16_bf16 v[64:79], v[92:95], v[212:215], v[64:79]
    ds_read_b64_tr_b16 v[84:85], v5 offset:40960
    ds_read_b64_tr_b16 v[86:87], v5 offset:41984
    s_waitcnt vmcnt(13) lgkmcnt(10)
    v_mfma_f32_32x32x16_bf16 v[48:63], v[96:99], v[216:219], v[48:63]
    ds_read_b64_tr_b16 v[88:89], v4 offset:43008
    ds_read_b64_tr_b16 v[90:91], v4 offset:44032
    buffer_load_dwordx4 v[144:147], v8, s[4:7], s26 offen sc1
    s_add_u32 s26, s26, 65536
    s_waitcnt lgkmcnt(10)
    v_mfma_f32_32x32x16_bf16 v[64:79], v[100:103], v[216:219], v[64:79]
    ds_read_b64_tr_b16 v[92:93], v5 offset:43008
    ds_read_b64_tr_b16 v[94:95], v5 offset:44032
    s_waitcnt vmcnt(13) lgkmcnt(10)
    v_mfma_f32_32x32x16_bf16 v[48:63], v[104:107], v[220:223], v[48:63]
    ds_read_b64_tr_b16 v[96:97], v4 offset:45056
    ds_read_b64_tr_b16 v[98:99], v4 offset:46080
    buffer_load_dwordx4 v[148:151], v8, s[4:7], s26 offen sc1
    s_add_u32 s26, s26, 65536
    s_waitcnt lgkmcnt(10)
    v_mfma_f32_32x32x16_bf16 v[64:79], v[108:111], v[220:223], v[64:79]
    ds_read_b64_tr_b16 v[100:101], v5 offset:45056
    ds_read_b64_tr_b16 v[102:103], v5 offset:46080
    s_waitcnt vmcnt(13) lgkmcnt(10)
    v_mfma_f32_32x32x16_bf16 v[48:63], v[80:83], v[224:227], v[48:63]
    ds_read_b64_tr_b16 v[104:105], v4 offset:47104
    ds_read_b64_tr_b16 v[106:107], v4 offset:48128
    buffer_load_dwordx4 v[152:155], v8, s[4:7], s26 offen sc1
    s_add_u32 s26, s26, 65536
    s_waitcnt lgkmcnt(10)
    v_mfma_f32_32x32x16_bf16 v[64:79], v[84:87], v[224:227], v[64:79]
    ds_read_b64_tr_b16 v[108:109], v5 offset:47104
    ds_read_b64_tr_b16 v[110:111], v5 offset:48128
    s_waitcnt vmcnt(13) lgkmcnt(10)
    v_mfma_f32_32x32x16_bf16 v[48:63], v[88:91], v[228:231], v[48:63]
    s_barrier
    ds_read_b64_tr_b16 v[80:81], v4 offset:49152
    ds_read_b64_tr_b16 v[82:83], v4 offset:50176
    buffer_load_dwordx4 v[156:159], v8, s[4:7], s26 offen sc1
    s_add_u32 s26, s26, 65536
    s_waitcnt lgkmcnt(10)
    v_mfma_f32_32x32x16_bf16 v[64:79], v[92:95], v[228:231], v[64:79]
    ds_read_b64_tr_b16 v[84:85], v5 offset:49152
    ds_read_b64_tr_b16 v[86:87], v5 offset:50176
    s_waitcnt vmcnt(13) lgkmcnt(10)
    v_mfma_f32_32x32x16_bf16 v[48:63], v[96:99], v[232:235], v[48:63]
    ds_read_b64_tr_b16 v[88:89], v4 offset:51200
    ds_read_b64_tr_b16 v[90:91], v4 offset:52224
    s_waitcnt lgkmcnt(10)
    v_mfma_f32_32x32x16_bf16 v[64:79], v[100:103], v[232:235], v[64:79]
    ds_read_b64_tr_b16 v[92:93], v5 offset:51200
    ds_read_b64_tr_b16 v[94:95], v5 offset:52224
    s_waitcnt vmcnt(12) lgkmcnt(10)
    v_mfma_f32_32x32x16_bf16 v[48:63], v[104:107], v[236:239], v[48:63]
    ds_read_b64_tr_b16 v[96:97], v4 offset:53248
    ds_read_b64_tr_b16 v[98:99], v4 offset:54272
    s_waitcnt lgkmcnt(10)
    v_mfma_f32_32x32x16_bf16 v[64:79], v[108:111], v[236:239], v[64:79]
    ds_read_b64_tr_b16 v[100:101], v5 offset:53248
    ds_read_b64_tr_b16 v[102:103], v5 offset:54272
    s_waitcnt vmcnt(11) lgkmcnt(10)
    v_mfma_f32_32x32x16_bf16 v[48:63], v[80:83], v[112:115], v[48:63]
    ds_read_b64_tr_b16 v[104:105], v4 offset:55296
    ds_read_b64_tr_b16 v[106:107], v4 offset:56320
    s_waitcnt lgkmcnt(10)
    v_mfma_f32_32x32x16_bf16 v[64:79], v[84:87], v[112:115], v[64:79]
    ds_read_b64_tr_b16 v[108:109], v5 offset:55296
    ds_read_b64_tr_b16 v[110:111], v5 offset:56320
    s_waitcnt vmcnt(10) lgkmcnt(10)
    v_mfma_f32_32x32x16_bf16 v[48:63], v[88:91], v[116:119], v[48:63]
    ds_read_b64_tr_b16 v[80:81], v4 offset:57344
    ds_read_b64_tr_b16 v[82:83], v4 offset:58368
    s_waitcnt lgkmcnt(10)
    v_mfma_f32_32x32x16_bf16 v[64:79], v[92:95], v[116:119], v[64:79]
    ds_read_b64_tr_b16 v[84:85], v5 offset:57344
    ds_read_b64_tr_b16 v[86:87], v5 offset:58368
    s_waitcnt vmcnt(9) lgkmcnt(10)
    v_mfma_f32_32x32x16_bf16 v[48:63], v[96:99], v[120:123], v[48:63]
    ds_read_b64_tr_b16 v[88:89], v4 offset:59392
    ds_read_b64_tr_b16 v[90:91], v4 offset:60416
    s_waitcnt lgkmcnt(10)
    v_mfma_f32_32x32x16_bf16 v[64:79], v[100:103], v[120:123], v[64:79]
    ds_read_b64_tr_b16 v[92:93], v5 offset:59392
    ds_read_b64_tr_b16 v[94:95], v5 offset:60416
    s_waitcnt vmcnt(8) lgkmcnt(10)
    v_mfma_f32_32x32x16_bf16 v[48:63], v[104:107], v[124:127], v[48:63]
    ds_read_b64_tr_b16 v[96:97], v4 offset:61440
    ds_read_b64_tr_b16 v[98:99], v4 offset:62464
    s_waitcnt lgkmcnt(10)
    v_mfma_f32_32x32x16_bf16 v[64:79], v[108:111], v[124:127], v[64:79]
    ds_read_b64_tr_b16 v[100:101], v5 offset:61440
    ds_read_b64_tr_b16 v[102:103], v5 offset:62464
    s_waitcnt vmcnt(7) lgkmcnt(10)
    v_mfma_f32_32x32x16_bf16 v[48:63], v[80:83], v[128:131], v[48:63]
    ds_read_b64_tr_b16 v[104:105], v4 offset:63488
    ds_read_b64_tr_b16 v[106:107], v4 offset:64512
    s_waitcnt lgkmcnt(10)
    v_mfma_f32_32x32x16_bf16 v[64:79], v[84:87], v[128:131], v[64:79]
    ds_read_b64_tr_b16 v[108:109], v5 offset:63488
    ds_read_b64_tr_b16 v[110:111], v5 offset:64512
    s_waitcnt vmcnt(6) lgkmcnt(10)
    v_mfma_f32_32x32x16_bf16 v[48:63], v[88:91], v[132:135], v[48:63]
    s_barrier
    v_add_u32 v4, 0x10000, v4
    v_add_u32 v5, 0x10000, v5
    ds_read_b64_tr_b16 v[80:81], v4 offset:0
    ds_read_b64_tr_b16 v[82:83], v4 offset:1024
    s_waitcnt lgkmcnt(10)
    v_mfma_f32_32x32x16_bf16 v[64:79], v[92:95], v[132:135], v[64:79]
    ds_read_b64_tr_b16 v[84:85], v5 offset:0
    ds_read_b64_tr_b16 v[86:87], v5 offset:1024
    s_waitcnt vmcnt(5) lgkmcnt(10)
    v_mfma_f32_32x32x16_bf16 v[48:63], v[96:99], v[136:139], v[48:63]
    ds_read_b64_tr_b16 v[88:89], v4 offset:2048
    ds_read_b64_tr_b16 v[90:91], v4 offset:3072
    s_waitcnt lgkmcnt(10)
    v_mfma_f32_32x32x16_bf16 v[64:79], v[100:103], v[136:139], v[64:79]
    ds_read_b64_tr_b16 v[92:93], v5 offset:2048
    ds_read_b64_tr_b16 v[94:95], v5 offset:3072
    s_waitcnt vmcnt(4) lgkmcnt(10)
    v_mfma_f32_32x32x16_bf16 v[48:63], v[104:107], v[140:143], v[48:63]
    ds_read_b64_tr_b16 v[96:97], v4 offset:4096
    ds_read_b64_tr_b16 v[98:99], v4 offset:5120
    s_waitcnt lgkmcnt(10)
    v_mfma_f32_32x32x16_bf16 v[64:79], v[108:111], v[140:143], v[64:79]
    ds_read_b64_tr_b16 v[100:101], v5 offset:4096
    ds_read_b64_tr_b16 v[102:103], v5 offset:5120
    s_waitcnt vmcnt(3) lgkmcnt(10)
    v_mfma_f32_32x32x16_bf16 v[48:63], v[80:83], v[144:147], v[48:63]
    ds_read_b64_tr_b16 v[104:105], v4 offset:6144
    ds_read_b64_tr_b16 v[106:107], v4 offset:7168
    s_waitcnt lgkmcnt(10)
    v_mfma_f32_32x32x16_bf16 v[64:79], v[84:87], v[144:147], v[64:79]
    ds_read_b64_tr_b16 v[108:109], v5 offset:6144
    ds_read_b64_tr_b16 v[110:111], v5 offset:7168
    s_waitcnt vmcnt(2) lgkmcnt(10)
    v_mfma_f32_32x32x16_bf16 v[48:63], v[88:91], v[148:151], v[48:63]
    s_waitcnt lgkmcnt(8)
    v_mfma_f32_32x32x16_bf16 v[64:79], v[92:95], v[148:151], v[64:79]
    s_waitcnt vmcnt(1) lgkmcnt(6)
    v_mfma_f32_32x32x16_bf16 v[48:63], v[96:99], v[152:155], v[48:63]
    s_waitcnt lgkmcnt(4)
    v_mfma_f32_32x32x16_bf16 v[64:79], v[100:103], v[152:155], v[64:79]
    s_waitcnt vmcnt(0) lgkmcnt(2)
    v_mfma_f32_32x32x16_bf16 v[48:63], v[104:107], v[156:159], v[48:63]
    s_waitcnt lgkmcnt(0)
    v_mfma_f32_32x32x16_bf16 v[64:79], v[108:111], v[156:159], v[64:79]
    s_nop 9
    v_cvt_pk_bf16_f32 v16, v48, v49
    v_cvt_pk_bf16_f32 v17, v50, v51
    v_cvt_pk_bf16_f32 v18, v52, v53
    v_cvt_pk_bf16_f32 v19, v54, v55
    s_nop 0
    v_permlane32_swap_b32 v16, v18
    v_permlane32_swap_b32 v17, v19
    ds_write_b128 v32, v[16:19]
    v_cvt_pk_bf16_f32 v20, v56, v57
    v_cvt_pk_bf16_f32 v21, v58, v59
    v_cvt_pk_bf16_f32 v22, v60, v61
    v_cvt_pk_bf16_f32 v23, v62, v63
    s_nop 0
    v_permlane32_swap_b32 v20, v22
    v_permlane32_swap_b32 v21, v23
    ds_write_b128 v33, v[20:23]
    v_cvt_pk_bf16_f32 v24, v64, v65
    v_cvt_pk_bf16_f32 v25, v66, v67
    v_cvt_pk_bf16_f32 v26, v68, v69
    v_cvt_pk_bf16_f32 v27, v70, v71
    s_nop 0
    v_permlane32_swap_b32 v24, v26
    v_permlane32_swap_b32 v25, v27
    ds_write_b128 v34, v[24:27]
    v_cvt_pk_bf16_f32 v28, v72, v73
    v_cvt_pk_bf16_f32 v29, v74, v75
    v_cvt_pk_bf16_f32 v30, v76, v77
    v_cvt_pk_bf16_f32 v31, v78, v79
    s_nop 0
    v_permlane32_swap_b32 v28, v30
    v_permlane32_swap_b32 v29, v31
    ds_write_b128 v35, v[28:31]
    ds_read_b128 v[48:51], v36 offset:0
    ds_read_b128 v[52:55], v36 offset:1024
    ds_read_b128 v[56:59], v36 offset:2048
    ds_read_b128 v[60:63], v36 offset:3072
    s_waitcnt lgkmcnt(3)
    buffer_store_dwordx4 v[48:51], v37, s[12:15], s48 offen sc1
    s_waitcnt lgkmcnt(2)
    buffer_store_dwordx4 v[52:55], v37, s[12:15], s49 offen sc1
    s_waitcnt lgkmcnt(1)
    buffer_store_dwordx4 v[56:59], v37, s[12:15], s50 offen sc1
    s_waitcnt lgkmcnt(0)
    buffer_store_dwordx4 v[60:63], v37, s[12:15], s51 offen sc1
    s_endpgm
L_p3_idle5:
    s_barrier
L_exit:
    s_endpgm
L_slow0:
    buffer_store_dwordx4 v[152:155], v4, s[52:55], s25 offen sc1
    s_mov_b32 exec_hi, 0
    buffer_store_dwordx2 v[156:157], v5, s[52:55], s25 offen sc1
    s_mov_b32 exec_hi, -1
    s_branch L_back0
L_slow1:
    buffer_store_dwordx4 v[16:19], v10, s[4:7], s48 offen sc1
    buffer_store_dwordx4 v[20:23], v10, s[4:7], s49 offen sc1
    s_branch L_back1
L_slow2:
    buffer_store_dwordx4 v[24:27], v10, s[4:7], s50 offen sc1
    buffer_store_dwordx4 v[28:31], v10, s[4:7], s51 offen sc1
    s_branch L_back2
L_slow3:
    buffer_store_dwordx2 v[12:13], v9, s[4:7], 0 offen sc1
    s_branch L_back3
L_slow4:
    buffer_store_dword v13, v12, s[4:7], s23 offen sc1
    s_branch L_back4
L_slow5:
    buffer_store_dword v13, v12, s[4:7], s23 offen sc1
    s_branch L_back5
L_slow6:
    buffer_store_dword v13, v12, s[4:7], s23 offen sc1
    s_branch L_back6
L_code_end:
.section .rodata,"a"
.p2align 6
.amdhsa_kernel sequential_preLN__mha_block__mixer_channel_mlp__prompt_kernel
  .amdhsa_next_free_vgpr 256
  .amdhsa_next_free_sgpr 96
  .amdhsa_accum_offset 256
  .amdhsa_group_segment_fixed_size 0
  .amdhsa_kernarg_size 88
  .amdhsa_user_sgpr_count 2
  .amdhsa_user_sgpr_kernarg_segment_ptr 1
  .amdhsa_system_sgpr_workgroup_id_x 1
.end_amdhsa_kernel
```
